```python
import torch

def _softmax(x, axis=-1):
    return torch.softmax(x, dim=axis)
def _gelu(x):
    return torch.nn.functional.gelu(x, approximate="tanh")
def _silu(x):
    return torch.nn.functional.silu(x)
def _sigmoid(x):
    return torch.sigmoid(x)
def _layernorm(x, axis=-1, eps=1e-5):
    m = x.mean(dim=axis, keepdim=True)
    v = x.var(dim=axis, keepdim=True, unbiased=False)
    return (x - m) / torch.sqrt(v + eps)
def _scatter_add(tgt, idx, src, axis=0):
    return tgt.clone().index_add_(axis, idx, src)
def _segment_sum(src, seg, n):
    out = torch.zeros((n,) + src.shape[1:], dtype=src.dtype)
    return out.index_add_(0, seg, src)
def _pad(x, pw):
    flat = tuple(v for pair in reversed(pw) for v in pair)
    return torch.nn.functional.pad(x, flat)

kernel_name = 'sequential_preLN__softmax_full_mha__dense_activation_relu__prompt'

def setup_inputs():

    _w = (lambda a: (lambda t: t.to(torch.bfloat16) if t.is_floating_point() else t)(torch.as_tensor(a)))
    def _A_setup():
        B, S, D = 1, 2048, 448
        return {
            "x": _w((lambda *s: torch.randn(*s, dtype=torch.bfloat16) * 0.05)(B, S, D)),
            "wqkv": _w((lambda *s: torch.randn(*s, dtype=torch.bfloat16) * 0.05)(D, 3 * D)),
            "wo": _w((lambda *s: torch.randn(*s, dtype=torch.bfloat16) * 0.05)(D, D)),
        }
    _A_in = _A_setup()

    def _B_setup():
        B, S, D, Dff = 1, 2048, 448, 1792
        return {
            "x": _w((lambda *s: torch.randn(*s, dtype=torch.bfloat16) * 0.05)(B, S, D)),
            "w1": _w((lambda *s: torch.randn(*s, dtype=torch.bfloat16) * 0.05)(D, Dff)),
            "w2": _w((lambda *s: torch.randn(*s, dtype=torch.bfloat16) * 0.05)(Dff, D)),
        }
    _B_in = _B_setup()

    return {
        "A_x": _A_in["x"],
        "A_wqkv": _A_in["wqkv"],
        "A_wo": _A_in["wo"],
        "B_x": _B_in["x"],
        "B_w1": _B_in["w1"],
        "B_w2": _B_in["w2"],
    }

def reference(A_x, A_wqkv, A_wo, B_x, B_w1, B_w2):
    def _A_ref(x, wqkv, wo):
        B, S, D = x.shape
        H = 16; Dh = D // H
        qkv = (lambda x, *d: x.permute(*d))((x @ wqkv).reshape(B, S, 3, H, Dh), 2, 0, 3, 1, 4)
        q, k, v = qkv[0], qkv[1], qkv[2]
        scale = Dh ** -0.5
        scores = torch.einsum("bhqd,bhkd->bhqk", q, k) * scale
        p = _softmax(scores, axis=-1)
        o = torch.einsum("bhqk,bhkd->bhqd", p, v)
        return (lambda x, *d: x.permute(*d))(o, 0, 2, 1, 3).reshape(B, S, D) @ wo

    def _B_ref(x, w1, w2):
        h = torch.einsum("bsd,df->bsf", x, w1)
        zero = torch.zeros_like(h)
        h = torch.maximum(h, zero)
        return torch.einsum("bsf,fd->bsd", h, w2)

    x = A_x
    h = x + _A_ref(_layernorm(x, axis=-1), A_wqkv, A_wo)
    h2 = h + _B_ref(_layernorm(h, axis=-1), B_w1, B_w2)
    return h2
```

```asm
; @launch grid=(256,1,1) block=(512,1,1) lds=163840
.amdgcn_target "amdgcn-amd-amdhsa--gfx950"
.text
.globl sequential_preLN__softmax_full_mha__dense_activation_relu__prompt_kernel
.p2align 8
.type sequential_preLN__softmax_full_mha__dense_activation_relu__prompt_kernel,@function
sequential_preLN__softmax_full_mha__dense_activation_relu__prompt_kernel:
    s_cmp_ge_u32 s2, 256
    s_cbranch_scc1 Lend
    v_lshrrev_b32 v1, 6, v0
    v_and_b32 v0, 63, v0
    v_readfirstlane_b32 s38, v1
    v_lshlrev_b32 v1, 4, v0
    s_cmp_ge_u32 s38, 4
    s_cbranch_scc1 Lpb
    v_mov_b32 v4, 0
    v_mov_b32 v5, 0
    v_mov_b32 v6, 0
    v_mov_b32 v7, 0
    v_add_u32 v8, 155648, v1
    ds_write_b128 v8, v[4:7]
    ds_write_b128 v8, v[4:7] offset:1024
    ds_write_b128 v8, v[4:7] offset:2048
    ds_write_b128 v8, v[4:7] offset:3072
    ds_write_b128 v8, v[4:7] offset:4096
    s_waitcnt lgkmcnt(0)
    s_barrier
Lpb:
    s_load_dwordx16 s[64:79], s[0:1], 0
    s_load_dwordx2 s[80:81], s[0:1], 64
    s_mov_b32 s46, s2
    s_lshr_b32 s47, s2, 3
    s_mul_i32 s56, s47, 37
    s_lshr_b32 s56, s56, 8
    s_mul_i32 s49, s56, 7
    s_sub_u32 s57, s47, s49
    s_and_b32 s50, s2, 1
    s_mul_i32 s50, s50, 7
    s_add_u32 s82, s57, s50
    s_bfe_u32 s50, s2, 0x20001
    s_lshl_b32 s50, s50, 2
    s_add_u32 s83, s56, s50
    s_and_b32 s39, s38, 3
    v_and_b32 v2, 31, v0
    v_lshrrev_b32 v3, 5, v0
    s_cmp_lt_u32 s38, 4
    s_cbranch_scc1 LA
    s_barrier
    s_cmp_ge_u32 s2, 224
    s_cbranch_scc1 LF
    v_lshrrev_b32 v4, 3, v0
    v_and_b32 v5, 7, v0
    v_lshrrev_b32 v6, 4, v0
    v_xor_b32 v5, v5, v6
    s_lshl_b32 s47, s83, 7
    s_lshl_b32 s48, s39, 5
    s_add_u32 s47, s47, s48
    v_add_u32 v4, s47, v4
    v_mul_u32_u24 v4, 0x380, v4
    v_lshl_add_u32 v8, v5, 4, v4
    v_xor_b32 v5, 4, v5
    v_lshl_add_u32 v9, v5, 4, v4
    v_add_u32 v9, 0x1800, v9
    v_add_u32 v10, 0x3000, v8
    v_add_u32 v11, 0x3000, v9
    s_mul_i32 s47, s39, 43008
    s_mul_i32 s48, s82, 192
    s_add_u32 s47, s47, s48
    v_add_u32 v5, s47, v1
    s_movk_i32 s48, 0x9c0
    v_add_u32 v4, 0, v0
    v_mul_u32_u24 v4, 0xab, v4
    v_lshrrev_b32 v4, 11, v4
    v_mad_u32_u24 v12, v4, s48, v5
    v_add_u32 v4, 64, v0
    v_mul_u32_u24 v4, 0xab, v4
    v_lshrrev_b32 v4, 11, v4
    v_mad_u32_u24 v13, v4, s48, v5
    v_add_u32 v4, 128, v0
    v_mul_u32_u24 v4, 0xab, v4
    v_lshrrev_b32 v4, 11, v4
    v_mad_u32_u24 v14, v4, s48, v5
    s_lshl_b32 s50, s39, 12
    s_mul_i32 s51, s39, 3072
    s_lshl_b32 s53, s56, 1
    s_add_u32 s53, s53, s57
    s_sub_u32 s54, s53, 7
    s_cmp_ge_u32 s53, 7
    s_cselect_b32 s53, s54, s53
    s_mul_i32 s54, s53, 172032
    s_lshl_b32 s53, s53, 7
    s_waitcnt lgkmcnt(0)
    s_mov_b32 s4, s64
    s_mov_b32 s5, s65
    s_mov_b32 s6, 1835008
    s_mov_b32 s7, 0x00020000
    s_mov_b32 s8, s66
    s_mov_b32 s9, s67
    s_mov_b32 s10, 1204224
    s_mov_b32 s11, 0x00020000
    s_add_u32 m0, s50, 0
    s_nop 0
    buffer_load_dwordx4 v8, s[4:7], s53 offen offset:0 lds
    buffer_load_dwordx4 v9, s[4:7], s53 offen offset:1024 lds
    buffer_load_dwordx4 v10, s[4:7], s53 offen offset:2048 lds
    buffer_load_dwordx4 v11, s[4:7], s53 offen offset:3072 lds
    s_add_u32 m0, s51, 81920
    s_add_u32 s53, s53, 128
    buffer_load_dwordx4 v12, s[8:11], s54 offen offset:0 lds
    buffer_load_dwordx4 v13, s[8:11], s54 offen offset:1024 lds
    buffer_load_dwordx4 v14, s[8:11], s54 offen offset:2048 lds
    s_add_u32 s54, s54, 172032
    s_cmp_eq_u32 s53, 896
    s_cselect_b32 s53, 0, s53
    s_cselect_b32 s54, 0, s54
    s_mov_b32 s12, s68
    s_mov_b32 s13, s69
    s_mov_b32 s14, 401408
    s_mov_b32 s15, 0x00020000
    s_mov_b32 s16, s72
    s_mov_b32 s17, s73
    s_mov_b32 s18, 1605632
    s_mov_b32 s19, 0x00020000
    s_mov_b32 s20, s74
    s_mov_b32 s21, s75
    s_mov_b32 s22, 1605632
    s_mov_b32 s23, 0x00020000
    s_mov_b32 s24, s76
    s_mov_b32 s25, s77
    s_mov_b32 s26, 1835008
    s_mov_b32 s27, 0x00020000
    s_mov_b32 s28, s80
    s_mov_b32 s29, s81
    s_mov_b32 s30, 33554432
    s_mov_b32 s31, 0x00020000
    s_mov_b32 s32, s78
    s_mov_b32 s33, s79
    s_mov_b32 s34, 256
    s_mov_b32 s35, 0x00020000
    s_and_b32 s36, s46, 7
    s_lshl_b32 s62, s36, 1
    s_bfe_u32 s47, s46, 0x10003
    s_add_u32 s62, s62, s47
    s_lshr_b32 s63, s46, 4
    s_lshr_b32 s47, s46, 7
    s_lshl_b32 s47, s47, 3
    s_add_u32 s36, s36, s47
    s_bfe_u32 s37, s46, 0x40003
    s_mov_b32 s42, 0
    s_mov_b32 s43, -1
    s_mov_b32 s44, 0xF0000000
    s_mov_b32 s45, 0xF0000000
    s_mov_b32 s3, 0
    v_bfe_u32 v4, v0, 2, 2
    v_lshl_add_u32 v4, v3, 3, v4
    v_mul_u32_u24 v4, 0xc0, v4
    v_bfe_u32 v5, v0, 4, 1
    v_lshl_add_u32 v4, v5, 5, v4
    v_and_b32 v5, 3, v0
    v_lshl_add_u32 v4, v5, 3, v4
    v_add_u32 v20, 81920, v4
    s_lshl_b32 s47, s39, 6
    v_add_u32 v20, s47, v20
    s_mov_b32 s48, 0x00020001
    s_mov_b32 s49, 0x00020001
    v_mov_b32 v4, 0x3f803f80
    v_cndmask_b32 v56, 0, v4, s[48:49]
    v_mov_b32 v57, v56
    v_mov_b32 v58, v56
    v_mov_b32 v59, v56
    s_lshl_b32 s47, s38, 8
    s_add_u32 s47, s47, 158720
    v_lshl_add_u32 v16, v0, 2, s47
    v_and_b32 v4, 7, v0
    v_lshlrev_b32 v4, 8, v4
    v_lshl_add_u32 v4, v0, 2, v4
    v_add_u32 v17, 158720, v4
    v_and_b32 v18, 4, v0
    v_lshrrev_b32 v18, 1, v18
    v_subrev_u32 v18, 2, v18
    s_add_u32 m0, s50, 16384
    s_nop 0
    buffer_load_dwordx4 v8, s[4:7], s53 offen offset:0 lds
    buffer_load_dwordx4 v9, s[4:7], s53 offen offset:1024 lds
    buffer_load_dwordx4 v10, s[4:7], s53 offen offset:2048 lds
    buffer_load_dwordx4 v11, s[4:7], s53 offen offset:3072 lds
    s_add_u32 m0, s51, 94208
    s_add_u32 s53, s53, 128
    buffer_load_dwordx4 v12, s[8:11], s54 offen offset:0 lds
    buffer_load_dwordx4 v13, s[8:11], s54 offen offset:1024 lds
    buffer_load_dwordx4 v14, s[8:11], s54 offen offset:2048 lds
    s_add_u32 s54, s54, 172032
    s_cmp_eq_u32 s53, 896
    s_cselect_b32 s53, 0, s53
    s_cselect_b32 s54, 0, s54
    s_lshl_b32 s49, s82, 4
    s_add_u32 s49, s49, s83
    s_mov_b32 s55, s49
    s_waitcnt vmcnt(7)
    v_mov_b32 v4, 1
    ds_write_b32 v16, v4
    s_add_u32 m0, s50, 32768
    s_nop 0
    buffer_load_dwordx4 v8, s[4:7], s53 offen offset:0 lds
    buffer_load_dwordx4 v9, s[4:7], s53 offen offset:1024 lds
    buffer_load_dwordx4 v10, s[4:7], s53 offen offset:2048 lds
    buffer_load_dwordx4 v11, s[4:7], s53 offen offset:3072 lds
    s_add_u32 m0, s51, 106496
    s_add_u32 s53, s53, 128
    buffer_load_dwordx4 v12, s[8:11], s54 offen offset:0 lds
    buffer_load_dwordx4 v13, s[8:11], s54 offen offset:1024 lds
    buffer_load_dwordx4 v14, s[8:11], s54 offen offset:2048 lds
    s_add_u32 s54, s54, 172032
    s_cmp_eq_u32 s53, 896
    s_cselect_b32 s53, 0, s53
    s_cselect_b32 s54, 0, s54
    s_waitcnt vmcnt(7)
    v_mov_b32 v4, 2
    ds_write_b32 v16, v4
    v_add_u32 v18, 1, v18
Lbp_1:
    ds_read_b32 v4, v17
    s_waitcnt lgkmcnt(0)
    v_cmp_gt_i32 vcc, v18, v4
    s_nop 4
    s_cbranch_vccnz Lbp_1
    ds_read_b64_tr_b16 v[24:25], v20 offset:0
    ds_read_b64_tr_b16 v[26:27], v20 offset:768
    ds_read_b64_tr_b16 v[28:29], v20 offset:3072
    ds_read_b64_tr_b16 v[30:31], v20 offset:3840
    ds_read_b64_tr_b16 v[32:33], v20 offset:6144
    ds_read_b64_tr_b16 v[34:35], v20 offset:6912
    ds_read_b64_tr_b16 v[36:37], v20 offset:9216
    ds_read_b64_tr_b16 v[38:39], v20 offset:9984
    s_add_u32 m0, s50, 49152
    s_nop 0
    buffer_load_dwordx4 v8, s[4:7], s53 offen offset:0 lds
    buffer_load_dwordx4 v9, s[4:7], s53 offen offset:1024 lds
    buffer_load_dwordx4 v10, s[4:7], s53 offen offset:2048 lds
    buffer_load_dwordx4 v11, s[4:7], s53 offen offset:3072 lds
    s_add_u32 m0, s51, 118784
    s_add_u32 s53, s53, 128
    buffer_load_dwordx4 v12, s[8:11], s54 offen offset:0 lds
    buffer_load_dwordx4 v13, s[8:11], s54 offen offset:1024 lds
    buffer_load_dwordx4 v14, s[8:11], s54 offen offset:2048 lds
    s_add_u32 s54, s54, 172032
    s_cmp_eq_u32 s53, 896
    s_cselect_b32 s53, 0, s53
    s_cselect_b32 s54, 0, s54
    s_waitcnt lgkmcnt(6)
    v_mfma_f32_16x16x32_bf16 v[40:43], v[56:59], v[24:27], 0
    s_waitcnt lgkmcnt(4)
    v_mfma_f32_16x16x32_bf16 v[40:43], v[56:59], v[28:31], v[40:43]
    s_waitcnt lgkmcnt(2)
    v_mfma_f32_16x16x32_bf16 v[40:43], v[56:59], v[32:35], v[40:43]
    s_waitcnt lgkmcnt(0)
    v_mfma_f32_16x16x32_bf16 v[40:43], v[56:59], v[36:39], v[40:43]
    s_waitcnt vmcnt(7)
    v_mov_b32 v4, 3
    ds_write_b32 v16, v4
    v_add_u32 v18, 1, v18
Lbp_2:
    ds_read_b32 v4, v17
    s_waitcnt lgkmcnt(0)
    v_cmp_gt_i32 vcc, v18, v4
    s_nop 4
    s_cbranch_vccnz Lbp_2
    ds_read_b64_tr_b16 v[24:25], v20 offset:12288
    ds_read_b64_tr_b16 v[26:27], v20 offset:13056
    ds_read_b64_tr_b16 v[28:29], v20 offset:15360
    ds_read_b64_tr_b16 v[30:31], v20 offset:16128
    ds_read_b64_tr_b16 v[32:33], v20 offset:18432
    ds_read_b64_tr_b16 v[34:35], v20 offset:19200
    ds_read_b64_tr_b16 v[36:37], v20 offset:21504
    ds_read_b64_tr_b16 v[38:39], v20 offset:22272
    v_mov_b32 v4, 0
    s_mov_b32 s47, 0
    s_cmp_eq_u32 s38, 7
    s_cselect_b32 s47, s47, 0x7ff00000
    buffer_load_dwordx2 v[52:53], v4, s[32:35], s47 offen sc1
    s_add_u32 m0, s50, 65536
    s_nop 0
    buffer_load_dwordx4 v8, s[4:7], s53 offen offset:0 lds
    buffer_load_dwordx4 v9, s[4:7], s53 offen offset:1024 lds
    buffer_load_dwordx4 v10, s[4:7], s53 offen offset:2048 lds
    buffer_load_dwordx4 v11, s[4:7], s53 offen offset:3072 lds
    s_add_u32 m0, s51, 131072
    s_add_u32 s53, s53, 128
    buffer_load_dwordx4 v12, s[8:11], s54 offen offset:0 lds
    buffer_load_dwordx4 v13, s[8:11], s54 offen offset:1024 lds
    buffer_load_dwordx4 v14, s[8:11], s54 offen offset:2048 lds
    s_add_u32 s54, s54, 172032
    s_cmp_eq_u32 s53, 896
    s_cselect_b32 s53, 0, s53
    s_cselect_b32 s54, 0, s54
    s_waitcnt lgkmcnt(6)
    v_mfma_f32_16x16x32_bf16 v[40:43], v[56:59], v[24:27], v[40:43]
    s_waitcnt lgkmcnt(4)
    v_mfma_f32_16x16x32_bf16 v[40:43], v[56:59], v[28:31], v[40:43]
    s_waitcnt lgkmcnt(2)
    v_mfma_f32_16x16x32_bf16 v[40:43], v[56:59], v[32:35], v[40:43]
    s_waitcnt lgkmcnt(0)
    v_mfma_f32_16x16x32_bf16 v[40:43], v[56:59], v[36:39], v[40:43]
    s_waitcnt vmcnt(8)
    v_mov_b32 v4, 4
    ds_write_b32 v16, v4
    v_add_u32 v18, 1, v18
Lbp_3:
    ds_read_b32 v4, v17
    s_waitcnt lgkmcnt(0)
    v_cmp_gt_i32 vcc, v18, v4
    s_nop 4
    s_cbranch_vccnz Lbp_3
    ds_read_b64_tr_b16 v[24:25], v20 offset:24576
    ds_read_b64_tr_b16 v[26:27], v20 offset:25344
    ds_read_b64_tr_b16 v[28:29], v20 offset:27648
    ds_read_b64_tr_b16 v[30:31], v20 offset:28416
    ds_read_b64_tr_b16 v[32:33], v20 offset:30720
    ds_read_b64_tr_b16 v[34:35], v20 offset:31488
    ds_read_b64_tr_b16 v[36:37], v20 offset:33792
    ds_read_b64_tr_b16 v[38:39], v20 offset:34560
    s_add_u32 m0, s50, 0
    s_nop 0
    buffer_load_dwordx4 v8, s[4:7], s53 offen offset:0 lds
    buffer_load_dwordx4 v9, s[4:7], s53 offen offset:1024 lds
    buffer_load_dwordx4 v10, s[4:7], s53 offen offset:2048 lds
    buffer_load_dwordx4 v11, s[4:7], s53 offen offset:3072 lds
    s_add_u32 m0, s51, 81920
    s_add_u32 s53, s53, 128
    buffer_load_dwordx4 v12, s[8:11], s54 offen offset:0 lds
    buffer_load_dwordx4 v13, s[8:11], s54 offen offset:1024 lds
    buffer_load_dwordx4 v14, s[8:11], s54 offen offset:2048 lds
    s_add_u32 s54, s54, 172032
    s_cmp_eq_u32 s53, 896
    s_cselect_b32 s53, 0, s53
    s_cselect_b32 s54, 0, s54
    s_waitcnt lgkmcnt(6)
    v_mfma_f32_16x16x32_bf16 v[40:43], v[56:59], v[24:27], v[40:43]
    s_waitcnt lgkmcnt(4)
    v_mfma_f32_16x16x32_bf16 v[40:43], v[56:59], v[28:31], v[40:43]
    s_waitcnt lgkmcnt(2)
    v_mfma_f32_16x16x32_bf16 v[40:43], v[56:59], v[32:35], v[40:43]
    s_waitcnt lgkmcnt(0)
    v_mfma_f32_16x16x32_bf16 v[40:43], v[56:59], v[36:39], v[40:43]
    s_waitcnt vmcnt(7)
    v_mov_b32 v4, 5
    ds_write_b32 v16, v4
    v_add_u32 v18, 1, v18
Lbp_4:
    ds_read_b32 v4, v17
    s_waitcnt lgkmcnt(0)
    v_cmp_gt_i32 vcc, v18, v4
    s_nop 4
    s_cbranch_vccnz Lbp_4
    ds_read_b64_tr_b16 v[24:25], v20 offset:36864
    ds_read_b64_tr_b16 v[26:27], v20 offset:37632
    ds_read_b64_tr_b16 v[28:29], v20 offset:39936
    ds_read_b64_tr_b16 v[30:31], v20 offset:40704
    ds_read_b64_tr_b16 v[32:33], v20 offset:43008
    ds_read_b64_tr_b16 v[34:35], v20 offset:43776
    ds_read_b64_tr_b16 v[36:37], v20 offset:46080
    ds_read_b64_tr_b16 v[38:39], v20 offset:46848
    s_add_u32 m0, s50, 16384
    s_nop 0
    buffer_load_dwordx4 v8, s[4:7], s53 offen offset:0 lds
    buffer_load_dwordx4 v9, s[4:7], s53 offen offset:1024 lds
    buffer_load_dwordx4 v10, s[4:7], s53 offen offset:2048 lds
    buffer_load_dwordx4 v11, s[4:7], s53 offen offset:3072 lds
    s_add_u32 m0, s51, 94208
    s_add_u32 s53, s53, 128
    buffer_load_dwordx4 v12, s[8:11], s54 offen offset:0 lds
    buffer_load_dwordx4 v13, s[8:11], s54 offen offset:1024 lds
    buffer_load_dwordx4 v14, s[8:11], s54 offen offset:2048 lds
    s_add_u32 s54, s54, 172032
    s_cmp_eq_u32 s53, 896
    s_cselect_b32 s53, 0, s53
    s_cselect_b32 s54, 0, s54
    s_and_b32 s47, s46, 7
    s_mul_i32 s47, s47, 24
    s_lshr_b32 s48, s46, 3
    s_add_u32 s47, s47, s48
    s_mul_i32 s47, s47, 3
    s_add_u32 s47, s47, s39
    s_sub_u32 s47, s47, 1
    s_and_b32 s56, s47, 3
    s_lshr_b32 s57, s47, 2
    s_lshl_b32 s95, s39, 12
    s_add_u32 s95, s95, 139264
    s_mov_b32 s83, 896
    s_mul_i32 s49, s56, 224
    s_cmp_ge_u32 s57, 32
    s_cbranch_scc1 Lwf_5
    s_mov_b64 s[84:85], s[12:13]
    s_mov_b64 s[86:87], s[14:15]
    s_mov_b32 s94, 0
    s_lshr_b32 s47, s57, 1
    s_mul_i32 s47, s47, 28
    s_and_b32 s48, s57, 1
    s_lshl_b32 s48, s48, 4
    s_add_u32 s47, s47, s48
    s_mul_i32 s88, s47, 896
    s_add_u32 s88, s88, s49
    s_lshl_b32 s82, s56, 5
    s_add_u32 s82, s82, s57
    s_add_u32 s82, s82, 512
    s_lshl_b32 s47, s56, 7
    s_add_u32 s47, s47, s57
    s_lshl_b32 s47, s47, 10
    s_add_u32 s90, s47, 16777216
    s_add_u32 s91, s90, 0x8000
    s_add_u32 s92, s91, 0x8000
    s_add_u32 s93, s92, 0x8000
    s_branch Lwf_6
Lwf_5:
    s_mov_b64 s[84:85], s[20:21]
    s_mov_b64 s[86:87], s[22:23]
    s_mov_b32 s94, 1
    s_sub_u32 s48, s57, 32
    s_mul_i32 s88, s48, 14336
    s_add_u32 s88, s88, s49
    s_mul_i32 s82, s56, 112
    s_add_u32 s82, s82, s48
    s_add_u32 s82, s82, 1024
    s_add_u32 s47, s49, s48
    s_mul_i32 s90, s47, 1792
    s_add_u32 s90, s90, 19922944
    s_add_u32 s91, s90, 1024
    s_add_u32 s92, s90, 200704
    s_add_u32 s93, s92, 1024
Lwf_6:
    s_lshl_b32 s82, s82, 3
    s_add_u32 s82, s82, 25182208
    s_cmp_ge_u32 s46, 192
    s_cselect_b32 s47, 0, s39
    s_cmp_eq_u32 s47, 0
    s_cselect_b32 s82, 0x7ff00000, s82
    s_cselect_b32 s88, 0x7ff00000, s88
    s_cselect_b32 s90, 0x7ff00000, s90
    s_cselect_b32 s91, 0x7ff00000, s91
    s_cselect_b32 s92, 0x7ff00000, s92
    s_cselect_b32 s93, 0x7ff00000, s93
    s_lshl_b32 s89, s83, 2
    v_lshrrev_b32 v4, 4, v0
    v_mul_lo_u32 v4, v4, s83
    v_and_b32 v5, 15, v0
    v_lshl_add_u32 v61, v5, 4, v4
    s_cmp_eq_u32 s82, 0x7ff00000
    s_cbranch_scc1 Lwd_7
    s_add_u32 m0, s95, 0
    s_nop 0
    buffer_load_dwordx4 v61, s[84:87], s88 offen nt lds
    s_add_u32 s88, s88, s89
    s_add_u32 m0, s95, 1024
    s_nop 0
    buffer_load_dwordx4 v61, s[84:87], s88 offen nt lds
    s_add_u32 s88, s88, s89
    s_add_u32 m0, s95, 2048
    s_nop 0
    buffer_load_dwordx4 v61, s[84:87], s88 offen nt lds
    s_add_u32 s88, s88, s89
    s_add_u32 m0, s95, 3072
    s_nop 0
    buffer_load_dwordx4 v61, s[84:87], s88 offen nt lds
    s_branch Lwd_8
Lwd_7:
    buffer_load_dword v128, v1, s[28:31], s82 offen
    buffer_load_dword v129, v1, s[28:31], s82 offen
    buffer_load_dword v130, v1, s[28:31], s82 offen
    buffer_load_dword v131, v1, s[28:31], s82 offen
Lwd_8:
    s_cmp_lg_u32 s38, 7
    s_cbranch_scc1 Lnq_9
    s_mov_b32 s48, 0
    v_mov_b32 v4, 0
Lnp_11:
    v_readfirstlane_b32 s40, v52
    v_readfirstlane_b32 s41, v53
    s_cmp_lg_u32 s40, 0
    s_cbranch_scc1 Lnok_10
    buffer_load_dwordx2 v[52:53], v4, s[32:35], 0 offen sc1
    s_waitcnt vmcnt(0)
    s_add_u32 s48, s48, 1
    s_cmp_lt_u32 s48, 262144
    s_cbranch_scc1 Lnp_11
Lnok_10:
    v_mov_b32 v4, 162184
    ds_write_b64 v4, v[52:53]
Lnq_9:
    s_waitcnt lgkmcnt(6)
    v_mfma_f32_16x16x32_bf16 v[40:43], v[56:59], v[24:27], v[40:43]
    s_waitcnt lgkmcnt(4)
    v_mfma_f32_16x16x32_bf16 v[40:43], v[56:59], v[28:31], v[40:43]
    s_waitcnt lgkmcnt(2)
    v_mfma_f32_16x16x32_bf16 v[40:43], v[56:59], v[32:35], v[40:43]
    s_waitcnt lgkmcnt(0)
    v_mfma_f32_16x16x32_bf16 v[40:43], v[56:59], v[36:39], v[40:43]
    s_waitcnt vmcnt(11)
    v_mov_b32 v4, 6
    ds_write_b32 v16, v4
    v_add_u32 v18, 1, v18
Lbp_12:
    ds_read_b32 v4, v17
    s_waitcnt lgkmcnt(0)
    v_cmp_gt_i32 vcc, v18, v4
    s_nop 4
    s_cbranch_vccnz Lbp_12
    ds_read_b64_tr_b16 v[24:25], v20 offset:49152
    ds_read_b64_tr_b16 v[26:27], v20 offset:49920
    ds_read_b64_tr_b16 v[28:29], v20 offset:52224
    ds_read_b64_tr_b16 v[30:31], v20 offset:52992
    ds_read_b64_tr_b16 v[32:33], v20 offset:55296
    ds_read_b64_tr_b16 v[34:35], v20 offset:56064
    ds_read_b64_tr_b16 v[36:37], v20 offset:58368
    ds_read_b64_tr_b16 v[38:39], v20 offset:59136
    s_mul_i32 s47, s62, 7
    s_lshr_b32 s47, s47, 1
    s_lshl_b32 s47, s47, 3
    s_mul_i32 s48, s62, 28
    s_add_u32 s48, s48, 448
    v_mov_b32 v4, s47
    v_mov_b32 v5, s48
    v_cndmask_b32 v4, v4, v5, s[42:43]
    v_bfe_u32 v5, v0, 4, 1
    v_mul_u32_u24 v6, 4, v3
    v_sub_u32 v6, 31, v6
    v_mad_u32_u24 v4, v5, v6, v4
    v_add_u32 v4, 448, v4
    v_mul_u32_u24 v4, 0x2ab, v4
    v_lshrrev_b32 v4, 16, v4
    v_and_b32 v6, 15, v0
    v_lshl_add_u32 v4, v4, 4, v6
    v_lshlrev_b32 v200, 3, v4
    v_mul_u32_u24 v4, 31, v5
    v_add_u32 v4, s47, v4
    v_mul_u32_u24 v4, 0x2ab, v4
    v_lshrrev_b32 v4, 16, v4
    v_lshl_add_u32 v4, v4, 4, s63
    v_lshlrev_b32 v201, 3, v4
    s_waitcnt lgkmcnt(6)
    v_mfma_f32_16x16x32_bf16 v[40:43], v[56:59], v[24:27], v[40:43]
    s_waitcnt lgkmcnt(4)
    v_mfma_f32_16x16x32_bf16 v[40:43], v[56:59], v[28:31], v[40:43]
    s_waitcnt lgkmcnt(2)
    v_mfma_f32_16x16x32_bf16 v[40:43], v[56:59], v[32:35], v[40:43]
    s_waitcnt lgkmcnt(0)
    v_mfma_f32_16x16x32_bf16 v[40:43], v[56:59], v[36:39], v[40:43]
    s_waitcnt vmcnt(4)
    v_mov_b32 v4, 7
    ds_write_b32 v16, v4
    v_add_u32 v18, 1, v18
Lbp_13:
    ds_read_b32 v4, v17
    s_waitcnt lgkmcnt(0)
    v_cmp_gt_i32 vcc, v18, v4
    s_nop 4
    s_cbranch_vccnz Lbp_13
    ds_read_b64_tr_b16 v[24:25], v20 offset:0
    ds_read_b64_tr_b16 v[26:27], v20 offset:768
    ds_read_b64_tr_b16 v[28:29], v20 offset:3072
    ds_read_b64_tr_b16 v[30:31], v20 offset:3840
    ds_read_b64_tr_b16 v[32:33], v20 offset:6144
    ds_read_b64_tr_b16 v[34:35], v20 offset:6912
    ds_read_b64_tr_b16 v[36:37], v20 offset:9216
    ds_read_b64_tr_b16 v[38:39], v20 offset:9984
    s_mov_b32 s49, s55
    s_lshl_b32 s47, s49, 3
    s_add_u32 s47, s47, 25165824
    s_cmp_eq_u32 s38, 7
    s_cselect_b32 s47, s47, 0x7ff00000
    v_mov_b32 v4, s40
    v_mov_b32 v5, s41
    v_mov_b32 v6, 0
    s_mov_b64 exec, 1
    buffer_store_dwordx2 v[4:5], v6, s[28:31], s47 offen sc1
    s_mov_b64 exec, -1
    s_waitcnt lgkmcnt(6)
    v_mfma_f32_16x16x32_bf16 v[40:43], v[56:59], v[24:27], v[40:43]
    s_waitcnt lgkmcnt(4)
    v_mfma_f32_16x16x32_bf16 v[40:43], v[56:59], v[28:31], v[40:43]
    s_waitcnt lgkmcnt(2)
    v_mfma_f32_16x16x32_bf16 v[40:43], v[56:59], v[32:35], v[40:43]
    s_waitcnt lgkmcnt(0)
    v_mfma_f32_16x16x32_bf16 v[40:43], v[56:59], v[36:39], v[40:43]
    v_add_u32 v18, 1, v18
Lbp_14:
    ds_read_b32 v4, v17
    s_waitcnt lgkmcnt(0)
    v_cmp_gt_i32 vcc, v18, v4
    s_nop 4
    s_cbranch_vccnz Lbp_14
    ds_read_b64_tr_b16 v[24:25], v20 offset:12288
    ds_read_b64_tr_b16 v[26:27], v20 offset:13056
    ds_read_b64_tr_b16 v[28:29], v20 offset:15360
    ds_read_b64_tr_b16 v[30:31], v20 offset:16128
    ds_read_b64_tr_b16 v[32:33], v20 offset:18432
    ds_read_b64_tr_b16 v[34:35], v20 offset:19200
    ds_read_b64_tr_b16 v[36:37], v20 offset:21504
    ds_read_b64_tr_b16 v[38:39], v20 offset:22272
    s_waitcnt lgkmcnt(6)
    v_mfma_f32_16x16x32_bf16 v[40:43], v[56:59], v[24:27], v[40:43]
    s_waitcnt lgkmcnt(4)
    v_mfma_f32_16x16x32_bf16 v[40:43], v[56:59], v[28:31], v[40:43]
    s_waitcnt lgkmcnt(2)
    v_mfma_f32_16x16x32_bf16 v[40:43], v[56:59], v[32:35], v[40:43]
    s_waitcnt lgkmcnt(0)
    v_mfma_f32_16x16x32_bf16 v[40:43], v[56:59], v[36:39], v[40:43]
    s_lshl_b32 s47, s39, 7
    s_add_u32 s47, s47, 161792
    v_lshl_add_u32 v4, v0, 2, s47
    s_cmp_eq_u32 s39, 3
    s_cselect_b32 exec_lo, 0, 0xffff
    s_mov_b32 exec_hi, 0
    s_nop 1
    ds_write2_b32 v4, v40, v41 offset0:0 offset1:16
    s_mov_b64 exec, -1
    s_mov_b32 s47, 25165824
    s_cmp_eq_u32 s38, 4
    s_cselect_b32 s47, s47, 0x7ff00000
    buffer_load_dwordx2 v[192:193], v200, s[28:31], s47 offen sc1
    buffer_load_dwordx2 v[194:195], v201, s[28:31], s47 offen sc1
    s_waitcnt lgkmcnt(0)
    s_barrier
    s_mov_b32 s55, s82
    s_mov_b32 s53, s90
    s_cmp_eq_u32 s55, 0x7ff00000
    s_cbranch_scc1 LJB
    s_waitcnt vmcnt(3)
    v_bfe_u32 v61, v0, 2, 2
    v_lshl_add_u32 v61, v3, 2, v61
    v_lshlrev_b32 v61, 8, v61
    v_bfe_u32 v60, v0, 4, 1
    v_lshl_add_u32 v61, v60, 5, v61
    v_and_b32 v60, 3, v0
    v_lshl_add_u32 v61, v60, 3, v61
    v_add_u32 v61, s95, v61
    s_lshl_b32 s47, s94, 4
    v_subrev_u32 v60, s47, v61
    ds_read_b64_tr_b16 v[128:129], v61 offset:0
    ds_read_b64_tr_b16 v[130:131], v61 offset:2048
    ds_read_b64_tr_b16 v[132:133], v61 offset:64
    ds_read_b64_tr_b16 v[134:135], v61 offset:2112
    ds_read_b64_tr_b16 v[136:137], v60 offset:128
    ds_read_b64_tr_b16 v[138:139], v60 offset:2176
    ds_read_b64_tr_b16 v[140:141], v60 offset:192
    ds_read_b64_tr_b16 v[142:143], v60 offset:2240
LJB:
    s_mul_i32 s47, s62, 7
    s_lshr_b32 s47, s47, 1
    s_lshl_b32 s47, s47, 9
    s_add_u32 s47, s47, 28672
    v_add_u32 v36, s47, v1
    s_mul_i32 s47, s62, 448
    s_add_u32 s47, s47, 55296
    v_mul_u32_u24 v4, 0x1c00, v3
    v_lshl_add_u32 v4, v2, 4, v4
    v_add_u32 v37, s47, v4
    v_add_u32 v38, 0x3400, v37
    s_lshl_b32 s59, s39, 12
    s_mul_i32 s57, s39, 86016
    v_add_u32 v30, s59, v1
    v_lshlrev_b32 v39, 2, v0
    v_add_u32 v39, 155648, v39
    v_mov_b32 v31, 1
    v_mov_b32 v4, 162184
    ds_read_b64 v[52:53], v4
    s_waitcnt lgkmcnt(0)
    v_readfirstlane_b32 s40, v52
    v_readfirstlane_b32 s41, v53
    s_cmp_lg_u32 s38, 4
    s_cbranch_scc1 Lkv_15
    s_waitcnt vmcnt(0)
    s_mov_b32 s48, 0
Lkp_16:
    v_cmp_ne_u64 vcc, s[40:41], v[192:193]
    v_cmp_ne_u64 s[50:51], s[40:41], v[194:195]
    s_nop 0
    s_or_b64 vcc, vcc, s[50:51]
    s_nop 1
    s_cbranch_vccz Lkd_17
    s_sleep 2
    s_mov_b32 s47, 25165824
    buffer_load_dwordx2 v[192:193], v200, s[28:31], s47 offen sc1
    buffer_load_dwordx2 v[194:195], v201, s[28:31], s47 offen sc1
    s_waitcnt vmcnt(0)
    s_add_u32 s48, s48, 1
    s_cmp_lt_u32 s48, 262144
    s_cbranch_scc1 Lkp_16
Lkd_17:
    v_mov_b32 v4, 16
    ds_add_u32 v39, v4 offset:2048
Lkv_15:
    v_mov_b32 v4, 0x3f803f80
    v_cmp_eq_u32 vcc, 28, v2
    s_nop 1
    v_cndmask_b32 v4, 0, v4, vcc
    v_mov_b32 v5, v4
    v_mov_b32 v6, v4
    v_mov_b32 v7, v4
    s_mov_b64 exec, s[44:45]
    ds_write_b128 v30, v[4:7] offset:2048
    ds_write_b128 v30, v[4:7] offset:3072
    ds_write_b128 v30, v[4:7] offset:18432
    ds_write_b128 v30, v[4:7] offset:19456
    ds_write_b128 v30, v[4:7] offset:34816
    ds_write_b128 v30, v[4:7] offset:35840
    ds_write_b128 v30, v[4:7] offset:51200
    ds_write_b128 v30, v[4:7] offset:52224
    s_mov_b64 exec, -1
    s_and_b32 s52, s37, 3
    s_lshl_b32 s52, s52, 2
    s_add_u32 s52, s52, s39
    s_lshl_b32 s52, s52, 15
    s_add_u32 s52, s52, 16777216
    s_and_b32 s51, s37, 7
    s_mul_i32 s51, s51, 7
    s_add_u32 s58, s51, s39
    s_mul_i32 s58, s58, 28672
    s_add_u32 s58, s58, 17825792
    s_add_u32 s82, s58, 0
    s_mul_i32 s83, s51, 28672
    s_mul_i32 s84, s39, 7168
    s_add_u32 s83, s83, s84
    s_add_u32 s83, s83, 17940480
    s_add_u32 s84, s84, 69632
    s_and_b32 s47, s37, 7
    s_mul_i32 s48, s47, 7
    s_lshr_b32 s48, s48, 2
    s_min_u32 s48, s48, 11
    s_mul_i32 s48, s48, 224
    v_min_u32 v4, 41, v0
    v_lshl_add_u32 v48, v4, 4, s48
    s_lshr_b32 s47, s47, 1
    s_mul_i32 s47, s47, 896
    s_add_u32 s47, s47, 8192
    v_min_u32 v4, 55, v0
    v_lshl_add_u32 v50, v4, 4, s47
    s_and_b32 s47, s37, 3
    s_lshl_b32 s47, s47, 8
    s_add_u32 s47, s47, 4096
    v_and_b32 v4, 15, v0
    v_lshl_add_u32 v49, v4, 4, s47
    v_mov_b32 v16, -1
    v_mov_b32 v17, -1
    v_mov_b32 v18, -1
    v_mov_b32 v19, -1
    s_lshl_b32 s47, s63, 2
    s_add_u32 s47, s47, s39
    s_lshl_b32 s47, s47, 4
    s_add_u32 s89, s47, s62
    s_lshl_b32 s47, s89, 11
    s_add_u32 s85, s47, 29360128
    s_lshl_b32 s48, s36, 4
    s_add_u32 s48, s48, s37
    s_lshl_b32 s90, s48, 2
    s_add_u32 s90, s90, s39
    s_mul_i32 s47, s48, 7
    s_lshl_b32 s49, s39, 1
    s_add_u32 s47, s47, s49
    s_lshl_b32 s47, s47, 10
    s_add_u32 s86, s47, 6291456
    s_add_u32 s47, s86, 1024
    s_lshl_b32 s48, s48, 10
    s_add_u32 s48, s48, 22020096
    s_cmp_eq_u32 s39, 3
    s_cselect_b32 s87, s48, s47
    s_lshl_b32 s47, s36, 2
    s_lshr_b32 s48, s37, 3
    s_lshl_b32 s48, s48, 1
    s_add_u32 s47, s47, s48
    s_lshr_b32 s48, s39, 1
    s_add_u32 s47, s47, s48
    s_mul_i32 s47, s47, 112
    s_and_b32 s48, s37, 7
    s_lshl_b32 s48, s48, 1
    s_and_b32 s49, s39, 1
    s_add_u32 s48, s48, s49
    s_mul_i32 s48, s48, 7
    s_add_u32 s47, s47, s48
    s_lshl_b32 s47, s47, 10
    s_add_u32 s95, s47, 8388608
    s_add_u32 s88, s95, 4096
    s_lshl_b32 s49, s36, 2
    s_lshr_b32 s47, s37, 2
    s_add_u32 s49, s49, s47
    s_lshl_b32 s49, s49, 4
    v_and_b32 v4, 15, v0
    v_add_lshl_u32 v25, v4, s49, 3
    s_lshl_b32 s49, s36, 4
    s_and_b32 s47, s37, 8
    s_add_u32 s49, s49, s47
    s_lshl_b32 s49, s49, 2
    v_add_lshl_u32 v26, v2, s49, 3
    s_setprio 2
Lpw_18:
    ds_read_b32 v4, v39 offset:2048
    s_waitcnt lgkmcnt(0)
    v_cmp_gt_u32 vcc, 20, v4
    s_sleep 1
    s_nop 3
    s_cbranch_vccnz Lpw_18
    s_add_u32 s47, s63, 0
    s_and_b32 s47, s47, 15
    s_mul_i32 s47, s47, 344064
    s_add_u32 s47, s47, s57
    s_add_u32 m0, s59, 0
    s_nop 0
    buffer_load_dwordx4 v36, s[28:31], s47 offen offset:0 sc1 lds
    buffer_load_dwordx4 v36, s[28:31], s47 offen offset:1024 sc1 lds
    s_not_b64 exec, s[44:45]
    buffer_load_dwordx4 v37, s[28:31], s47 offen offset:2048 sc1 lds
    buffer_load_dwordx4 v38, s[28:31], s47 offen offset:3072 sc1 lds
    s_mov_b64 exec, -1
    s_add_u32 s47, s63, 1
    s_and_b32 s47, s47, 15
    s_mul_i32 s47, s47, 344064
    s_add_u32 s47, s47, s57
    s_add_u32 m0, s59, 16384
    s_nop 0
    buffer_load_dwordx4 v36, s[28:31], s47 offen offset:0 sc1 lds
    buffer_load_dwordx4 v36, s[28:31], s47 offen offset:1024 sc1 lds
    s_not_b64 exec, s[44:45]
    buffer_load_dwordx4 v37, s[28:31], s47 offen offset:2048 sc1 lds
    buffer_load_dwordx4 v38, s[28:31], s47 offen offset:3072 sc1 lds
    s_mov_b64 exec, -1
    s_waitcnt vmcnt(4)
    s_mov_b32 s48, 0
Lvr_19:
    ds_read_b64 v[8:9], v30 offset:0
    ds_read_b64 v[10:11], v30 offset:1024
    ds_read_b64 v[12:13], v30 offset:2048
    ds_read_b64 v[14:15], v30 offset:3072
    s_waitcnt lgkmcnt(0)
    v_max3_u32 v8, v8, v10, v12
    v_max_u32 v8, v8, v14
    v_cmp_eq_u32 vcc, -1, v8
    s_nop 4
    s_cbranch_vccz Lvk_20
    s_sleep 4
    s_add_u32 s47, s63, 0
    s_and_b32 s47, s47, 15
    s_mul_i32 s47, s47, 344064
    s_add_u32 s47, s47, s57
    s_add_u32 m0, s59, 0
    s_nop 0
    buffer_load_dwordx4 v36, s[28:31], s47 offen offset:0 sc1 lds
    buffer_load_dwordx4 v36, s[28:31], s47 offen offset:1024 sc1 lds
    s_not_b64 exec, s[44:45]
    buffer_load_dwordx4 v37, s[28:31], s47 offen offset:2048 sc1 lds
    buffer_load_dwordx4 v38, s[28:31], s47 offen offset:3072 sc1 lds
    s_mov_b64 exec, -1
    s_add_u32 s47, s63, 1
    s_and_b32 s47, s47, 15
    s_mul_i32 s47, s47, 344064
    s_add_u32 s47, s47, s57
    s_add_u32 m0, s59, 16384
    s_nop 0
    buffer_load_dwordx4 v36, s[28:31], s47 offen offset:0 sc1 lds
    buffer_load_dwordx4 v36, s[28:31], s47 offen offset:1024 sc1 lds
    s_not_b64 exec, s[44:45]
    buffer_load_dwordx4 v37, s[28:31], s47 offen offset:2048 sc1 lds
    buffer_load_dwordx4 v38, s[28:31], s47 offen offset:3072 sc1 lds
    s_mov_b64 exec, -1
    s_waitcnt vmcnt(0)
    s_add_u32 s48, s48, 1
    s_cmp_lt_u32 s48, 262144
    s_cbranch_scc1 Lvr_19
Lvk_20:
    ds_add_u32 v39, v31 offset:0
    s_add_u32 s47, s63, 2
    s_and_b32 s47, s47, 15
    s_mul_i32 s47, s47, 344064
    s_add_u32 s47, s47, s57
    s_add_u32 m0, s59, 32768
    s_nop 0
    buffer_load_dwordx4 v36, s[28:31], s47 offen offset:0 sc1 lds
    buffer_load_dwordx4 v36, s[28:31], s47 offen offset:1024 sc1 lds
    s_not_b64 exec, s[44:45]
    buffer_load_dwordx4 v37, s[28:31], s47 offen offset:2048 sc1 lds
    buffer_load_dwordx4 v38, s[28:31], s47 offen offset:3072 sc1 lds
    s_mov_b64 exec, -1
    s_add_u32 s47, s63, 3
    s_and_b32 s47, s47, 15
    s_mul_i32 s47, s47, 344064
    s_add_u32 s47, s47, s57
    s_add_u32 m0, s59, 49152
    s_nop 0
    buffer_load_dwordx4 v36, s[28:31], s47 offen offset:0 sc1 lds
    buffer_load_dwordx4 v36, s[28:31], s47 offen offset:1024 sc1 lds
    s_not_b64 exec, s[44:45]
    buffer_load_dwordx4 v37, s[28:31], s47 offen offset:2048 sc1 lds
    buffer_load_dwordx4 v38, s[28:31], s47 offen offset:3072 sc1 lds
    s_mov_b64 exec, -1
    s_mov_b32 s47, 25182208
    s_cmp_eq_u32 s38, 5
    s_cselect_b32 s47, s47, 0x7ff00000
    buffer_load_dwordx4 v[40:43], v48, s[28:31], s47 offen sc1
    v_mul_u32_u24 v5, 24, v3
    v_add_u32 v5, v5, v2
    v_lshlrev_b32 v5, 4, v5
    s_cmp_eq_u32 s94, 1
    s_cselect_b64 vcc, -1, 0
    s_cselect_b32 s48, 0x00ffffff, -1
    s_mov_b32 s49, s48
    v_cndmask_b32 v5, v1, v5, vcc
    s_waitcnt lgkmcnt(0)
    buffer_store_dwordx4 v[128:131], v1, s[28:31], s53 offen sc1
    s_mov_b64 exec, s[48:49]
    buffer_store_dwordx4 v[132:135], v5, s[28:31], s91 offen sc1
    s_mov_b64 exec, -1
    buffer_store_dwordx4 v[136:139], v1, s[28:31], s92 offen sc1
    s_mov_b64 exec, s[48:49]
    buffer_store_dwordx4 v[140:143], v5, s[28:31], s93 offen sc1
    s_mov_b64 exec, -1
    s_waitcnt vmcnt(13)
    s_mov_b32 s48, 0
Lvr_21:
    ds_read_b64 v[8:9], v30 offset:16384
    ds_read_b64 v[10:11], v30 offset:17408
    ds_read_b64 v[12:13], v30 offset:18432
    ds_read_b64 v[14:15], v30 offset:19456
    s_waitcnt lgkmcnt(0)
    v_max3_u32 v8, v8, v10, v12
    v_max_u32 v8, v8, v14
    v_cmp_eq_u32 vcc, -1, v8
    s_nop 4
    s_cbranch_vccz Lvk_22
    s_sleep 4
    s_add_u32 s47, s63, 1
    s_and_b32 s47, s47, 15
    s_mul_i32 s47, s47, 344064
    s_add_u32 s47, s47, s57
    s_add_u32 m0, s59, 16384
    s_nop 0
    buffer_load_dwordx4 v36, s[28:31], s47 offen offset:0 sc1 lds
    buffer_load_dwordx4 v36, s[28:31], s47 offen offset:1024 sc1 lds
    s_not_b64 exec, s[44:45]
    buffer_load_dwordx4 v37, s[28:31], s47 offen offset:2048 sc1 lds
    buffer_load_dwordx4 v38, s[28:31], s47 offen offset:3072 sc1 lds
    s_mov_b64 exec, -1
    s_waitcnt vmcnt(0)
    s_add_u32 s48, s48, 1
    s_cmp_lt_u32 s48, 262144
    s_cbranch_scc1 Lvr_21
Lvk_22:
    ds_add_u32 v39, v31 offset:256
    s_waitcnt vmcnt(9)
    s_mov_b32 s48, 0
Lvr_23:
    ds_read_b64 v[8:9], v30 offset:32768
    ds_read_b64 v[10:11], v30 offset:33792
    ds_read_b64 v[12:13], v30 offset:34816
    ds_read_b64 v[14:15], v30 offset:35840
    s_waitcnt lgkmcnt(0)
    v_max3_u32 v8, v8, v10, v12
    v_max_u32 v8, v8, v14
    v_cmp_eq_u32 vcc, -1, v8
    s_nop 4
    s_cbranch_vccz Lvk_24
    s_sleep 4
    s_add_u32 s47, s63, 2
    s_and_b32 s47, s47, 15
    s_mul_i32 s47, s47, 344064
    s_add_u32 s47, s47, s57
    s_add_u32 m0, s59, 32768
    s_nop 0
    buffer_load_dwordx4 v36, s[28:31], s47 offen offset:0 sc1 lds
    buffer_load_dwordx4 v36, s[28:31], s47 offen offset:1024 sc1 lds
    s_not_b64 exec, s[44:45]
    buffer_load_dwordx4 v37, s[28:31], s47 offen offset:2048 sc1 lds
    buffer_load_dwordx4 v38, s[28:31], s47 offen offset:3072 sc1 lds
    s_mov_b64 exec, -1
    s_waitcnt vmcnt(0)
    s_add_u32 s48, s48, 1
    s_cmp_lt_u32 s48, 262144
    s_cbranch_scc1 Lvr_23
Lvk_24:
    ds_add_u32 v39, v31 offset:512
Lcw_25:
    ds_read_b32 v4, v39 offset:1024
    s_waitcnt lgkmcnt(0)
    v_cmp_gt_u32 vcc, 4, v4
    s_sleep 1
    s_nop 3
    s_cbranch_vccnz Lcw_25
    s_add_u32 s47, s63, 4
    s_and_b32 s47, s47, 15
    s_mul_i32 s47, s47, 344064
    s_add_u32 s47, s47, s57
    s_add_u32 m0, s59, 0
    s_nop 0
    buffer_load_dwordx4 v36, s[28:31], s47 offen offset:0 lds
    buffer_load_dwordx4 v36, s[28:31], s47 offen offset:1024 lds
    s_not_b64 exec, s[44:45]
    buffer_load_dwordx4 v37, s[28:31], s47 offen offset:2048 lds
    buffer_load_dwordx4 v38, s[28:31], s47 offen offset:3072 lds
    s_mov_b64 exec, -1
    s_waitcnt vmcnt(9)
    s_mov_b32 s48, 0
Lvr_26:
    ds_read_b64 v[8:9], v30 offset:49152
    ds_read_b64 v[10:11], v30 offset:50176
    ds_read_b64 v[12:13], v30 offset:51200
    ds_read_b64 v[14:15], v30 offset:52224
    s_waitcnt lgkmcnt(0)
    v_max3_u32 v8, v8, v10, v12
    v_max_u32 v8, v8, v14
    v_cmp_eq_u32 vcc, -1, v8
    s_nop 4
    s_cbranch_vccz Lvk_27
    s_add_u32 s47, s63, 3
    s_and_b32 s47, s47, 15
    s_mul_i32 s47, s47, 344064
    s_add_u32 s47, s47, s57
    s_add_u32 m0, s59, 49152
    s_nop 0
    buffer_load_dwordx4 v36, s[28:31], s47 offen offset:0 sc1 lds
    buffer_load_dwordx4 v36, s[28:31], s47 offen offset:1024 sc1 lds
    s_not_b64 exec, s[44:45]
    buffer_load_dwordx4 v37, s[28:31], s47 offen offset:2048 sc1 lds
    buffer_load_dwordx4 v38, s[28:31], s47 offen offset:3072 sc1 lds
    s_mov_b64 exec, -1
    s_waitcnt vmcnt(0)
    s_add_u32 s48, s48, 1
    s_cmp_lt_u32 s48, 262144
    s_cbranch_scc1 Lvr_26
Lvk_27:
    ds_add_u32 v39, v31 offset:768
    buffer_store_dwordx4 v[16:19], v1, s[28:31], s85 offen offset:0 sc1
    buffer_store_dwordx4 v[16:19], v1, s[28:31], s85 offen offset:1024 sc1
    s_waitcnt vmcnt(10)
    s_cmp_lg_u32 s38, 5
    s_cbranch_scc1 Lfw_28
    s_mov_b32 s48, 0
Lkp_29:
    v_cmp_ne_u64 vcc, s[40:41], v[40:41]
    v_cmp_ne_u64 s[50:51], s[40:41], v[42:43]
    s_nop 0
    s_or_b64 vcc, vcc, s[50:51]
    s_nop 1
    s_cbranch_vccz Lkd_30
    s_sleep 2
    s_mov_b32 s47, 25182208
    buffer_load_dwordx4 v[40:43], v48, s[28:31], s47 offen sc1
    s_waitcnt vmcnt(0)
    s_add_u32 s48, s48, 1
    s_cmp_lt_u32 s48, 262144
    s_cbranch_scc1 Lkp_29
Lkd_30:
    v_mov_b32 v4, 32
    ds_add_u32 v39, v4 offset:2048
Lfw_28:
Lpw_31:
    ds_read_b32 v4, v39 offset:2048
    s_waitcnt lgkmcnt(0)
    v_cmp_gt_u32 vcc, 52, v4
    s_sleep 1
    s_nop 3
    s_cbranch_vccnz Lpw_31
    s_add_u32 s47, s83, 0
    s_add_u32 m0, s84, 0
    s_nop 0
    buffer_load_dwordx4 v1, s[28:31], s47 offen offset:0 lds
    s_add_u32 s47, s83, 0
    s_add_u32 m0, s84, 0
    s_nop 0
    buffer_load_dwordx4 v1, s[28:31], s47 offen offset:1024 lds
    s_add_u32 s47, s83, 0
    s_add_u32 m0, s84, 0
    s_nop 0
    buffer_load_dwordx4 v1, s[28:31], s47 offen offset:2048 lds
    s_add_u32 s47, s83, 0
    s_add_u32 m0, s84, 0
    s_nop 0
    buffer_load_dwordx4 v1, s[28:31], s47 offen offset:3072 lds
    s_add_u32 s47, s83, 4096
    s_add_u32 m0, s84, 4096
    s_nop 0
    buffer_load_dwordx4 v1, s[28:31], s47 offen offset:0 lds
    s_add_u32 s47, s83, 4096
    s_add_u32 m0, s84, 4096
    s_nop 0
    buffer_load_dwordx4 v1, s[28:31], s47 offen offset:1024 lds
    s_add_u32 s47, s83, 4096
    s_add_u32 m0, s84, 4096
    s_nop 0
    buffer_load_dwordx4 v1, s[28:31], s47 offen offset:2048 lds
Lcw_32:
    ds_read_b32 v4, v39 offset:1280
    s_waitcnt lgkmcnt(0)
    v_cmp_gt_u32 vcc, 4, v4
    s_sleep 1
    s_nop 3
    s_cbranch_vccnz Lcw_32
    s_add_u32 s47, s63, 5
    s_and_b32 s47, s47, 15
    s_mul_i32 s47, s47, 344064
    s_add_u32 s47, s47, s57
    s_add_u32 m0, s59, 16384
    s_nop 0
    buffer_load_dwordx4 v36, s[28:31], s47 offen offset:0 lds
    buffer_load_dwordx4 v36, s[28:31], s47 offen offset:1024 lds
    s_not_b64 exec, s[44:45]
    buffer_load_dwordx4 v37, s[28:31], s47 offen offset:2048 lds
    buffer_load_dwordx4 v38, s[28:31], s47 offen offset:3072 lds
    s_mov_b64 exec, -1
    s_waitcnt vmcnt(13)
    s_mov_b32 s48, 0
Lvr_33:
    ds_read_b64 v[8:9], v30 offset:0
    ds_read_b64 v[10:11], v30 offset:1024
    ds_read_b64 v[12:13], v30 offset:2048
    ds_read_b64 v[14:15], v30 offset:3072
    s_waitcnt lgkmcnt(0)
    v_max3_u32 v8, v8, v10, v12
    v_max_u32 v8, v8, v14
    v_cmp_eq_u32 vcc, -1, v8
    s_nop 4
    s_cbranch_vccz Lvk_34
    s_add_u32 s47, s63, 4
    s_and_b32 s47, s47, 15
    s_mul_i32 s47, s47, 344064
    s_add_u32 s47, s47, s57
    s_add_u32 m0, s59, 0
    s_nop 0
    buffer_load_dwordx4 v36, s[28:31], s47 offen offset:0 sc1 lds
    buffer_load_dwordx4 v36, s[28:31], s47 offen offset:1024 sc1 lds
    s_not_b64 exec, s[44:45]
    buffer_load_dwordx4 v37, s[28:31], s47 offen offset:2048 sc1 lds
    buffer_load_dwordx4 v38, s[28:31], s47 offen offset:3072 sc1 lds
    s_mov_b64 exec, -1
    s_waitcnt vmcnt(0)
    s_add_u32 s48, s48, 1
    s_cmp_lt_u32 s48, 262144
    s_cbranch_scc1 Lvr_33
Lvk_34:
    ds_add_u32 v39, v31 offset:0
    v_mov_b32 v4, s40
    v_mov_b32 v5, s41
    v_mov_b32 v6, 0
    s_mov_b64 exec, 1
    buffer_store_dwordx2 v[4:5], v6, s[28:31], s55 offen sc1
    s_mov_b64 exec, -1
    buffer_store_dwordx4 v[16:19], v1, s[28:31], s86 offen offset:0 sc1
    buffer_store_dwordx4 v[16:19], v1, s[28:31], s87 offen offset:0 sc1
    s_add_u32 s47, s83, 28672
    s_add_u32 m0, s84, 28672
    s_nop 0
    buffer_load_dwordx4 v1, s[28:31], s47 offen offset:0 lds
    s_add_u32 s47, s83, 28672
    s_add_u32 m0, s84, 28672
    s_nop 0
    buffer_load_dwordx4 v1, s[28:31], s47 offen offset:1024 lds
    s_add_u32 s47, s83, 28672
    s_add_u32 m0, s84, 28672
    s_nop 0
    buffer_load_dwordx4 v1, s[28:31], s47 offen offset:2048 lds
    s_add_u32 s47, s83, 28672
    s_add_u32 m0, s84, 28672
    s_nop 0
    buffer_load_dwordx4 v1, s[28:31], s47 offen offset:3072 lds
    s_add_u32 s47, s83, 32768
    s_add_u32 m0, s84, 32768
    s_nop 0
    buffer_load_dwordx4 v1, s[28:31], s47 offen offset:0 lds
    s_add_u32 s47, s83, 32768
    s_add_u32 m0, s84, 32768
    s_nop 0
    buffer_load_dwordx4 v1, s[28:31], s47 offen offset:1024 lds
    s_add_u32 s47, s83, 32768
    s_add_u32 m0, s84, 32768
    s_nop 0
    buffer_load_dwordx4 v1, s[28:31], s47 offen offset:2048 lds
Lcw_35:
    ds_read_b32 v4, v39 offset:1536
    s_waitcnt lgkmcnt(0)
    v_cmp_gt_u32 vcc, 4, v4
    s_sleep 1
    s_nop 3
    s_cbranch_vccnz Lcw_35
    s_add_u32 s47, s63, 6
    s_and_b32 s47, s47, 15
    s_mul_i32 s47, s47, 344064
    s_add_u32 s47, s47, s57
    s_add_u32 m0, s59, 32768
    s_nop 0
    buffer_load_dwordx4 v36, s[28:31], s47 offen offset:0 lds
    buffer_load_dwordx4 v36, s[28:31], s47 offen offset:1024 lds
    s_not_b64 exec, s[44:45]
    buffer_load_dwordx4 v37, s[28:31], s47 offen offset:2048 lds
    buffer_load_dwordx4 v38, s[28:31], s47 offen offset:3072 lds
    s_mov_b64 exec, -1
    s_waitcnt vmcnt(14)
    s_mov_b32 s48, 0
Lvr_36:
    ds_read_b64 v[8:9], v30 offset:16384
    ds_read_b64 v[10:11], v30 offset:17408
    ds_read_b64 v[12:13], v30 offset:18432
    ds_read_b64 v[14:15], v30 offset:19456
    s_waitcnt lgkmcnt(0)
    v_max3_u32 v8, v8, v10, v12
    v_max_u32 v8, v8, v14
    v_cmp_eq_u32 vcc, -1, v8
    s_nop 4
    s_cbranch_vccz Lvk_37
    s_add_u32 s47, s63, 5
    s_and_b32 s47, s47, 15
    s_mul_i32 s47, s47, 344064
    s_add_u32 s47, s47, s57
    s_add_u32 m0, s59, 16384
    s_nop 0
    buffer_load_dwordx4 v36, s[28:31], s47 offen offset:0 sc1 lds
    buffer_load_dwordx4 v36, s[28:31], s47 offen offset:1024 sc1 lds
    s_not_b64 exec, s[44:45]
    buffer_load_dwordx4 v37, s[28:31], s47 offen offset:2048 sc1 lds
    buffer_load_dwordx4 v38, s[28:31], s47 offen offset:3072 sc1 lds
    s_mov_b64 exec, -1
    s_waitcnt vmcnt(0)
    s_add_u32 s48, s48, 1
    s_cmp_lt_u32 s48, 262144
    s_cbranch_scc1 Lvr_36
Lvk_37:
    ds_add_u32 v39, v31 offset:256
    buffer_store_dwordx4 v[16:19], v1, s[28:31], s95 offen offset:0 sc1
    buffer_store_dwordx4 v[16:19], v1, s[28:31], s95 offen offset:1024 sc1
    s_add_u32 s47, s83, 57344
    s_add_u32 m0, s84, 57344
    s_nop 0
    buffer_load_dwordx4 v1, s[28:31], s47 offen offset:0 lds
    s_add_u32 s47, s83, 57344
    s_add_u32 m0, s84, 57344
    s_nop 0
    buffer_load_dwordx4 v1, s[28:31], s47 offen offset:1024 lds
    s_add_u32 s47, s83, 57344
    s_add_u32 m0, s84, 57344
    s_nop 0
    buffer_load_dwordx4 v1, s[28:31], s47 offen offset:2048 lds
    s_add_u32 s47, s83, 57344
    s_add_u32 m0, s84, 57344
    s_nop 0
    buffer_load_dwordx4 v1, s[28:31], s47 offen offset:3072 lds
    s_add_u32 s47, s83, 61440
    s_add_u32 m0, s84, 61440
    s_nop 0
    buffer_load_dwordx4 v1, s[28:31], s47 offen offset:0 lds
    s_add_u32 s47, s83, 61440
    s_add_u32 m0, s84, 61440
    s_nop 0
    buffer_load_dwordx4 v1, s[28:31], s47 offen offset:1024 lds
    s_add_u32 s47, s83, 61440
    s_add_u32 m0, s84, 61440
    s_nop 0
    buffer_load_dwordx4 v1, s[28:31], s47 offen offset:2048 lds
Lcw_38:
    ds_read_b32 v4, v39 offset:1792
    s_waitcnt lgkmcnt(0)
    v_cmp_gt_u32 vcc, 4, v4
    s_sleep 1
    s_nop 3
    s_cbranch_vccnz Lcw_38
    s_add_u32 s47, s63, 7
    s_and_b32 s47, s47, 15
    s_mul_i32 s47, s47, 344064
    s_add_u32 s47, s47, s57
    s_add_u32 m0, s59, 49152
    s_nop 0
    buffer_load_dwordx4 v36, s[28:31], s47 offen offset:0 lds
    buffer_load_dwordx4 v36, s[28:31], s47 offen offset:1024 lds
    s_not_b64 exec, s[44:45]
    buffer_load_dwordx4 v37, s[28:31], s47 offen offset:2048 lds
    buffer_load_dwordx4 v38, s[28:31], s47 offen offset:3072 lds
    s_mov_b64 exec, -1
    s_waitcnt vmcnt(13)
    s_mov_b32 s48, 0
Lvr_39:
    ds_read_b64 v[8:9], v30 offset:32768
    ds_read_b64 v[10:11], v30 offset:33792
    ds_read_b64 v[12:13], v30 offset:34816
    ds_read_b64 v[14:15], v30 offset:35840
    s_waitcnt lgkmcnt(0)
    v_max3_u32 v8, v8, v10, v12
    v_max_u32 v8, v8, v14
    v_cmp_eq_u32 vcc, -1, v8
    s_nop 4
    s_cbranch_vccz Lvk_40
    s_add_u32 s47, s63, 6
    s_and_b32 s47, s47, 15
    s_mul_i32 s47, s47, 344064
    s_add_u32 s47, s47, s57
    s_add_u32 m0, s59, 32768
    s_nop 0
    buffer_load_dwordx4 v36, s[28:31], s47 offen offset:0 sc1 lds
    buffer_load_dwordx4 v36, s[28:31], s47 offen offset:1024 sc1 lds
    s_not_b64 exec, s[44:45]
    buffer_load_dwordx4 v37, s[28:31], s47 offen offset:2048 sc1 lds
    buffer_load_dwordx4 v38, s[28:31], s47 offen offset:3072 sc1 lds
    s_mov_b64 exec, -1
    s_waitcnt vmcnt(0)
    s_add_u32 s48, s48, 1
    s_cmp_lt_u32 s48, 262144
    s_cbranch_scc1 Lvr_39
Lvk_40:
    ds_add_u32 v39, v31 offset:512
    buffer_store_dwordx4 v[16:19], v1, s[28:31], s95 offen offset:2048 sc1
    buffer_store_dwordx4 v[16:19], v1, s[28:31], s95 offen offset:3072 sc1
    s_mov_b32 s47, 25182208
    s_cmp_eq_u32 s38, 5
    s_cselect_b32 s47, s47, 0x7ff00000
    buffer_load_dwordx4 v[40:43], v49, s[28:31], s47 offen sc1
    buffer_load_dwordx4 v[44:47], v50, s[28:31], s47 offen sc1
    buffer_load_dwordx4 v[72:75], v1, s[28:31], s82 offen offset:0
    buffer_load_dwordx4 v[76:79], v1, s[28:31], s82 offen offset:1024
    buffer_load_dwordx4 v[80:83], v1, s[28:31], s82 offen offset:2048
    buffer_load_dwordx4 v[84:87], v1, s[28:31], s82 offen offset:3072
    s_add_u32 s82, s82, 4096
    buffer_load_dwordx4 v[88:91], v1, s[28:31], s82 offen offset:0
    buffer_load_dwordx4 v[92:95], v1, s[28:31], s82 offen offset:1024
    buffer_load_dwordx4 v[96:99], v1, s[28:31], s82 offen offset:2048
Lcw_41:
    ds_read_b32 v4, v39 offset:1024
    s_waitcnt lgkmcnt(0)
    v_cmp_gt_u32 vcc, 8, v4
    s_sleep 1
    s_nop 3
    s_cbranch_vccnz Lcw_41
    s_add_u32 s47, s63, 8
    s_and_b32 s47, s47, 15
    s_mul_i32 s47, s47, 344064
    s_add_u32 s47, s47, s57
    s_add_u32 m0, s59, 0
    s_nop 0
    buffer_load_dwordx4 v36, s[28:31], s47 offen offset:0 lds
    buffer_load_dwordx4 v36, s[28:31], s47 offen offset:1024 lds
    s_not_b64 exec, s[44:45]
    buffer_load_dwordx4 v37, s[28:31], s47 offen offset:2048 lds
    buffer_load_dwordx4 v38, s[28:31], s47 offen offset:3072 lds
    s_mov_b64 exec, -1
    s_waitcnt vmcnt(15)
    s_mov_b32 s48, 0
Lvr_42:
    ds_read_b64 v[8:9], v30 offset:49152
    ds_read_b64 v[10:11], v30 offset:50176
    ds_read_b64 v[12:13], v30 offset:51200
    ds_read_b64 v[14:15], v30 offset:52224
    s_waitcnt lgkmcnt(0)
    v_max3_u32 v8, v8, v10, v12
    v_max_u32 v8, v8, v14
    v_cmp_eq_u32 vcc, -1, v8
    s_nop 4
    s_cbranch_vccz Lvk_43
    s_add_u32 s47, s63, 7
    s_and_b32 s47, s47, 15
    s_mul_i32 s47, s47, 344064
    s_add_u32 s47, s47, s57
    s_add_u32 m0, s59, 49152
    s_nop 0
    buffer_load_dwordx4 v36, s[28:31], s47 offen offset:0 sc1 lds
    buffer_load_dwordx4 v36, s[28:31], s47 offen offset:1024 sc1 lds
    s_not_b64 exec, s[44:45]
    buffer_load_dwordx4 v37, s[28:31], s47 offen offset:2048 sc1 lds
    buffer_load_dwordx4 v38, s[28:31], s47 offen offset:3072 sc1 lds
    s_mov_b64 exec, -1
    s_waitcnt vmcnt(0)
    s_add_u32 s48, s48, 1
    s_cmp_lt_u32 s48, 262144
    s_cbranch_scc1 Lvr_42
Lvk_43:
    ds_add_u32 v39, v31 offset:768
    buffer_store_dwordx4 v[16:19], v1, s[28:31], s88 offen offset:0 sc1
    buffer_store_dwordx4 v[16:19], v1, s[28:31], s88 offen offset:1024 sc1
    buffer_load_dwordx4 v[100:103], v1, s[28:31], s82 offen offset:3072
    s_add_u32 s82, s82, 4096
    buffer_load_dwordx4 v[104:107], v1, s[28:31], s82 offen offset:0
    buffer_load_dwordx4 v[108:111], v1, s[28:31], s82 offen offset:1024
    buffer_load_dwordx4 v[112:115], v1, s[28:31], s82 offen offset:2048
    buffer_load_dwordx4 v[116:119], v1, s[28:31], s82 offen offset:3072
    s_add_u32 s82, s82, 4096
    buffer_load_dwordx4 v[120:123], v1, s[28:31], s82 offen offset:0
    buffer_load_dwordx4 v[124:127], v1, s[28:31], s82 offen offset:1024
Lcw_44:
    ds_read_b32 v4, v39 offset:1280
    s_waitcnt lgkmcnt(0)
    v_cmp_gt_u32 vcc, 8, v4
    s_sleep 1
    s_nop 3
    s_cbranch_vccnz Lcw_44
    s_add_u32 s47, s63, 9
    s_and_b32 s47, s47, 15
    s_mul_i32 s47, s47, 344064
    s_add_u32 s47, s47, s57
    s_add_u32 m0, s59, 16384
    s_nop 0
    buffer_load_dwordx4 v36, s[28:31], s47 offen offset:0 lds
    buffer_load_dwordx4 v36, s[28:31], s47 offen offset:1024 lds
    s_not_b64 exec, s[44:45]
    buffer_load_dwordx4 v37, s[28:31], s47 offen offset:2048 lds
    buffer_load_dwordx4 v38, s[28:31], s47 offen offset:3072 lds
    s_mov_b64 exec, -1
    s_waitcnt vmcnt(13)
    s_mov_b32 s48, 0
Lvr_45:
    ds_read_b64 v[8:9], v30 offset:0
    ds_read_b64 v[10:11], v30 offset:1024
    ds_read_b64 v[12:13], v30 offset:2048
    ds_read_b64 v[14:15], v30 offset:3072
    s_waitcnt lgkmcnt(0)
    v_max3_u32 v8, v8, v10, v12
    v_max_u32 v8, v8, v14
    v_cmp_eq_u32 vcc, -1, v8
    s_nop 4
    s_cbranch_vccz Lvk_46
    s_add_u32 s47, s63, 8
    s_and_b32 s47, s47, 15
    s_mul_i32 s47, s47, 344064
    s_add_u32 s47, s47, s57
    s_add_u32 m0, s59, 0
    s_nop 0
    buffer_load_dwordx4 v36, s[28:31], s47 offen offset:0 sc1 lds
    buffer_load_dwordx4 v36, s[28:31], s47 offen offset:1024 sc1 lds
    s_not_b64 exec, s[44:45]
    buffer_load_dwordx4 v37, s[28:31], s47 offen offset:2048 sc1 lds
    buffer_load_dwordx4 v38, s[28:31], s47 offen offset:3072 sc1 lds
    s_mov_b64 exec, -1
    s_waitcnt vmcnt(0)
    s_add_u32 s48, s48, 1
    s_cmp_lt_u32 s48, 262144
    s_cbranch_scc1 Lvr_45
Lvk_46:
    ds_add_u32 v39, v31 offset:0
    buffer_store_dwordx4 v[16:19], v1, s[28:31], s88 offen offset:2048 sc1
    s_cmp_lg_u32 s38, 5
    s_cbranch_scc1 Lfw_47
    s_mov_b32 s48, 0
Lkp_48:
    v_cmp_ne_u64 vcc, s[40:41], v[40:41]
    v_cmp_ne_u64 s[50:51], s[40:41], v[42:43]
    s_nop 0
    s_or_b64 vcc, vcc, s[50:51]
    v_cmp_ne_u64 s[50:51], s[40:41], v[44:45]
    s_nop 0
    s_or_b64 vcc, vcc, s[50:51]
    v_cmp_ne_u64 s[50:51], s[40:41], v[46:47]
    s_nop 0
    s_or_b64 vcc, vcc, s[50:51]
    s_cbranch_vccz Lkd_49
    s_sleep 2
    s_mov_b32 s47, 25182208
    buffer_load_dwordx4 v[40:43], v49, s[28:31], s47 offen sc1
    buffer_load_dwordx4 v[44:47], v50, s[28:31], s47 offen sc1
    s_waitcnt vmcnt(0)
    s_add_u32 s48, s48, 1
    s_cmp_lt_u32 s48, 262144
    s_cbranch_scc1 Lkp_48
Lkd_49:
    v_mov_b32 v4, 64
    ds_add_u32 v39, v4 offset:2048
Lfw_47:
Lpw_50:
    ds_read_b32 v4, v39 offset:2048
    s_waitcnt lgkmcnt(0)
    v_cmp_gt_u32 vcc, 116, v4
    s_sleep 1
    s_nop 3
    s_cbranch_vccnz Lpw_50
    buffer_load_dwordx4 v[128:131], v1, s[28:31], s82 offen offset:2048
    buffer_load_dwordx4 v[132:135], v1, s[28:31], s82 offen offset:3072
    s_add_u32 s82, s82, 4096
    buffer_load_dwordx4 v[136:139], v1, s[28:31], s82 offen offset:0
    buffer_load_dwordx4 v[140:143], v1, s[28:31], s82 offen offset:1024
    buffer_load_dwordx4 v[144:147], v1, s[28:31], s82 offen offset:2048
    buffer_load_dwordx4 v[148:151], v1, s[28:31], s82 offen offset:3072
    s_add_u32 s82, s82, 4096
    buffer_load_dwordx4 v[152:155], v1, s[28:31], s82 offen offset:0
Lcw_51:
    ds_read_b32 v4, v39 offset:1536
    s_waitcnt lgkmcnt(0)
    v_cmp_gt_u32 vcc, 8, v4
    s_sleep 1
    s_nop 3
    s_cbranch_vccnz Lcw_51
    s_add_u32 s47, s63, 10
    s_and_b32 s47, s47, 15
    s_mul_i32 s47, s47, 344064
    s_add_u32 s47, s47, s57
    s_add_u32 m0, s59, 32768
    s_nop 0
    buffer_load_dwordx4 v36, s[28:31], s47 offen offset:0 lds
    buffer_load_dwordx4 v36, s[28:31], s47 offen offset:1024 lds
    s_not_b64 exec, s[44:45]
    buffer_load_dwordx4 v37, s[28:31], s47 offen offset:2048 lds
    buffer_load_dwordx4 v38, s[28:31], s47 offen offset:3072 lds
    s_mov_b64 exec, -1
    s_waitcnt vmcnt(12)
    s_mov_b32 s48, 0
Lvr_52:
    ds_read_b64 v[8:9], v30 offset:16384
    ds_read_b64 v[10:11], v30 offset:17408
    ds_read_b64 v[12:13], v30 offset:18432
    ds_read_b64 v[14:15], v30 offset:19456
    s_waitcnt lgkmcnt(0)
    v_max3_u32 v8, v8, v10, v12
    v_max_u32 v8, v8, v14
    v_cmp_eq_u32 vcc, -1, v8
    s_nop 4
    s_cbranch_vccz Lvk_53
    s_add_u32 s47, s63, 9
    s_and_b32 s47, s47, 15
    s_mul_i32 s47, s47, 344064
    s_add_u32 s47, s47, s57
    s_add_u32 m0, s59, 16384
    s_nop 0
    buffer_load_dwordx4 v36, s[28:31], s47 offen offset:0 sc1 lds
    buffer_load_dwordx4 v36, s[28:31], s47 offen offset:1024 sc1 lds
    s_not_b64 exec, s[44:45]
    buffer_load_dwordx4 v37, s[28:31], s47 offen offset:2048 sc1 lds
    buffer_load_dwordx4 v38, s[28:31], s47 offen offset:3072 sc1 lds
    s_mov_b64 exec, -1
    s_waitcnt vmcnt(0)
    s_add_u32 s48, s48, 1
    s_cmp_lt_u32 s48, 262144
    s_cbranch_scc1 Lvr_52
Lvk_53:
    ds_add_u32 v39, v31 offset:256
    s_waitcnt vmcnt(11)
    s_mov_b32 s49, s89
    s_lshl_b32 s47, s49, 3
    s_add_u32 s47, s47, 25198592
    v_mov_b32 v4, s40
    v_mov_b32 v5, s41
    v_mov_b32 v6, 0
    s_mov_b64 exec, 1
    buffer_store_dwordx2 v[4:5], v6, s[28:31], s47 offen sc1
    s_mov_b64 exec, -1
    s_getreg_b32 s48, hwreg(HW_REG_XCC_ID, 0, 4)
    s_or_b32 s48, s48, s41
    s_mov_b32 s49, s90
    s_lshl_b32 s47, s49, 3
    s_add_u32 s47, s47, 25214976
    v_mov_b32 v4, s40
    v_mov_b32 v5, s48
    v_mov_b32 v6, 0
    s_mov_b64 exec, 1
    buffer_store_dwordx2 v[4:5], v6, s[28:31], s47 offen sc1
    s_mov_b64 exec, -1
    buffer_load_dwordx4 v[156:159], v1, s[28:31], s82 offen offset:1024
    buffer_load_dwordx4 v[160:163], v1, s[28:31], s52 offen offset:0
    buffer_load_dwordx4 v[164:167], v1, s[28:31], s52 offen offset:1024
    buffer_load_dwordx4 v[168:171], v1, s[28:31], s52 offen offset:2048
    buffer_load_dwordx4 v[172:175], v1, s[28:31], s52 offen offset:3072
    s_add_u32 s52, s52, 4096
    buffer_load_dwordx4 v[176:179], v1, s[28:31], s52 offen offset:0
    buffer_load_dwordx4 v[180:183], v1, s[28:31], s52 offen offset:1024
Lcw_54:
    ds_read_b32 v4, v39 offset:1792
    s_waitcnt lgkmcnt(0)
    v_cmp_gt_u32 vcc, 8, v4
    s_sleep 1
    s_nop 3
    s_cbranch_vccnz Lcw_54
    s_add_u32 s47, s63, 11
    s_and_b32 s47, s47, 15
    s_mul_i32 s47, s47, 344064
    s_add_u32 s47, s47, s57
    s_add_u32 m0, s59, 49152
    s_nop 0
    buffer_load_dwordx4 v36, s[28:31], s47 offen offset:0 lds
    buffer_load_dwordx4 v36, s[28:31], s47 offen offset:1024 lds
    s_not_b64 exec, s[44:45]
    buffer_load_dwordx4 v37, s[28:31], s47 offen offset:2048 lds
    buffer_load_dwordx4 v38, s[28:31], s47 offen offset:3072 lds
    s_mov_b64 exec, -1
    s_waitcnt vmcnt(13)
    s_mov_b32 s48, 0
Lvr_55:
    ds_read_b64 v[8:9], v30 offset:32768
    ds_read_b64 v[10:11], v30 offset:33792
    ds_read_b64 v[12:13], v30 offset:34816
    ds_read_b64 v[14:15], v30 offset:35840
    s_waitcnt lgkmcnt(0)
    v_max3_u32 v8, v8, v10, v12
    v_max_u32 v8, v8, v14
    v_cmp_eq_u32 vcc, -1, v8
    s_nop 4
    s_cbranch_vccz Lvk_56
    s_add_u32 s47, s63, 10
    s_and_b32 s47, s47, 15
    s_mul_i32 s47, s47, 344064
    s_add_u32 s47, s47, s57
    s_add_u32 m0, s59, 32768
    s_nop 0
    buffer_load_dwordx4 v36, s[28:31], s47 offen offset:0 sc1 lds
    buffer_load_dwordx4 v36, s[28:31], s47 offen offset:1024 sc1 lds
    s_not_b64 exec, s[44:45]
    buffer_load_dwordx4 v37, s[28:31], s47 offen offset:2048 sc1 lds
    buffer_load_dwordx4 v38, s[28:31], s47 offen offset:3072 sc1 lds
    s_mov_b64 exec, -1
    s_waitcnt vmcnt(0)
    s_add_u32 s48, s48, 1
    s_cmp_lt_u32 s48, 262144
    s_cbranch_scc1 Lvr_55
Lvk_56:
    ds_add_u32 v39, v31 offset:512
    buffer_load_dwordx4 v[184:187], v1, s[28:31], s52 offen offset:2048
    buffer_load_dwordx4 v[188:191], v1, s[28:31], s52 offen offset:3072
    s_add_u32 s52, s52, 4096
    buffer_load_dwordx4 v[192:195], v1, s[28:31], s52 offen offset:0
    buffer_load_dwordx4 v[196:199], v1, s[28:31], s52 offen offset:1024
    buffer_load_dwordx4 v[200:203], v1, s[28:31], s52 offen offset:2048
    buffer_load_dwordx4 v[204:207], v1, s[28:31], s52 offen offset:3072
    s_add_u32 s52, s52, 4096
    buffer_load_dwordx4 v[208:211], v1, s[28:31], s52 offen offset:0
Lcw_57:
    ds_read_b32 v4, v39 offset:1024
    s_waitcnt lgkmcnt(0)
    v_cmp_gt_u32 vcc, 12, v4
    s_sleep 1
    s_nop 3
    s_cbranch_vccnz Lcw_57
    s_add_u32 s47, s63, 12
    s_and_b32 s47, s47, 15
    s_mul_i32 s47, s47, 344064
    s_add_u32 s47, s47, s57
    s_add_u32 m0, s59, 0
    s_nop 0
    buffer_load_dwordx4 v36, s[28:31], s47 offen offset:0 lds
    buffer_load_dwordx4 v36, s[28:31], s47 offen offset:1024 lds
    s_not_b64 exec, s[44:45]
    buffer_load_dwordx4 v37, s[28:31], s47 offen offset:2048 lds
    buffer_load_dwordx4 v38, s[28:31], s47 offen offset:3072 lds
    s_mov_b64 exec, -1
    s_waitcnt vmcnt(11)
    s_mov_b32 s48, 0
Lvr_58:
    ds_read_b64 v[8:9], v30 offset:49152
    ds_read_b64 v[10:11], v30 offset:50176
    ds_read_b64 v[12:13], v30 offset:51200
    ds_read_b64 v[14:15], v30 offset:52224
    s_waitcnt lgkmcnt(0)
    v_max3_u32 v8, v8, v10, v12
    v_max_u32 v8, v8, v14
    v_cmp_eq_u32 vcc, -1, v8
    s_nop 4
    s_cbranch_vccz Lvk_59
    s_add_u32 s47, s63, 11
    s_and_b32 s47, s47, 15
    s_mul_i32 s47, s47, 344064
    s_add_u32 s47, s47, s57
    s_add_u32 m0, s59, 49152
    s_nop 0
    buffer_load_dwordx4 v36, s[28:31], s47 offen offset:0 sc1 lds
    buffer_load_dwordx4 v36, s[28:31], s47 offen offset:1024 sc1 lds
    s_not_b64 exec, s[44:45]
    buffer_load_dwordx4 v37, s[28:31], s47 offen offset:2048 sc1 lds
    buffer_load_dwordx4 v38, s[28:31], s47 offen offset:3072 sc1 lds
    s_mov_b64 exec, -1
    s_waitcnt vmcnt(0)
    s_add_u32 s48, s48, 1
    s_cmp_lt_u32 s48, 262144
    s_cbranch_scc1 Lvr_58
Lvk_59:
    ds_add_u32 v39, v31 offset:768
    buffer_load_dwordx4 v[212:215], v1, s[28:31], s52 offen offset:1024
    buffer_load_dwordx4 v[216:219], v1, s[28:31], s52 offen offset:2048
    buffer_load_dwordx4 v[220:223], v1, s[28:31], s52 offen offset:3072
    s_add_u32 s52, s52, 4096
    buffer_load_dwordx4 v[224:227], v1, s[28:31], s52 offen offset:0
    buffer_load_dwordx4 v[228:231], v1, s[28:31], s52 offen offset:1024
    buffer_load_dwordx4 v[232:235], v1, s[28:31], s52 offen offset:2048
    buffer_load_dwordx4 v[236:239], v1, s[28:31], s52 offen offset:3072
Lcw_60:
    ds_read_b32 v4, v39 offset:1280
    s_waitcnt lgkmcnt(0)
    v_cmp_gt_u32 vcc, 12, v4
    s_sleep 1
    s_nop 3
    s_cbranch_vccnz Lcw_60
    s_add_u32 s47, s63, 13
    s_and_b32 s47, s47, 15
    s_mul_i32 s47, s47, 344064
    s_add_u32 s47, s47, s57
    s_add_u32 m0, s59, 16384
    s_nop 0
    buffer_load_dwordx4 v36, s[28:31], s47 offen offset:0 lds
    buffer_load_dwordx4 v36, s[28:31], s47 offen offset:1024 lds
    s_not_b64 exec, s[44:45]
    buffer_load_dwordx4 v37, s[28:31], s47 offen offset:2048 lds
    buffer_load_dwordx4 v38, s[28:31], s47 offen offset:3072 lds
    s_mov_b64 exec, -1
    s_waitcnt vmcnt(11)
    s_mov_b32 s48, 0
Lvr_61:
    ds_read_b64 v[8:9], v30 offset:0
    ds_read_b64 v[10:11], v30 offset:1024
    ds_read_b64 v[12:13], v30 offset:2048
    ds_read_b64 v[14:15], v30 offset:3072
    s_waitcnt lgkmcnt(0)
    v_max3_u32 v8, v8, v10, v12
    v_max_u32 v8, v8, v14
    v_cmp_eq_u32 vcc, -1, v8
    s_nop 4
    s_cbranch_vccz Lvk_62
    s_add_u32 s47, s63, 12
    s_and_b32 s47, s47, 15
    s_mul_i32 s47, s47, 344064
    s_add_u32 s47, s47, s57
    s_add_u32 m0, s59, 0
    s_nop 0
    buffer_load_dwordx4 v36, s[28:31], s47 offen offset:0 sc1 lds
    buffer_load_dwordx4 v36, s[28:31], s47 offen offset:1024 sc1 lds
    s_not_b64 exec, s[44:45]
    buffer_load_dwordx4 v37, s[28:31], s47 offen offset:2048 sc1 lds
    buffer_load_dwordx4 v38, s[28:31], s47 offen offset:3072 sc1 lds
    s_mov_b64 exec, -1
    s_waitcnt vmcnt(0)
    s_add_u32 s48, s48, 1
    s_cmp_lt_u32 s48, 262144
    s_cbranch_scc1 Lvr_61
Lvk_62:
    ds_add_u32 v39, v31 offset:0
    s_add_u32 s52, s52, 4096
    buffer_load_dwordx4 v[240:243], v1, s[28:31], s52 offen offset:0
    buffer_load_dwordx4 v[244:247], v1, s[28:31], s52 offen offset:1024
    buffer_load_dwordx4 v[248:251], v1, s[28:31], s52 offen offset:2048
    buffer_load_dwordx4 v[252:255], v1, s[28:31], s52 offen offset:3072
    s_add_u32 s52, s52, 4096
    buffer_load_dwordx4 v[40:43], v1, s[28:31], s52 offen offset:0
    buffer_load_dwordx4 v[44:47], v1, s[28:31], s52 offen offset:1024
    buffer_load_dwordx4 v[48:51], v1, s[28:31], s52 offen offset:2048
Lcw_63:
    ds_read_b32 v4, v39 offset:1536
    s_waitcnt lgkmcnt(0)
    v_cmp_gt_u32 vcc, 12, v4
    s_sleep 1
    s_nop 3
    s_cbranch_vccnz Lcw_63
    s_add_u32 s47, s63, 14
    s_and_b32 s47, s47, 15
    s_mul_i32 s47, s47, 344064
    s_add_u32 s47, s47, s57
    s_add_u32 m0, s59, 32768
    s_nop 0
    buffer_load_dwordx4 v36, s[28:31], s47 offen offset:0 lds
    buffer_load_dwordx4 v36, s[28:31], s47 offen offset:1024 lds
    s_not_b64 exec, s[44:45]
    buffer_load_dwordx4 v37, s[28:31], s47 offen offset:2048 lds
    buffer_load_dwordx4 v38, s[28:31], s47 offen offset:3072 lds
    s_mov_b64 exec, -1
    s_waitcnt vmcnt(11)
    s_mov_b32 s48, 0
Lvr_64:
    ds_read_b64 v[8:9], v30 offset:16384
    ds_read_b64 v[10:11], v30 offset:17408
    ds_read_b64 v[12:13], v30 offset:18432
    ds_read_b64 v[14:15], v30 offset:19456
    s_waitcnt lgkmcnt(0)
    v_max3_u32 v8, v8, v10, v12
    v_max_u32 v8, v8, v14
    v_cmp_eq_u32 vcc, -1, v8
    s_nop 4
    s_cbranch_vccz Lvk_65
    s_add_u32 s47, s63, 13
    s_and_b32 s47, s47, 15
    s_mul_i32 s47, s47, 344064
    s_add_u32 s47, s47, s57
    s_add_u32 m0, s59, 16384
    s_nop 0
    buffer_load_dwordx4 v36, s[28:31], s47 offen offset:0 sc1 lds
    buffer_load_dwordx4 v36, s[28:31], s47 offen offset:1024 sc1 lds
    s_not_b64 exec, s[44:45]
    buffer_load_dwordx4 v37, s[28:31], s47 offen offset:2048 sc1 lds
    buffer_load_dwordx4 v38, s[28:31], s47 offen offset:3072 sc1 lds
    s_mov_b64 exec, -1
    s_waitcnt vmcnt(0)
    s_add_u32 s48, s48, 1
    s_cmp_lt_u32 s48, 262144
    s_cbranch_scc1 Lvr_64
Lvk_65:
    ds_add_u32 v39, v31 offset:256
    s_mov_b32 s47, 25198592
    buffer_load_dwordx2 v[28:29], v25, s[28:31], s47 offen sc1
    s_mov_b32 s47, 25214976
    buffer_load_dwordx2 v[32:33], v26, s[28:31], s47 offen sc1
    buffer_load_dwordx4 v[52:55], v1, s[28:31], s52 offen offset:3072
    s_add_u32 s52, s52, 4096
    buffer_load_dwordx4 v[56:59], v1, s[28:31], s52 offen offset:0
    buffer_load_dwordx4 v[60:63], v1, s[28:31], s52 offen offset:1024
    buffer_load_dwordx4 v[64:67], v1, s[28:31], s52 offen offset:2048
    buffer_load_dwordx4 v[68:71], v1, s[28:31], s52 offen offset:3072
Lcw_66:
    ds_read_b32 v4, v39 offset:1792
    s_waitcnt lgkmcnt(0)
    v_cmp_gt_u32 vcc, 12, v4
    s_sleep 1
    s_nop 3
    s_cbranch_vccnz Lcw_66
    s_add_u32 s47, s63, 15
    s_and_b32 s47, s47, 15
    s_mul_i32 s47, s47, 344064
    s_add_u32 s47, s47, s57
    s_add_u32 m0, s59, 49152
    s_nop 0
    buffer_load_dwordx4 v36, s[28:31], s47 offen offset:0 lds
    buffer_load_dwordx4 v36, s[28:31], s47 offen offset:1024 lds
    s_not_b64 exec, s[44:45]
    buffer_load_dwordx4 v37, s[28:31], s47 offen offset:2048 lds
    buffer_load_dwordx4 v38, s[28:31], s47 offen offset:3072 lds
    s_mov_b64 exec, -1
    s_waitcnt vmcnt(11)
    s_mov_b32 s48, 0
Lvr_67:
    ds_read_b64 v[8:9], v30 offset:32768
    ds_read_b64 v[10:11], v30 offset:33792
    ds_read_b64 v[12:13], v30 offset:34816
    ds_read_b64 v[14:15], v30 offset:35840
    s_waitcnt lgkmcnt(0)
    v_max3_u32 v8, v8, v10, v12
    v_max_u32 v8, v8, v14
    v_cmp_eq_u32 vcc, -1, v8
    s_nop 4
    s_cbranch_vccz Lvk_68
    s_add_u32 s47, s63, 14
    s_and_b32 s47, s47, 15
    s_mul_i32 s47, s47, 344064
    s_add_u32 s47, s47, s57
    s_add_u32 m0, s59, 32768
    s_nop 0
    buffer_load_dwordx4 v36, s[28:31], s47 offen offset:0 sc1 lds
    buffer_load_dwordx4 v36, s[28:31], s47 offen offset:1024 sc1 lds
    s_not_b64 exec, s[44:45]
    buffer_load_dwordx4 v37, s[28:31], s47 offen offset:2048 sc1 lds
    buffer_load_dwordx4 v38, s[28:31], s47 offen offset:3072 sc1 lds
    s_mov_b64 exec, -1
    s_waitcnt vmcnt(0)
    s_add_u32 s48, s48, 1
    s_cmp_lt_u32 s48, 262144
    s_cbranch_scc1 Lvr_67
Lvk_68:
    ds_add_u32 v39, v31 offset:512
    s_lshl_b32 s50, s36, 7
    s_lshr_b32 s47, s37, 2
    s_lshl_b32 s47, s47, 5
    s_add_u32 s50, s50, s47
    s_mul_i32 s50, s50, 896
    s_and_b32 s47, s37, 3
    s_mul_i32 s47, s47, 224
    s_add_u32 s50, s50, s47
    s_lshl_b32 s47, s39, 6
    s_add_u32 s50, s50, s47
    v_mul_u32_u24 v4, 0x380, v2
    v_lshl_add_u32 v4, v3, 3, v4
    buffer_load_dwordx2 v[16:17], v4, s[4:7], s50 offen offset:0
    buffer_load_dwordx2 v[18:19], v4, s[4:7], s50 offen offset:16
    buffer_load_dwordx2 v[20:21], v4, s[4:7], s50 offen offset:32
    buffer_load_dwordx2 v[22:23], v4, s[4:7], s50 offen offset:48
    s_waitcnt vmcnt(4)
    s_mov_b32 s48, 0
Lvr_69:
    ds_read_b64 v[8:9], v30 offset:49152
    ds_read_b64 v[10:11], v30 offset:50176
    ds_read_b64 v[12:13], v30 offset:51200
    ds_read_b64 v[14:15], v30 offset:52224
    s_waitcnt lgkmcnt(0)
    v_max3_u32 v8, v8, v10, v12
    v_max_u32 v8, v8, v14
    v_cmp_eq_u32 vcc, -1, v8
    s_nop 4
    s_cbranch_vccz Lvk_70
    s_add_u32 s47, s63, 15
    s_and_b32 s47, s47, 15
    s_mul_i32 s47, s47, 344064
    s_add_u32 s47, s47, s57
    s_add_u32 m0, s59, 49152
    s_nop 0
    buffer_load_dwordx4 v36, s[28:31], s47 offen offset:0 sc1 lds
    buffer_load_dwordx4 v36, s[28:31], s47 offen offset:1024 sc1 lds
    s_not_b64 exec, s[44:45]
    buffer_load_dwordx4 v37, s[28:31], s47 offen offset:2048 sc1 lds
    buffer_load_dwordx4 v38, s[28:31], s47 offen offset:3072 sc1 lds
    s_mov_b64 exec, -1
    s_waitcnt vmcnt(0)
    s_add_u32 s48, s48, 1
    s_cmp_lt_u32 s48, 262144
    s_cbranch_scc1 Lvr_69
Lvk_70:
    ds_add_u32 v39, v31 offset:768
    s_mov_b32 s48, 0
Lfp_71:
    v_cmp_ne_u64 vcc, s[40:41], v[28:29]
    s_nop 4
    s_cbranch_vccz Lfd_72
    s_sleep 2
    s_mov_b32 s47, 25198592
    buffer_load_dwordx2 v[28:29], v25, s[28:31], s47 offen sc1
    s_waitcnt vmcnt(0)
    s_add_u32 s48, s48, 1
    s_cmp_lt_u32 s48, 262144
    s_cbranch_scc1 Lfp_71
Lfd_72:
    s_mov_b32 s48, 0
Lfp_73:
    v_and_b32 v34, 15, v33
    v_and_b32 v33, -16, v33
    v_cmp_ne_u64 vcc, s[40:41], v[32:33]
    s_nop 4
    s_cbranch_vccz Lfd_74
    s_sleep 2
    s_mov_b32 s47, 25214976
    buffer_load_dwordx2 v[32:33], v26, s[28:31], s47 offen sc1
    s_waitcnt vmcnt(0)
    s_add_u32 s48, s48, 1
    s_cmp_lt_u32 s48, 262144
    s_cbranch_scc1 Lfp_73
Lfd_74:
    s_getreg_b32 s47, hwreg(HW_REG_XCC_ID, 0, 4)
    v_cmp_ne_u32 vcc, s47, v34
    s_nop 0
    s_cmp_eq_u64 vcc, 0
    s_cselect_b32 s3, 1, 0
    v_mov_b32 v4, s3
    v_mov_b32 v5, 162176
    ds_write_b32 v5, v4
    s_waitcnt lgkmcnt(0)
    s_setprio 0
    s_barrier
    s_lshl_b32 s50, s36, 2
    s_lshr_b32 s51, s37, 2
    s_add_u32 s59, s50, s51
    s_and_b32 s47, s37, 7
    s_mul_i32 s93, s47, 0
    s_add_u32 s93, s93, s38
    s_and_b32 s93, s93, 7
    s_mov_b32 s86, 0
    s_add_u32 s87, s86, 1
    s_cmp_eq_u32 s87, 7
    s_cselect_b32 s87, 0, s87
    s_add_u32 s88, s87, 1
    s_cmp_eq_u32 s88, 7
    s_cselect_b32 s88, 0, s88
    s_add_u32 s89, s88, 1
    s_cmp_eq_u32 s89, 7
    s_cselect_b32 s89, 0, s89
    s_add_u32 s90, s89, 1
    s_cmp_eq_u32 s90, 7
    s_cselect_b32 s90, 0, s90
    s_add_u32 s91, s90, 1
    s_cmp_eq_u32 s91, 7
    s_cselect_b32 s91, 0, s91
    s_add_u32 s92, s91, 1
    s_cmp_eq_u32 s92, 7
    s_cselect_b32 s92, 0, s92
    s_lshl_b32 s50, s59, 15
    s_lshl_b32 s51, s39, 13
    s_add_u32 s50, s50, s51
    s_add_u32 s50, s50, 29360128
    s_add_u32 s52, s50, 4096
    v_add_u32 v6, s51, v1
    s_add_u32 m0, s51, 0
    s_nop 0
    buffer_load_dwordx4 v1, s[28:31], s50 offen offset:0 sc1 lds
    buffer_load_dwordx4 v1, s[28:31], s50 offen offset:1024 sc1 lds
    buffer_load_dwordx4 v1, s[28:31], s50 offen offset:2048 sc1 lds
    buffer_load_dwordx4 v1, s[28:31], s50 offen offset:3072 sc1 lds
    s_add_u32 m0, s51, 4096
    s_nop 0
    buffer_load_dwordx4 v1, s[28:31], s52 offen offset:0 sc1 lds
    buffer_load_dwordx4 v1, s[28:31], s52 offen offset:1024 sc1 lds
    buffer_load_dwordx4 v1, s[28:31], s52 offen offset:2048 sc1 lds
    buffer_load_dwordx4 v1, s[28:31], s52 offen offset:3072 sc1 lds
    s_waitcnt vmcnt(8)
    v_lshlrev_b32 v24, 16, v16
    v_and_b32 v25, 0xffff0000, v16
    v_lshlrev_b32 v26, 16, v17
    v_and_b32 v27, 0xffff0000, v17
    v_lshlrev_b32 v28, 16, v18
    v_and_b32 v29, 0xffff0000, v18
    v_lshlrev_b32 v30, 16, v19
    v_and_b32 v31, 0xffff0000, v19
    v_lshlrev_b32 v32, 16, v20
    v_and_b32 v33, 0xffff0000, v20
    v_lshlrev_b32 v34, 16, v21
    v_and_b32 v35, 0xffff0000, v21
    v_lshlrev_b32 v36, 16, v22
    v_and_b32 v37, 0xffff0000, v22
    v_lshlrev_b32 v38, 16, v23
    v_and_b32 v39, 0xffff0000, v23
    s_waitcnt vmcnt(0)
    s_mov_b32 s48, 0
Lvr_75:
    ds_read_b64 v[8:9], v6 offset:0
    ds_read_b64 v[10:11], v6 offset:1024
    ds_read_b64 v[12:13], v6 offset:2048
    ds_read_b64 v[14:15], v6 offset:3072
    ds_read_b64 v[16:17], v6 offset:4096
    ds_read_b64 v[18:19], v6 offset:5120
    ds_read_b64 v[20:21], v6 offset:6144
    ds_read_b64 v[22:23], v6 offset:7168
    s_waitcnt lgkmcnt(0)
    v_max3_u32 v8, v8, v10, v12
    v_max3_u32 v8, v8, v14, v16
    v_max3_u32 v8, v8, v18, v20
    v_max_u32 v8, v8, v22
    v_cmp_eq_u32 vcc, -1, v8
    s_nop 4
    s_cbranch_vccz Lvk_76
    s_add_u32 m0, s51, 0
    s_nop 0
    buffer_load_dwordx4 v1, s[28:31], s50 offen offset:0 sc1 lds
    buffer_load_dwordx4 v1, s[28:31], s50 offen offset:1024 sc1 lds
    buffer_load_dwordx4 v1, s[28:31], s50 offen offset:2048 sc1 lds
    buffer_load_dwordx4 v1, s[28:31], s50 offen offset:3072 sc1 lds
    s_add_u32 m0, s51, 4096
    s_nop 0
    buffer_load_dwordx4 v1, s[28:31], s52 offen offset:0 sc1 lds
    buffer_load_dwordx4 v1, s[28:31], s52 offen offset:1024 sc1 lds
    buffer_load_dwordx4 v1, s[28:31], s52 offen offset:2048 sc1 lds
    buffer_load_dwordx4 v1, s[28:31], s52 offen offset:3072 sc1 lds
    s_waitcnt vmcnt(0)
    s_add_u32 s48, s48, 1
    s_cmp_lt_u32 s48, 262144
    s_cbranch_scc1 Lvr_75
Lvk_76:
    s_barrier
    ds_read_b128 v[8:11], v1 offset:0
    ds_read_b128 v[12:15], v1 offset:1024
    ds_read_b128 v[16:19], v1 offset:2048
    ds_read_b128 v[20:23], v1 offset:3072
    s_waitcnt lgkmcnt(3)
    v_mfma_f32_32x32x16_bf16 v[24:39], v[160:163], v[8:11], v[24:39]
    ds_read_b128 v[8:11], v1 offset:4096
    s_waitcnt lgkmcnt(3)
    v_mfma_f32_32x32x16_bf16 v[24:39], v[164:167], v[12:15], v[24:39]
    ds_read_b128 v[12:15], v1 offset:5120
    s_waitcnt lgkmcnt(3)
    v_mfma_f32_32x32x16_bf16 v[24:39], v[168:171], v[16:19], v[24:39]
    ds_read_b128 v[16:19], v1 offset:6144
    s_waitcnt lgkmcnt(3)
    v_mfma_f32_32x32x16_bf16 v[24:39], v[172:175], v[20:23], v[24:39]
    ds_read_b128 v[20:23], v1 offset:7168
    s_waitcnt lgkmcnt(3)
    v_mfma_f32_32x32x16_bf16 v[24:39], v[176:179], v[8:11], v[24:39]
    ds_read_b128 v[8:11], v1 offset:8192
    s_waitcnt lgkmcnt(3)
    v_mfma_f32_32x32x16_bf16 v[24:39], v[180:183], v[12:15], v[24:39]
    ds_read_b128 v[12:15], v1 offset:9216
    s_waitcnt lgkmcnt(3)
    v_mfma_f32_32x32x16_bf16 v[24:39], v[184:187], v[16:19], v[24:39]
    s_add_u32 s50, s58, 22528
    buffer_load_dwordx4 v[160:163], v1, s[28:31], s50 offen offset:0
    buffer_load_dwordx4 v[164:167], v1, s[28:31], s50 offen offset:1024
    buffer_load_dwordx4 v[168:171], v1, s[28:31], s50 offen offset:2048
    buffer_load_dwordx4 v[172:175], v1, s[28:31], s50 offen offset:3072
    s_add_u32 s50, s50, 4096
    buffer_load_dwordx4 v[176:179], v1, s[28:31], s50 offen offset:0
    buffer_load_dwordx4 v[180:183], v1, s[28:31], s50 offen offset:1024
    ds_read_b128 v[16:19], v1 offset:10240
    s_waitcnt lgkmcnt(3)
    v_mfma_f32_32x32x16_bf16 v[24:39], v[188:191], v[20:23], v[24:39]
    ds_read_b128 v[20:23], v1 offset:11264
    s_waitcnt lgkmcnt(3)
    v_mfma_f32_32x32x16_bf16 v[24:39], v[192:195], v[8:11], v[24:39]
    ds_read_b128 v[8:11], v1 offset:12288
    s_waitcnt lgkmcnt(3)
    v_mfma_f32_32x32x16_bf16 v[24:39], v[196:199], v[12:15], v[24:39]
    ds_read_b128 v[12:15], v1 offset:13312
    s_waitcnt lgkmcnt(3)
    v_mfma_f32_32x32x16_bf16 v[24:39], v[200:203], v[16:19], v[24:39]
    ds_read_b128 v[16:19], v1 offset:14336
    s_waitcnt lgkmcnt(3)
    v_mfma_f32_32x32x16_bf16 v[24:39], v[204:207], v[20:23], v[24:39]
    ds_read_b128 v[20:23], v1 offset:15360
    s_waitcnt lgkmcnt(3)
    v_mfma_f32_32x32x16_bf16 v[24:39], v[208:211], v[8:11], v[24:39]
    s_mul_i32 s50, s59, 28
    s_and_b32 s51, s37, 3
    s_mul_i32 s52, s51, 7
    s_add_u32 s50, s50, s52
    s_lshl_b32 s52, s39, 1
    s_add_u32 s50, s50, s52
    s_lshl_b32 s50, s50, 10
    s_add_u32 s50, s50, 6291456
    s_add_u32 s52, s50, 1024
    s_cmp_eq_u32 s39, 3
    s_cselect_b32 s52, 0x7ff00000, s52
    s_cselect_b32 s54, 0, 1.0
    s_lshl_b32 s53, s59, 4
    s_lshl_b32 s51, s51, 2
    s_add_u32 s53, s53, s51
    s_add_u32 s53, s53, s39
    s_lshl_b32 s53, s53, 8
    s_add_u32 s53, s53, 22020096
    ds_read_b128 v[8:11], v1 offset:16384
    s_waitcnt lgkmcnt(3)
    v_mfma_f32_32x32x16_bf16 v[24:39], v[212:215], v[12:15], v[24:39]
    ds_read_b128 v[12:15], v1 offset:17408
    s_waitcnt lgkmcnt(3)
    v_mfma_f32_32x32x16_bf16 v[24:39], v[216:219], v[16:19], v[24:39]
    ds_read_b128 v[16:19], v1 offset:18432
    s_waitcnt lgkmcnt(3)
    v_mfma_f32_32x32x16_bf16 v[24:39], v[220:223], v[20:23], v[24:39]
    ds_read_b128 v[20:23], v1 offset:19456
    s_waitcnt lgkmcnt(3)
    v_mfma_f32_32x32x16_bf16 v[24:39], v[224:227], v[8:11], v[24:39]
    ds_read_b128 v[8:11], v1 offset:20480
    s_waitcnt lgkmcnt(3)
    v_mfma_f32_32x32x16_bf16 v[24:39], v[228:231], v[12:15], v[24:39]
    ds_read_b128 v[12:15], v1 offset:21504
    s_waitcnt lgkmcnt(3)
    v_mfma_f32_32x32x16_bf16 v[24:39], v[232:235], v[16:19], v[24:39]
    ds_read_b128 v[16:19], v1 offset:22528
    s_waitcnt lgkmcnt(3)
    v_mfma_f32_32x32x16_bf16 v[24:39], v[236:239], v[20:23], v[24:39]
    ds_read_b128 v[20:23], v1 offset:23552
    s_waitcnt lgkmcnt(3)
    v_mfma_f32_32x32x16_bf16 v[24:39], v[240:243], v[8:11], v[24:39]
    ds_read_b128 v[8:11], v1 offset:24576
    s_waitcnt lgkmcnt(3)
    v_mfma_f32_32x32x16_bf16 v[24:39], v[244:247], v[12:15], v[24:39]
    ds_read_b128 v[12:15], v1 offset:25600
    s_waitcnt lgkmcnt(3)
    v_mfma_f32_32x32x16_bf16 v[24:39], v[248:251], v[16:19], v[24:39]
    ds_read_b128 v[16:19], v1 offset:26624
    s_waitcnt lgkmcnt(3)
    v_mfma_f32_32x32x16_bf16 v[24:39], v[252:255], v[20:23], v[24:39]
    ds_read_b128 v[20:23], v1 offset:27648
    s_waitcnt lgkmcnt(3)
    v_mfma_f32_32x32x16_bf16 v[24:39], v[40:43], v[8:11], v[24:39]
    ds_read_b128 v[8:11], v1 offset:28672
    s_waitcnt lgkmcnt(3)
    v_mfma_f32_32x32x16_bf16 v[24:39], v[44:47], v[12:15], v[24:39]
    ds_read_b128 v[12:15], v1 offset:29696
    s_waitcnt lgkmcnt(3)
    v_mfma_f32_32x32x16_bf16 v[24:39], v[48:51], v[16:19], v[24:39]
    ds_read_b128 v[16:19], v1 offset:30720
    s_waitcnt lgkmcnt(3)
    v_mfma_f32_32x32x16_bf16 v[24:39], v[52:55], v[20:23], v[24:39]
    ds_read_b128 v[20:23], v1 offset:31744
    s_waitcnt lgkmcnt(3)
    v_mfma_f32_32x32x16_bf16 v[24:39], v[56:59], v[8:11], v[24:39]
    s_waitcnt lgkmcnt(2)
    v_mfma_f32_32x32x16_bf16 v[24:39], v[60:63], v[12:15], v[24:39]
    s_waitcnt lgkmcnt(0)
    v_mfma_f32_32x32x16_bf16 v[24:39], v[64:67], v[16:19], v[24:39]
    s_waitcnt lgkmcnt(0)
    v_mfma_f32_32x32x16_bf16 v[24:39], v[68:71], v[20:23], v[24:39]
    s_nop 11
    v_cvt_pk_bf16_f32 v8, v24, v25
    v_cvt_pk_bf16_f32 v9, v26, v27
    v_cvt_pk_bf16_f32 v10, v28, v29
    v_cvt_pk_bf16_f32 v11, v30, v31
    v_cvt_pk_bf16_f32 v12, v32, v33
    v_cvt_pk_bf16_f32 v13, v34, v35
    v_cvt_pk_bf16_f32 v14, v36, v37
    v_cvt_pk_bf16_f32 v15, v38, v39
    v_min_u32 v8, -2, v8
    v_min_u32 v12, -2, v12
    s_cmp_eq_u32 s3, 0
    s_cbranch_scc1 Lhs_77
    buffer_store_dwordx4 v[8:11], v1, s[28:31], s50 offen
    buffer_store_dwordx4 v[12:15], v1, s[28:31], s52 offen
    s_branch Lhs_78
Lhs_77:
    buffer_store_dwordx4 v[8:11], v1, s[28:31], s50 offen sc1
    buffer_store_dwordx4 v[12:15], v1, s[28:31], s52 offen sc1
Lhs_78:
    v_add_f32 v4, v24, v25
    v_mul_f32 v5, v24, v24
    v_fmac_f32 v5, v25, v25
    v_add_f32 v4, v4, v26
    v_fmac_f32 v5, v26, v26
    v_add_f32 v4, v4, v27
    v_fmac_f32 v5, v27, v27
    v_add_f32 v4, v4, v28
    v_fmac_f32 v5, v28, v28
    v_add_f32 v4, v4, v29
    v_fmac_f32 v5, v29, v29
    v_add_f32 v4, v4, v30
    v_fmac_f32 v5, v30, v30
    v_add_f32 v4, v4, v31
    v_fmac_f32 v5, v31, v31
    s_cmp_eq_u32 s39, 3
    s_cbranch_scc1 Lp3h_79
    v_add_f32 v4, v4, v32
    v_fmac_f32 v5, v32, v32
    v_add_f32 v4, v4, v33
    v_fmac_f32 v5, v33, v33
    v_add_f32 v4, v4, v34
    v_fmac_f32 v5, v34, v34
    v_add_f32 v4, v4, v35
    v_fmac_f32 v5, v35, v35
    v_add_f32 v4, v4, v36
    v_fmac_f32 v5, v36, v36
    v_add_f32 v4, v4, v37
    v_fmac_f32 v5, v37, v37
    v_add_f32 v4, v4, v38
    v_fmac_f32 v5, v38, v38
    v_add_f32 v4, v4, v39
    v_fmac_f32 v5, v39, v39
Lp3h_79:
    v_mov_b32 v6, v4
    v_mov_b32 v7, v5
    s_nop 0
    v_permlane32_swap_b32 v4, v6
    v_permlane32_swap_b32 v5, v7
    v_add_f32 v4, v4, v6
    v_add_f32 v5, v5, v7
    v_min_u32 v4, -2, v4
    v_lshlrev_b32 v6, 3, v0
    s_mov_b64 exec, 0xffffffff
    s_cmp_eq_u32 s3, 0
    s_cbranch_scc1 Lhs_80
    buffer_store_dwordx2 v[4:5], v6, s[28:31], s53 offen
    s_branch Lhs_81
Lhs_80:
    buffer_store_dwordx2 v[4:5], v6, s[28:31], s53 offen sc1
Lhs_81:
    s_mov_b64 exec, -1
    s_barrier
    s_lshl_b32 s50, s36, 2
    s_lshr_b32 s51, s37, 3
    s_lshl_b32 s51, s51, 1
    s_add_u32 s59, s50, s51
    s_mul_i32 s50, s59, 28672
    s_mul_i32 s51, s38, 7168
    s_add_u32 s50, s50, s51
    s_add_u32 s50, s50, 6291456
    s_add_u32 s52, s50, 4096
    v_add_u32 v6, s51, v1
    s_waitcnt vmcnt(3)
    s_mov_b32 s48, 0x00020001
    s_mov_b32 s49, 0x00020001
    v_mov_b32 v4, 0x3f803f80
    v_cndmask_b32 v8, 0, v4, s[48:49]
    v_mov_b32 v9, v8
    v_mov_b32 v10, v8
    v_mov_b32 v11, v8
    s_nop 1
    v_mfma_f32_16x16x32_bf16 v[12:15], v[8:11], v[72:75], 0
    v_mfma_f32_16x16x32_bf16 v[12:15], v[8:11], v[76:79], v[12:15]
    v_mfma_f32_16x16x32_bf16 v[12:15], v[8:11], v[80:83], v[12:15]
    v_mfma_f32_16x16x32_bf16 v[12:15], v[8:11], v[84:87], v[12:15]
    v_mfma_f32_16x16x32_bf16 v[12:15], v[8:11], v[88:91], v[12:15]
    v_mfma_f32_16x16x32_bf16 v[12:15], v[8:11], v[92:95], v[12:15]
    v_mfma_f32_16x16x32_bf16 v[12:15], v[8:11], v[96:99], v[12:15]
    v_mfma_f32_16x16x32_bf16 v[12:15], v[8:11], v[100:103], v[12:15]
    v_mfma_f32_16x16x32_bf16 v[12:15], v[8:11], v[104:107], v[12:15]
    v_mfma_f32_16x16x32_bf16 v[12:15], v[8:11], v[108:111], v[12:15]
    v_mfma_f32_16x16x32_bf16 v[12:15], v[8:11], v[112:115], v[12:15]
    v_mfma_f32_16x16x32_bf16 v[12:15], v[8:11], v[116:119], v[12:15]
    v_mfma_f32_16x16x32_bf16 v[12:15], v[8:11], v[120:123], v[12:15]
    v_mfma_f32_16x16x32_bf16 v[12:15], v[8:11], v[124:127], v[12:15]
    v_mfma_f32_16x16x32_bf16 v[12:15], v[8:11], v[128:131], v[12:15]
    v_mfma_f32_16x16x32_bf16 v[12:15], v[8:11], v[132:135], v[12:15]
    v_mfma_f32_16x16x32_bf16 v[12:15], v[8:11], v[136:139], v[12:15]
    v_mfma_f32_16x16x32_bf16 v[12:15], v[8:11], v[140:143], v[12:15]
    v_mfma_f32_16x16x32_bf16 v[12:15], v[8:11], v[144:147], v[12:15]
    v_mfma_f32_16x16x32_bf16 v[12:15], v[8:11], v[148:151], v[12:15]
    v_mfma_f32_16x16x32_bf16 v[12:15], v[8:11], v[152:155], v[12:15]
    v_mfma_f32_16x16x32_bf16 v[12:15], v[8:11], v[156:159], v[12:15]
    v_mfma_f32_16x16x32_bf16 v[12:15], v[8:11], v[160:163], v[12:15]
    v_mfma_f32_16x16x32_bf16 v[12:15], v[8:11], v[164:167], v[12:15]
    v_mfma_f32_16x16x32_bf16 v[12:15], v[8:11], v[168:171], v[12:15]
    v_mfma_f32_16x16x32_bf16 v[12:15], v[8:11], v[172:175], v[12:15]
    v_mfma_f32_16x16x32_bf16 v[12:15], v[8:11], v[176:179], v[12:15]
    v_mfma_f32_16x16x32_bf16 v[12:15], v[8:11], v[180:183], v[12:15]
    s_lshl_b32 s47, s38, 7
    s_add_u32 s47, s47, 162816
    v_lshl_add_u32 v4, v0, 2, s47
    v_lshl_add_u32 v5, v3, 4, s47
    s_mov_b64 exec, 0xffff
    s_nop 2
    ds_write_b32 v4, v12
    ds_write_b32 v4, v13 offset:64
    s_mov_b64 exec, -1
    ds_read_b128 v[56:59], v5 offset:0
    ds_read_b128 v[60:63], v5 offset:32
    ds_read_b128 v[64:67], v5 offset:64
    ds_read_b128 v[68:71], v5 offset:96
    s_waitcnt lgkmcnt(0)
    v_add_u32 v6, s51, v1
    s_add_u32 m0, s51, 0
    s_nop 0
    buffer_load_dwordx4 v1, s[28:31], s50 offen offset:0 sc1 lds
    buffer_load_dwordx4 v1, s[28:31], s50 offen offset:1024 sc1 lds
    buffer_load_dwordx4 v1, s[28:31], s50 offen offset:2048 sc1 lds
    buffer_load_dwordx4 v1, s[28:31], s50 offen offset:3072 sc1 lds
    s_add_u32 m0, s51, 4096
    s_nop 0
    buffer_load_dwordx4 v1, s[28:31], s52 offen offset:0 sc1 lds
    buffer_load_dwordx4 v1, s[28:31], s52 offen offset:1024 sc1 lds
    buffer_load_dwordx4 v1, s[28:31], s52 offen offset:2048 sc1 lds
    s_waitcnt vmcnt(0)
    s_mov_b32 s48, 0
Lvr_82:
    ds_read_b64 v[24:25], v6 offset:0
    ds_read_b64 v[26:27], v6 offset:1024
    ds_read_b64 v[28:29], v6 offset:2048
    ds_read_b64 v[30:31], v6 offset:3072
    ds_read_b64 v[32:33], v6 offset:4096
    ds_read_b64 v[34:35], v6 offset:5120
    ds_read_b64 v[36:37], v6 offset:6144
    s_waitcnt lgkmcnt(0)
    v_max3_u32 v24, v24, v26, v28
    v_max3_u32 v24, v24, v30, v32
    v_max3_u32 v24, v24, v34, v36
    v_cmp_eq_u32 vcc, -1, v24
    s_nop 4
    s_cbranch_vccz Lvk_83
    s_add_u32 m0, s51, 0
    s_nop 0
    buffer_load_dwordx4 v1, s[28:31], s50 offen offset:0 sc1 lds
    buffer_load_dwordx4 v1, s[28:31], s50 offen offset:1024 sc1 lds
    buffer_load_dwordx4 v1, s[28:31], s50 offen offset:2048 sc1 lds
    buffer_load_dwordx4 v1, s[28:31], s50 offen offset:3072 sc1 lds
    s_add_u32 m0, s51, 4096
    s_nop 0
    buffer_load_dwordx4 v1, s[28:31], s52 offen offset:0 sc1 lds
    buffer_load_dwordx4 v1, s[28:31], s52 offen offset:1024 sc1 lds
    buffer_load_dwordx4 v1, s[28:31], s52 offen offset:2048 sc1 lds
    s_waitcnt vmcnt(0)
    s_add_u32 s48, s48, 1
    s_cmp_lt_u32 s48, 262144
    s_cbranch_scc1 Lvr_82
Lvk_83:
    s_barrier
    s_and_b32 s51, s37, 7
    s_mul_i32 s51, s51, 7
    s_add_u32 s51, s51, s39
    s_lshl_b32 s51, s51, 1
    s_mul_i32 s54, s59, 112
    s_add_u32 s54, s54, s51
    s_lshl_b32 s54, s54, 10
    s_add_u32 s54, s54, 8388608
    s_add_u32 s55, s54, 114688
    ds_read_b128 v[8:11], v1 offset:0
    ds_read_b128 v[12:15], v1 offset:1024
    s_waitcnt lgkmcnt(1)
    v_mfma_f32_32x32x16_bf16 v[24:39], v[72:75], v[8:11], 0
    ds_read_b128 v[8:11], v1 offset:2048
    s_waitcnt lgkmcnt(1)
    v_mfma_f32_32x32x16_bf16 v[24:39], v[76:79], v[12:15], v[24:39]
    s_and_b32 s50, s37, 7
    s_mul_i32 s50, s50, 112
    s_mul_i32 s52, s93, 14
    s_add_u32 s52, s50, s52
    s_mul_i32 s52, s52, 1792
    s_add_u32 s52, s52, 19922944
    v_mul_u32_u24 v21, 24, v3
    v_min_u32 v20, 23, v2
    v_add_lshl_u32 v21, v21, v20, 4
    s_mul_i32 s50, s86, 3584
    s_add_u32 s50, s50, s52
    buffer_load_dwordx4 v[184:187], v1, s[28:31], s50 offen offset:0
    ds_read_b128 v[12:15], v1 offset:3072
    s_waitcnt lgkmcnt(1)
    v_mfma_f32_32x32x16_bf16 v[24:39], v[80:83], v[8:11], v[24:39]
    buffer_load_dwordx4 v[188:191], v21, s[28:31], s50 offen offset:1024
    ds_read_b128 v[8:11], v1 offset:4096
    s_waitcnt lgkmcnt(1)
    v_mfma_f32_32x32x16_bf16 v[24:39], v[84:87], v[12:15], v[24:39]
    buffer_load_dwordx4 v[192:195], v1, s[28:31], s50 offen offset:1792
    ds_read_b128 v[12:15], v1 offset:5120
    s_waitcnt lgkmcnt(1)
    v_mfma_f32_32x32x16_bf16 v[24:39], v[88:91], v[8:11], v[24:39]
    buffer_load_dwordx4 v[196:199], v21, s[28:31], s50 offen offset:2816
    ds_read_b128 v[8:11], v1 offset:6144
    s_waitcnt lgkmcnt(1)
    v_mfma_f32_32x32x16_bf16 v[24:39], v[92:95], v[12:15], v[24:39]
    s_mul_i32 s50, s87, 3584
    s_add_u32 s50, s50, s52
    buffer_load_dwordx4 v[200:203], v1, s[28:31], s50 offen offset:0
    ds_read_b128 v[12:15], v1 offset:7168
    s_waitcnt lgkmcnt(1)
    v_mfma_f32_32x32x16_bf16 v[24:39], v[96:99], v[8:11], v[24:39]
    buffer_load_dwordx4 v[204:207], v21, s[28:31], s50 offen offset:1024
    ds_read_b128 v[8:11], v1 offset:8192
    s_waitcnt lgkmcnt(1)
    v_mfma_f32_32x32x16_bf16 v[24:39], v[100:103], v[12:15], v[24:39]
    buffer_load_dwordx4 v[208:211], v1, s[28:31], s50 offen offset:1792
    ds_read_b128 v[12:15], v1 offset:9216
    s_waitcnt lgkmcnt(1)
    v_mfma_f32_32x32x16_bf16 v[24:39], v[104:107], v[8:11], v[24:39]
    buffer_load_dwordx4 v[212:215], v21, s[28:31], s50 offen offset:2816
    ds_read_b128 v[8:11], v1 offset:10240
    s_waitcnt lgkmcnt(1)
    v_mfma_f32_32x32x16_bf16 v[24:39], v[108:111], v[12:15], v[24:39]
    s_mul_i32 s50, s88, 3584
    s_add_u32 s50, s50, s52
    buffer_load_dwordx4 v[216:219], v1, s[28:31], s50 offen offset:0
    ds_read_b128 v[12:15], v1 offset:11264
    s_waitcnt lgkmcnt(1)
    v_mfma_f32_32x32x16_bf16 v[24:39], v[112:115], v[8:11], v[24:39]
    buffer_load_dwordx4 v[220:223], v21, s[28:31], s50 offen offset:1024
    ds_read_b128 v[8:11], v1 offset:12288
    s_waitcnt lgkmcnt(1)
    v_mfma_f32_32x32x16_bf16 v[24:39], v[116:119], v[12:15], v[24:39]
    buffer_load_dwordx4 v[224:227], v1, s[28:31], s50 offen offset:1792
    ds_read_b128 v[12:15], v1 offset:13312
    s_waitcnt lgkmcnt(1)
    v_mfma_f32_32x32x16_bf16 v[24:39], v[120:123], v[8:11], v[24:39]
    buffer_load_dwordx4 v[228:231], v21, s[28:31], s50 offen offset:2816
    ds_read_b128 v[8:11], v1 offset:14336
    s_waitcnt lgkmcnt(1)
    v_mfma_f32_32x32x16_bf16 v[24:39], v[124:127], v[12:15], v[24:39]
    s_mul_i32 s50, s89, 3584
    s_add_u32 s50, s50, s52
    buffer_load_dwordx4 v[232:235], v1, s[28:31], s50 offen offset:0
    ds_read_b128 v[12:15], v1 offset:15360
    s_waitcnt lgkmcnt(1)
    v_mfma_f32_32x32x16_bf16 v[24:39], v[128:131], v[8:11], v[24:39]
    buffer_load_dwordx4 v[236:239], v21, s[28:31], s50 offen offset:1024
    ds_read_b128 v[8:11], v1 offset:16384
    s_waitcnt lgkmcnt(1)
    v_mfma_f32_32x32x16_bf16 v[24:39], v[132:135], v[12:15], v[24:39]
    buffer_load_dwordx4 v[240:243], v1, s[28:31], s50 offen offset:1792
    ds_read_b128 v[12:15], v1 offset:17408
    s_waitcnt lgkmcnt(1)
    v_mfma_f32_32x32x16_bf16 v[24:39], v[136:139], v[8:11], v[24:39]
    buffer_load_dwordx4 v[244:247], v21, s[28:31], s50 offen offset:2816
    ds_read_b128 v[8:11], v1 offset:18432
    s_waitcnt lgkmcnt(1)
    v_mfma_f32_32x32x16_bf16 v[24:39], v[140:143], v[12:15], v[24:39]
    s_mul_i32 s50, s90, 3584
    s_add_u32 s50, s50, s52
    buffer_load_dwordx4 v[248:251], v1, s[28:31], s50 offen offset:0
    ds_read_b128 v[12:15], v1 offset:19456
    s_waitcnt lgkmcnt(1)
    v_mfma_f32_32x32x16_bf16 v[24:39], v[144:147], v[8:11], v[24:39]
    buffer_load_dwordx4 v[252:255], v21, s[28:31], s50 offen offset:1024
    ds_read_b128 v[8:11], v1 offset:20480
    s_waitcnt lgkmcnt(1)
    v_mfma_f32_32x32x16_bf16 v[24:39], v[148:151], v[12:15], v[24:39]
    ds_read_b128 v[12:15], v1 offset:21504
    s_waitcnt lgkmcnt(1)
    v_mfma_f32_32x32x16_bf16 v[24:39], v[152:155], v[8:11], v[24:39]
    ds_read_b128 v[8:11], v1 offset:22528
    s_waitcnt lgkmcnt(1)
    v_mfma_f32_32x32x16_bf16 v[24:39], v[156:159], v[12:15], v[24:39]
    ds_read_b128 v[12:15], v1 offset:23552
    s_waitcnt lgkmcnt(1)
    v_mfma_f32_32x32x16_bf16 v[24:39], v[160:163], v[8:11], v[24:39]
    ds_read_b128 v[8:11], v1 offset:24576
    s_waitcnt lgkmcnt(1)
    v_mfma_f32_32x32x16_bf16 v[24:39], v[164:167], v[12:15], v[24:39]
    ds_read_b128 v[12:15], v1 offset:25600
    s_waitcnt lgkmcnt(1)
    v_mfma_f32_32x32x16_bf16 v[24:39], v[168:171], v[8:11], v[24:39]
    ds_read_b128 v[8:11], v1 offset:26624
    s_waitcnt lgkmcnt(1)
    v_mfma_f32_32x32x16_bf16 v[24:39], v[172:175], v[12:15], v[24:39]
    s_barrier
    v_lshlrev_b32 v4, 3, v2
    v_add_u32 v4, 162304, v4
    ds_read_b64 v[6:7], v4 offset:256
    ds_read_b64 v[4:5], v4
    ds_read_b128 v[12:15], v1 offset:27648
    s_waitcnt lgkmcnt(1)
    v_mfma_f32_32x32x16_bf16 v[24:39], v[176:179], v[8:11], v[24:39]
    ds_read_b128 v[8:11], v1 offset:28672
    s_waitcnt lgkmcnt(1)
    v_mfma_f32_32x32x16_bf16 v[24:39], v[180:183], v[12:15], v[24:39]
    ds_read_b128 v[12:15], v1 offset:29696
    s_waitcnt lgkmcnt(1)
    v_mfma_f32_32x32x16_bf16 v[40:55], v[72:75], v[8:11], 0
    ds_read_b128 v[8:11], v1 offset:30720
    s_waitcnt lgkmcnt(1)
    v_mfma_f32_32x32x16_bf16 v[40:55], v[76:79], v[12:15], v[40:55]
    s_nop 5
    v_mul_f32 v24, v24, v4
    v_fmac_f32 v24, v5, v56
    v_mul_f32 v25, v25, v4
    v_fmac_f32 v25, v5, v57
    v_mul_f32 v26, v26, v4
    v_fmac_f32 v26, v5, v58
    v_mul_f32 v27, v27, v4
    v_fmac_f32 v27, v5, v59
    v_mul_f32 v28, v28, v4
    v_fmac_f32 v28, v5, v60
    v_mul_f32 v29, v29, v4
    v_fmac_f32 v29, v5, v61
    v_mul_f32 v30, v30, v4
    v_fmac_f32 v30, v5, v62
    v_mul_f32 v31, v31, v4
    v_fmac_f32 v31, v5, v63
    ds_read_b128 v[12:15], v1 offset:31744
    s_waitcnt lgkmcnt(1)
    v_mfma_f32_32x32x16_bf16 v[40:55], v[80:83], v[8:11], v[40:55]
    v_mul_f32 v32, v32, v4
    v_fmac_f32 v32, v5, v64
    v_mul_f32 v33, v33, v4
    v_fmac_f32 v33, v5, v65
    v_mul_f32 v34, v34, v4
    v_fmac_f32 v34, v5, v66
    v_mul_f32 v35, v35, v4
    v_fmac_f32 v35, v5, v67
    v_mul_f32 v36, v36, v4
    v_fmac_f32 v36, v5, v68
    v_mul_f32 v37, v37, v4
    v_fmac_f32 v37, v5, v69
    v_mul_f32 v38, v38, v4
    v_fmac_f32 v38, v5, v70
    v_mul_f32 v39, v39, v4
    v_fmac_f32 v39, v5, v71
    ds_read_b128 v[8:11], v1 offset:32768
    s_waitcnt lgkmcnt(1)
    v_mfma_f32_32x32x16_bf16 v[40:55], v[84:87], v[12:15], v[40:55]
    v_cvt_pk_bf16_f32 v24, v24, v25
    v_pk_max_i16 v24, v24, 0
    v_cvt_pk_bf16_f32 v25, v26, v27
    v_pk_max_i16 v25, v25, 0
    v_cvt_pk_bf16_f32 v26, v28, v29
    v_pk_max_i16 v26, v26, 0
    v_cvt_pk_bf16_f32 v27, v30, v31
    v_pk_max_i16 v27, v27, 0
    v_cvt_pk_bf16_f32 v28, v32, v33
    v_pk_max_i16 v28, v28, 0
    v_cvt_pk_bf16_f32 v29, v34, v35
    v_pk_max_i16 v29, v29, 0
    v_cvt_pk_bf16_f32 v30, v36, v37
    v_pk_max_i16 v30, v30, 0
    v_cvt_pk_bf16_f32 v31, v38, v39
    v_pk_max_i16 v31, v31, 0
    buffer_store_dwordx4 v[24:27], v1, s[28:31], s54 offen sc1
    buffer_store_dwordx4 v[28:31], v1, s[28:31], s54 offen offset:1024 sc1
    ds_read_b128 v[12:15], v1 offset:33792
    s_waitcnt lgkmcnt(1)
    v_mfma_f32_32x32x16_bf16 v[40:55], v[88:91], v[8:11], v[40:55]
    ds_read_b128 v[8:11], v1 offset:34816
    s_waitcnt lgkmcnt(1)
    v_mfma_f32_32x32x16_bf16 v[40:55], v[92:95], v[12:15], v[40:55]
    s_mul_i32 s50, s90, 3584
    s_add_u32 s50, s50, s52
    buffer_load_dwordx4 v[72:75], v1, s[28:31], s50 offen offset:1792
    ds_read_b128 v[12:15], v1 offset:35840
    s_waitcnt lgkmcnt(1)
    v_mfma_f32_32x32x16_bf16 v[40:55], v[96:99], v[8:11], v[40:55]
    buffer_load_dwordx4 v[76:79], v21, s[28:31], s50 offen offset:2816
    ds_read_b128 v[8:11], v1 offset:36864
    s_waitcnt lgkmcnt(1)
    v_mfma_f32_32x32x16_bf16 v[40:55], v[100:103], v[12:15], v[40:55]
    s_mul_i32 s50, s91, 3584
    s_add_u32 s50, s50, s52
    buffer_load_dwordx4 v[80:83], v1, s[28:31], s50 offen offset:0
    ds_read_b128 v[12:15], v1 offset:37888
    s_waitcnt lgkmcnt(1)
    v_mfma_f32_32x32x16_bf16 v[40:55], v[104:107], v[8:11], v[40:55]
    buffer_load_dwordx4 v[84:87], v21, s[28:31], s50 offen offset:1024
    ds_read_b128 v[8:11], v1 offset:38912
    s_waitcnt lgkmcnt(1)
    v_mfma_f32_32x32x16_bf16 v[40:55], v[108:111], v[12:15], v[40:55]
    buffer_load_dwordx4 v[88:91], v1, s[28:31], s50 offen offset:1792
    ds_read_b128 v[12:15], v1 offset:39936
    s_waitcnt lgkmcnt(1)
    v_mfma_f32_32x32x16_bf16 v[40:55], v[112:115], v[8:11], v[40:55]
    buffer_load_dwordx4 v[92:95], v21, s[28:31], s50 offen offset:2816
    ds_read_b128 v[8:11], v1 offset:40960
    s_waitcnt lgkmcnt(1)
    v_mfma_f32_32x32x16_bf16 v[40:55], v[116:119], v[12:15], v[40:55]
    s_mul_i32 s50, s92, 3584
    s_add_u32 s50, s50, s52
    buffer_load_dwordx4 v[96:99], v1, s[28:31], s50 offen offset:0
    ds_read_b128 v[12:15], v1 offset:41984
    s_waitcnt lgkmcnt(1)
    v_mfma_f32_32x32x16_bf16 v[40:55], v[120:123], v[8:11], v[40:55]
    buffer_load_dwordx4 v[100:103], v21, s[28:31], s50 offen offset:1024
    ds_read_b128 v[8:11], v1 offset:43008
    s_waitcnt lgkmcnt(1)
    v_mfma_f32_32x32x16_bf16 v[40:55], v[124:127], v[12:15], v[40:55]
    buffer_load_dwordx4 v[104:107], v1, s[28:31], s50 offen offset:1792
    ds_read_b128 v[12:15], v1 offset:44032
    s_waitcnt lgkmcnt(1)
    v_mfma_f32_32x32x16_bf16 v[40:55], v[128:131], v[8:11], v[40:55]
    buffer_load_dwordx4 v[108:111], v21, s[28:31], s50 offen offset:2816
    ds_read_b128 v[8:11], v1 offset:45056
    s_waitcnt lgkmcnt(1)
    v_mfma_f32_32x32x16_bf16 v[40:55], v[132:135], v[12:15], v[40:55]
    ds_read_b128 v[12:15], v1 offset:46080
    s_waitcnt lgkmcnt(1)
    v_mfma_f32_32x32x16_bf16 v[40:55], v[136:139], v[8:11], v[40:55]
    ds_read_b128 v[8:11], v1 offset:47104
    s_waitcnt lgkmcnt(1)
    v_mfma_f32_32x32x16_bf16 v[40:55], v[140:143], v[12:15], v[40:55]
    ds_read_b128 v[12:15], v1 offset:48128
    s_waitcnt lgkmcnt(1)
    v_mfma_f32_32x32x16_bf16 v[40:55], v[144:147], v[8:11], v[40:55]
    ds_read_b128 v[8:11], v1 offset:49152
    s_waitcnt lgkmcnt(1)
    v_mfma_f32_32x32x16_bf16 v[40:55], v[148:151], v[12:15], v[40:55]
    ds_read_b128 v[12:15], v1 offset:50176
    s_waitcnt lgkmcnt(1)
    v_mfma_f32_32x32x16_bf16 v[40:55], v[152:155], v[8:11], v[40:55]
    ds_read_b128 v[8:11], v1 offset:51200
    s_waitcnt lgkmcnt(1)
    v_mfma_f32_32x32x16_bf16 v[40:55], v[156:159], v[12:15], v[40:55]
    ds_read_b128 v[12:15], v1 offset:52224
    s_waitcnt lgkmcnt(1)
    v_mfma_f32_32x32x16_bf16 v[40:55], v[160:163], v[8:11], v[40:55]
    ds_read_b128 v[8:11], v1 offset:53248
    s_waitcnt lgkmcnt(1)
    v_mfma_f32_32x32x16_bf16 v[40:55], v[164:167], v[12:15], v[40:55]
    ds_read_b128 v[12:15], v1 offset:54272
    s_waitcnt lgkmcnt(1)
    v_mfma_f32_32x32x16_bf16 v[40:55], v[168:171], v[8:11], v[40:55]
    ds_read_b128 v[8:11], v1 offset:55296
    s_waitcnt lgkmcnt(1)
    v_mfma_f32_32x32x16_bf16 v[40:55], v[172:175], v[12:15], v[40:55]
    v_lshlrev_b32 v22, 2, v0
    v_add_u32 v22, 155648, v22
    v_mov_b32 v23, 1
    ds_add_u32 v22, v23 offset:2048
    ds_read_b128 v[12:15], v1 offset:56320
    s_waitcnt lgkmcnt(1)
    v_mfma_f32_32x32x16_bf16 v[40:55], v[176:179], v[8:11], v[40:55]
    s_waitcnt lgkmcnt(0)
    v_mfma_f32_32x32x16_bf16 v[40:55], v[180:183], v[12:15], v[40:55]
    s_and_b32 s51, s37, 7
    s_mul_i32 s51, s51, 7
    s_cmp_gt_u32 s38, 3
    s_subb_u32 s52, s38, 0
    s_add_u32 s52, s51, s52
    s_lshr_b32 s53, s52, 1
    s_lshl_b32 s53, s53, 10
    s_and_b32 s52, s52, 1
    s_lshl_b32 s52, s52, 3
    s_add_u32 s53, s53, s52
    v_add_u32 v20, s53, v1
    ds_read_b64 v[176:177], v20 offset:0
    ds_read_b64 v[178:179], v20 offset:28672
    s_mul_i32 s94, s59, 112
    s_mul_i32 s51, s93, 14
    s_add_u32 s94, s94, s51
    s_lshl_b32 s94, s94, 10
    s_add_u32 s94, s94, 8388608
    s_add_u32 s95, s94, 114688
    v_mul_f32 v40, v40, v6
    v_fmac_f32 v40, v7, v56
    v_mul_f32 v41, v41, v6
    v_fmac_f32 v41, v7, v57
    v_mul_f32 v42, v42, v6
    v_fmac_f32 v42, v7, v58
    v_mul_f32 v43, v43, v6
    v_fmac_f32 v43, v7, v59
    v_mul_f32 v44, v44, v6
    v_fmac_f32 v44, v7, v60
    v_mul_f32 v45, v45, v6
    v_fmac_f32 v45, v7, v61
    v_mul_f32 v46, v46, v6
    v_fmac_f32 v46, v7, v62
    v_mul_f32 v47, v47, v6
    v_fmac_f32 v47, v7, v63
    v_mul_f32 v48, v48, v6
    v_fmac_f32 v48, v7, v64
    v_mul_f32 v49, v49, v6
    v_fmac_f32 v49, v7, v65
    v_mul_f32 v50, v50, v6
    v_fmac_f32 v50, v7, v66
    v_mul_f32 v51, v51, v6
    v_fmac_f32 v51, v7, v67
    v_mul_f32 v52, v52, v6
    v_fmac_f32 v52, v7, v68
    v_mul_f32 v53, v53, v6
    v_fmac_f32 v53, v7, v69
    v_mul_f32 v54, v54, v6
    v_fmac_f32 v54, v7, v70
    v_mul_f32 v55, v55, v6
    v_fmac_f32 v55, v7, v71
    v_cvt_pk_bf16_f32 v40, v40, v41
    v_pk_max_i16 v40, v40, 0
    v_cvt_pk_bf16_f32 v41, v42, v43
    v_pk_max_i16 v41, v41, 0
    v_cvt_pk_bf16_f32 v42, v44, v45
    v_pk_max_i16 v42, v42, 0
    v_cvt_pk_bf16_f32 v43, v46, v47
    v_pk_max_i16 v43, v43, 0
    v_cvt_pk_bf16_f32 v44, v48, v49
    v_pk_max_i16 v44, v44, 0
    v_cvt_pk_bf16_f32 v45, v50, v51
    v_pk_max_i16 v45, v45, 0
    v_cvt_pk_bf16_f32 v46, v52, v53
    v_pk_max_i16 v46, v46, 0
    v_cvt_pk_bf16_f32 v47, v54, v55
    v_pk_max_i16 v47, v47, 0
    buffer_store_dwordx4 v[40:43], v1, s[28:31], s55 offen sc1
    buffer_store_dwordx4 v[44:47], v1, s[28:31], s55 offen offset:1024 sc1
    s_lshl_b32 s47, s86, 11
    s_add_u32 s47, s47, s94
    buffer_load_dwordx4 v[112:115], v1, s[28:31], s47 offen offset:0
    buffer_load_dwordx4 v[116:119], v1, s[28:31], s47 offen offset:1024
    s_lshl_b32 s47, s87, 11
    s_add_u32 s47, s47, s94
    buffer_load_dwordx4 v[120:123], v1, s[28:31], s47 offen offset:0
    buffer_load_dwordx4 v[124:127], v1, s[28:31], s47 offen offset:1024
    s_lshl_b32 s47, s88, 11
    s_add_u32 s47, s47, s94
    buffer_load_dwordx4 v[128:131], v1, s[28:31], s47 offen offset:0
    buffer_load_dwordx4 v[132:135], v1, s[28:31], s47 offen offset:1024
    s_branch Ljoin
LF:
    s_and_b32 s47, s46, 7
    s_lshl_b32 s47, s47, 2
    s_lshr_b32 s48, s46, 3
    s_sub_u32 s48, s48, 28
    s_add_u32 s57, s47, s48
    s_lshl_b32 s52, s57, 3
    s_add_u32 s52, s52, s38
    s_lshl_b32 s53, s38, 5
    s_add_u32 s53, s53, s57
    s_add_u32 s53, s53, 256
    s_waitcnt lgkmcnt(0)
    s_mov_b32 s4, s64
    s_mov_b32 s5, s65
    s_mov_b32 s6, 1835008
    s_mov_b32 s7, 0x00020000
    s_mov_b32 s12, s68
    s_mov_b32 s13, s69
    s_mov_b32 s14, 401408
    s_mov_b32 s15, 0x00020000
    s_mov_b32 s16, s72
    s_mov_b32 s17, s73
    s_mov_b32 s18, 1605632
    s_mov_b32 s19, 0x00020000
    s_mov_b32 s20, s74
    s_mov_b32 s21, s75
    s_mov_b32 s22, 1605632
    s_mov_b32 s23, 0x00020000
    s_mov_b32 s24, s76
    s_mov_b32 s25, s77
    s_mov_b32 s26, 1835008
    s_mov_b32 s27, 0x00020000
    s_mov_b32 s28, s80
    s_mov_b32 s29, s81
    s_mov_b32 s30, 33554432
    s_mov_b32 s31, 0x00020000
    s_mov_b32 s32, s78
    s_mov_b32 s33, s79
    s_mov_b32 s34, 256
    s_mov_b32 s35, 0x00020000
    s_and_b32 s36, s46, 7
    s_lshl_b32 s62, s36, 1
    s_bfe_u32 s47, s46, 0x10003
    s_add_u32 s62, s62, s47
    s_lshr_b32 s63, s46, 4
    s_lshr_b32 s47, s46, 7
    s_lshl_b32 s47, s47, 3
    s_add_u32 s36, s36, s47
    s_bfe_u32 s37, s46, 0x40003
    s_mov_b32 s42, 0
    s_mov_b32 s43, -1
    s_mov_b32 s44, 0xF0000000
    s_mov_b32 s45, 0xF0000000
    s_mov_b32 s3, 0
    s_mov_b32 s58, 0
LFp:
    s_mov_b32 s56, 0
LFs:
    s_mov_b32 s54, s82
    s_cmp_eq_u32 s56, 0
    s_cselect_b32 s49, s52, s53
    s_mov_b64 s[84:85], s[16:17]
    s_mov_b64 s[86:87], s[18:19]
    s_mov_b32 s83, 3584
    s_mov_b32 s94, 0
    s_mul_i32 s48, s49, 4682
    s_lshr_b32 s48, s48, 16
    s_mul_i32 s47, s48, 14
    s_sub_u32 s47, s49, s47
    s_mul_i32 s88, s48, 57344
    s_lshl_b32 s90, s47, 8
    s_add_u32 s88, s88, s90
    s_mul_i32 s47, s47, 28
    s_add_u32 s82, s47, s48
    s_lshl_b32 s82, s82, 3
    s_add_u32 s82, s82, 25182208
    s_lshl_b32 s47, s47, 2
    s_add_u32 s47, s47, s48
    s_lshl_b32 s47, s47, 10
    s_add_u32 s90, s47, 17825792
    s_add_u32 s91, s90, 28672
    s_add_u32 s92, s91, 28672
    s_add_u32 s93, s92, 28672
    s_cmp_ge_u32 s49, 392
    s_cselect_b32 s82, 0x7ff00000, s82
    s_cselect_b32 s88, 0x7ff00000, s88
    s_cselect_b32 s90, 0x7ff00000, s90
    s_cselect_b32 s91, 0x7ff00000, s91
    s_cselect_b32 s92, 0x7ff00000, s92
    s_cselect_b32 s93, 0x7ff00000, s93
    s_lshl_b32 s89, s83, 2
    v_lshrrev_b32 v4, 4, v0
    v_mul_lo_u32 v4, v4, s83
    v_and_b32 v5, 15, v0
    v_lshl_add_u32 v61, v5, 4, v4
    s_lshl_b32 s95, s38, 13
    s_lshl_b32 s47, s56, 12
    s_add_u32 s95, s95, s47
    s_cmp_lg_u32 s58, 0
    s_cbranch_scc1 LFf
    s_add_u32 m0, s95, 0
    s_nop 0
    buffer_load_dwordx4 v61, s[84:87], s88 offen nt lds
    s_add_u32 s88, s88, s89
    s_add_u32 m0, s95, 1024
    s_nop 0
    buffer_load_dwordx4 v61, s[84:87], s88 offen nt lds
    s_add_u32 s88, s88, s89
    s_add_u32 m0, s95, 2048
    s_nop 0
    buffer_load_dwordx4 v61, s[84:87], s88 offen nt lds
    s_add_u32 s88, s88, s89
    s_add_u32 m0, s95, 3072
    s_nop 0
    buffer_load_dwordx4 v61, s[84:87], s88 offen nt lds
    s_branch LFn
LFf:
    s_waitcnt vmcnt(4)
    v_bfe_u32 v61, v0, 2, 2
    v_lshl_add_u32 v61, v3, 2, v61
    v_lshlrev_b32 v61, 8, v61
    v_bfe_u32 v60, v0, 4, 1
    v_lshl_add_u32 v61, v60, 5, v61
    v_and_b32 v60, 3, v0
    v_lshl_add_u32 v61, v60, 3, v61
    v_add_u32 v61, s95, v61
    s_lshl_b32 s47, s94, 4
    v_subrev_u32 v60, s47, v61
    ds_read_b64_tr_b16 v[128:129], v61 offset:0
    ds_read_b64_tr_b16 v[130:131], v61 offset:2048
    ds_read_b64_tr_b16 v[132:133], v61 offset:64
    ds_read_b64_tr_b16 v[134:135], v61 offset:2112
    ds_read_b64_tr_b16 v[136:137], v60 offset:128
    ds_read_b64_tr_b16 v[138:139], v60 offset:2176
    ds_read_b64_tr_b16 v[140:141], v60 offset:192
    ds_read_b64_tr_b16 v[142:143], v60 offset:2240
    v_mul_u32_u24 v5, 24, v3
    v_add_u32 v5, v5, v2
    v_lshlrev_b32 v5, 4, v5
    s_cmp_eq_u32 s94, 1
    s_cselect_b64 vcc, -1, 0
    s_cselect_b32 s48, 0x00ffffff, -1
    s_mov_b32 s49, s48
    v_cndmask_b32 v5, v1, v5, vcc
    s_waitcnt lgkmcnt(0)
    buffer_store_dwordx4 v[128:131], v1, s[28:31], s90 offen sc1
    s_mov_b64 exec, s[48:49]
    buffer_store_dwordx4 v[132:135], v5, s[28:31], s91 offen sc1
    s_mov_b64 exec, -1
    buffer_store_dwordx4 v[136:139], v1, s[28:31], s92 offen sc1
    s_mov_b64 exec, s[48:49]
    buffer_store_dwordx4 v[140:143], v5, s[28:31], s93 offen sc1
    s_mov_b64 exec, -1
LFn:
    s_add_u32 s56, s56, 1
    s_cmp_lt_u32 s56, 2
    s_cbranch_scc1 LFs
    s_add_u32 s58, s58, 1
    s_cmp_lt_u32 s58, 2
    s_cbranch_scc1 LFp
    v_mov_b32 v4, 0
    s_mov_b32 s47, 0
    s_cmp_eq_u32 s38, 7
    s_cselect_b32 s47, s47, 0x7ff00000
    buffer_load_dwordx2 v[52:53], v4, s[32:35], s47 offen sc1
    s_mul_i32 s47, s62, 7
    s_lshr_b32 s47, s47, 1
    s_lshl_b32 s47, s47, 3
    s_mul_i32 s48, s62, 28
    s_add_u32 s48, s48, 448
    v_mov_b32 v4, s47
    v_mov_b32 v5, s48
    v_cndmask_b32 v4, v4, v5, s[42:43]
    v_bfe_u32 v5, v0, 4, 1
    v_mul_u32_u24 v6, 4, v3
    v_sub_u32 v6, 31, v6
    v_mad_u32_u24 v4, v5, v6, v4
    v_add_u32 v4, 448, v4
    v_mul_u32_u24 v4, 0x2ab, v4
    v_lshrrev_b32 v4, 16, v4
    v_and_b32 v6, 15, v0
    v_lshl_add_u32 v4, v4, 4, v6
    v_lshlrev_b32 v200, 3, v4
    v_mul_u32_u24 v4, 31, v5
    v_add_u32 v4, s47, v4
    v_mul_u32_u24 v4, 0x2ab, v4
    v_lshrrev_b32 v4, 16, v4
    v_lshl_add_u32 v4, v4, 4, s63
    v_lshlrev_b32 v201, 3, v4
    s_mov_b32 s47, 25165824
    s_cmp_eq_u32 s38, 4
    s_cselect_b32 s47, s47, 0x7ff00000
    buffer_load_dwordx2 v[192:193], v200, s[28:31], s47 offen sc1
    buffer_load_dwordx2 v[194:195], v201, s[28:31], s47 offen sc1
    s_waitcnt vmcnt(0)
    s_cmp_lg_u32 s38, 7
    s_cbranch_scc1 Lnq_86
    s_mov_b32 s48, 0
    v_mov_b32 v4, 0
Lnp_88:
    v_readfirstlane_b32 s40, v52
    v_readfirstlane_b32 s41, v53
    s_cmp_lg_u32 s40, 0
    s_cbranch_scc1 Lnok_87
    buffer_load_dwordx2 v[52:53], v4, s[32:35], 0 offen sc1
    s_waitcnt vmcnt(0)
    s_add_u32 s48, s48, 1
    s_cmp_lt_u32 s48, 262144
    s_cbranch_scc1 Lnp_88
Lnok_87:
    v_mov_b32 v4, 162184
    ds_write_b64 v4, v[52:53]
Lnq_86:
    s_waitcnt lgkmcnt(0)
    s_barrier
    v_mov_b32 v4, 162184
    ds_read_b64 v[52:53], v4
    s_waitcnt lgkmcnt(0)
    v_readfirstlane_b32 s40, v52
    v_readfirstlane_b32 s41, v53
    s_nop 0
    v_mov_b32 v4, s40
    v_mov_b32 v5, s41
    v_mov_b32 v6, 0
    s_mov_b64 exec, 1
    buffer_store_dwordx2 v[4:5], v6, s[28:31], s54 offen sc1
    s_mov_b64 exec, -1
    v_mov_b32 v4, s40
    v_mov_b32 v5, s41
    v_mov_b32 v6, 0
    s_mov_b64 exec, 1
    buffer_store_dwordx2 v[4:5], v6, s[28:31], s82 offen sc1
    s_mov_b64 exec, -1
    s_mov_b32 s55, 0x7ff00000
    s_mov_b32 s53, 0x7ff00000
    s_mov_b32 s91, 0x7ff00000
    s_mov_b32 s92, 0x7ff00000
    s_mov_b32 s93, 0x7ff00000
    s_cmp_lt_u32 s38, 4
    s_cbranch_scc1 LJA2
    s_branch LJB
LA:
    s_cmp_ge_u32 s38, 1
    s_cbranch_scc1 Lcp_89
    s_getpc_b64 s[48:49]
Lpc:
    s_sub_u32 s48, s48, Lpc-sequential_preLN__softmax_full_mha__dense_activation_relu__prompt_kernel
    s_subb_u32 s49, s49, 0
    s_lshr_b32 s47, s46, 3
    s_lshl3_add_u32 s47, s38, s47
    s_and_b32 s47, s47, 31
    s_lshl_b32 s47, s47, 4
    v_and_b32 v4, 15, v0
    v_add_lshl_u32 v4, v4, s47, 7
    v_min_u32 v4, Lcode_end-sequential_preLN__softmax_full_mha__dense_activation_relu__prompt_kernel-4, v4
    v_mov_b32 v5, s49
    v_add_co_u32 v4, vcc, s48, v4
    s_nop 1
    v_addc_co_u32 v5, vcc, 0, v5, vcc
    global_load_dword v62, v[4:5], off
Lcp_89:
    s_cmp_ge_u32 s2, 224
    s_cbranch_scc1 LF
    s_lshl_b32 s50, s83, 2
    s_add_u32 s50, s50, s39
    s_mul_i32 s50, s50, 86016
    s_mul_i32 s51, s82, 3
    s_add_u32 s52, s51, 0
    s_lshl_b32 s47, s52, 11
    s_lshl_b32 s48, s52, 9
    s_add_u32 s48, s48, 43008
    s_cmp_ge_u32 s52, 28
    s_cselect_b32 s47, s48, s47
    s_movk_i32 s48, 0x400
    s_cselect_b32 s48, 14336, s48
    s_add_u32 s86, s47, s50
    s_add_u32 s87, s86, s48
    s_cmp_lt_u32 s52, 14
    s_cselect_b32 s92, 0x3e8b97f6, 1.0
    s_add_u32 s52, s51, 1
    s_lshl_b32 s47, s52, 11
    s_lshl_b32 s48, s52, 9
    s_add_u32 s48, s48, 43008
    s_cmp_ge_u32 s52, 28
    s_cselect_b32 s47, s48, s47
    s_movk_i32 s48, 0x400
    s_cselect_b32 s48, 14336, s48
    s_add_u32 s88, s47, s50
    s_add_u32 s89, s88, s48
    s_cmp_lt_u32 s52, 14
    s_cselect_b32 s93, 0x3e8b97f6, 1.0
    s_add_u32 s52, s51, 2
    s_lshl_b32 s47, s52, 11
    s_lshl_b32 s48, s52, 9
    s_add_u32 s48, s48, 43008
    s_cmp_ge_u32 s52, 28
    s_cselect_b32 s47, s48, s47
    s_movk_i32 s48, 0x400
    s_cselect_b32 s48, 14336, s48
    s_add_u32 s90, s47, s50
    s_add_u32 s91, s90, s48
    s_cmp_lt_u32 s52, 14
    s_cselect_b32 s94, 0x3e8b97f6, 1.0
    v_mul_u32_u24 v22, 0x1c00, v3
    v_lshl_add_u32 v22, v2, 4, v22
    v_bfe_u32 v4, v2, 1, 3
    v_xor_b32 v4, v4, v3
    v_lshlrev_b32 v4, 4, v4
    s_lshl_b32 s47, s39, 12
    v_lshl_add_u32 v4, v2, 7, v4
    v_add_u32 v12, s47, v4
    v_xor_b32 v13, 32, v12
    v_xor_b32 v14, 64, v12
    v_xor_b32 v15, 96, v12
    v_bfe_u32 v4, v0, 2, 2
    v_lshl_add_u32 v4, v3, 3, v4
    v_mul_u32_u24 v4, 0xc0, v4
    v_bfe_u32 v5, v0, 4, 1
    v_lshl_add_u32 v4, v5, 5, v4
    v_and_b32 v5, 3, v0
    v_lshl_add_u32 v4, v5, 3, v4
    v_add_u32 v20, 81920, v4
    s_lshl_b32 s47, s38, 8
    s_add_u32 s47, s47, 158720
    v_lshl_add_u32 v16, v0, 2, s47
    v_and_b32 v4, 3, v0
    v_lshlrev_b32 v4, 8, v4
    v_lshl_add_u32 v4, v0, 2, v4
    v_add_u32 v17, 159744, v4
    v_mov_b32 v18, 0
    s_mov_b32 s55, 0xffff0000
    s_mov_b32 s48, 0x00020001
    s_mov_b32 s49, 0x00020001
    v_mov_b32 v4, 0x3f803f80
    v_cndmask_b32 v56, 0, v4, s[48:49]
    v_mov_b32 v57, v56
    v_mov_b32 v58, v56
    v_mov_b32 v59, v56
    v_mov_b32 v64, 0
    v_mov_b32 v65, 0
    v_mov_b32 v66, 0
    v_mov_b32 v67, 0
    v_mov_b32 v68, 0
    v_mov_b32 v69, 0
    v_mov_b32 v70, 0
    v_mov_b32 v71, 0
    v_mov_b32 v72, 0
    v_mov_b32 v73, 0
    v_mov_b32 v74, 0
    v_mov_b32 v75, 0
    v_mov_b32 v76, 0
    v_mov_b32 v77, 0
    v_mov_b32 v78, 0
    v_mov_b32 v79, 0
    v_mov_b32 v80, 0
    v_mov_b32 v81, 0
    v_mov_b32 v82, 0
    v_mov_b32 v83, 0
    v_mov_b32 v84, 0
    v_mov_b32 v85, 0
    v_mov_b32 v86, 0
    v_mov_b32 v87, 0
    v_mov_b32 v88, 0
    v_mov_b32 v89, 0
    v_mov_b32 v90, 0
    v_mov_b32 v91, 0
    v_mov_b32 v92, 0
    v_mov_b32 v93, 0
    v_mov_b32 v94, 0
    v_mov_b32 v95, 0
    v_mov_b32 v96, 0
    v_mov_b32 v97, 0
    v_mov_b32 v98, 0
    v_mov_b32 v99, 0
    v_mov_b32 v100, 0
    v_mov_b32 v101, 0
    v_mov_b32 v102, 0
    v_mov_b32 v103, 0
    v_mov_b32 v104, 0
    v_mov_b32 v105, 0
    v_mov_b32 v106, 0
    v_mov_b32 v107, 0
    v_mov_b32 v108, 0
    v_mov_b32 v109, 0
    v_mov_b32 v110, 0
    v_mov_b32 v111, 0
    v_mov_b32 v40, 0
    v_mov_b32 v41, 0
    v_mov_b32 v42, 0
    v_mov_b32 v43, 0
    v_mov_b32 v44, 0
    v_mov_b32 v45, 0
    v_mov_b32 v46, 0
    v_mov_b32 v47, 0
    v_mov_b32 v48, 0
    v_mov_b32 v49, 0
    v_mov_b32 v50, 0
    v_mov_b32 v51, 0
    v_mov_b32 v200, -1
    v_mov_b32 v201, -1
    v_mov_b32 v202, -1
    v_mov_b32 v203, -1
    s_waitcnt lgkmcnt(0)
    s_mov_b32 s4, s64
    s_mov_b32 s5, s65
    s_mov_b32 s6, 1835008
    s_mov_b32 s7, 0x00020000
    s_mov_b32 s12, s68
    s_mov_b32 s13, s69
    s_mov_b32 s14, 401408
    s_mov_b32 s15, 0x00020000
    s_mov_b32 s16, s72
    s_mov_b32 s17, s73
    s_mov_b32 s18, 1605632
    s_mov_b32 s19, 0x00020000
    s_mov_b32 s20, s74
    s_mov_b32 s21, s75
    s_mov_b32 s22, 1605632
    s_mov_b32 s23, 0x00020000
    s_mov_b32 s24, s76
    s_mov_b32 s25, s77
    s_mov_b32 s26, 1835008
    s_mov_b32 s27, 0x00020000
    s_mov_b32 s28, s80
    s_mov_b32 s29, s81
    s_mov_b32 s30, 33554432
    s_mov_b32 s31, 0x00020000
    s_mov_b32 s32, s78
    s_mov_b32 s33, s79
    s_mov_b32 s34, 256
    s_mov_b32 s35, 0x00020000
    s_and_b32 s36, s46, 7
    s_lshl_b32 s62, s36, 1
    s_bfe_u32 s47, s46, 0x10003
    s_add_u32 s62, s62, s47
    s_lshr_b32 s63, s46, 4
    s_lshr_b32 s47, s46, 7
    s_lshl_b32 s47, s47, 3
    s_add_u32 s36, s36, s47
    s_bfe_u32 s37, s46, 0x40003
    s_mov_b32 s42, 0
    s_mov_b32 s43, -1
    s_mov_b32 s44, 0xF0000000
    s_mov_b32 s45, 0xF0000000
    s_mov_b32 s3, 0
    s_or_b32 s47, s46, s38
    s_cmp_lg_u32 s47, 0
    s_cbranch_scc1 Lnw_90
    s_memrealtime s[40:41]
    s_waitcnt lgkmcnt(0)
    s_or_b32 s40, s40, 1
    s_lshl_b32 s41, s41, 4
    v_mov_b32 v4, s40
    v_mov_b32 v5, s41
    v_mov_b32 v6, 0
    s_mov_b64 exec, 1
    buffer_store_dwordx2 v[4:5], v6, s[32:35], 0 offen sc1
    s_mov_b64 exec, -1
Lnw_90:
    s_cmp_eq_u32 s82, 9
    s_cbranch_scc1 LA1
    s_cmp_gt_u32 s82, 9
    s_cbranch_scc1 LA2
LA0:
    v_mov_b32 v204, v1
    s_mov_b32 s58, s86
    s_mov_b32 s59, s87
Lap_91:
    ds_read_b32 v19, v17
    s_waitcnt lgkmcnt(0)
    v_cmp_gt_u32 vcc, 1, v19
    s_sleep 1
    s_nop 3
    s_cbranch_vccnz Lap_91
    ds_read_b128 v[24:27], v12
    ds_read_b64_tr_b16 v[112:113], v20 offset:0
    ds_read_b64_tr_b16 v[114:115], v20 offset:768
    ds_read_b64_tr_b16 v[116:117], v20 offset:64
    ds_read_b64_tr_b16 v[118:119], v20 offset:832
    ds_read_b64_tr_b16 v[120:121], v20 offset:128
    ds_read_b64_tr_b16 v[122:123], v20 offset:896
    ds_read_b128 v[28:31], v13
    ds_read_b64_tr_b16 v[124:125], v20 offset:3072
    ds_read_b64_tr_b16 v[126:127], v20 offset:3840
    ds_read_b64_tr_b16 v[128:129], v20 offset:3136
    ds_read_b64_tr_b16 v[130:131], v20 offset:3904
    ds_read_b64_tr_b16 v[132:133], v20 offset:3200
    ds_read_b64_tr_b16 v[134:135], v20 offset:3968
    s_mov_b32 s57, 1
Lp10:
    s_cmp_gt_u32 s57, 3
    s_cbranch_scc1 Lnw_92
    buffer_store_dwordx4 v[200:203], v204, s[28:31], s58 offen sc1
Lnw_92:
    s_waitcnt lgkmcnt(7)
    v_mfma_f32_32x32x16_bf16 v[64:79], v[112:115], v[24:27], v[64:79]
    ds_read_b128 v[32:35], v14
    ds_read_b64_tr_b16 v[136:137], v20 offset:6144
    ds_read_b64_tr_b16 v[138:139], v20 offset:6912
    v_lshlrev_b32 v4, 16, v24
    v_and_b32 v5, s55, v24
    v_lshlrev_b32 v6, 16, v25
    v_and_b32 v7, s55, v25
    v_mfma_f32_32x32x16_bf16 v[80:95], v[116:119], v[24:27], v[80:95]
    ds_read_b64_tr_b16 v[140:141], v20 offset:6208
    ds_read_b64_tr_b16 v[142:143], v20 offset:6976
    v_fmac_f32 v48, v4, v4
    v_fmac_f32 v49, v5, v5
    v_fmac_f32 v50, v6, v6
    v_fmac_f32 v51, v7, v7
    v_lshlrev_b32 v4, 16, v26
    v_mfma_f32_32x32x16_bf16 v[96:111], v[120:123], v[24:27], v[96:111]
    ds_read_b64_tr_b16 v[144:145], v20 offset:6272
    ds_read_b64_tr_b16 v[146:147], v20 offset:7040
    v_and_b32 v5, s55, v26
    v_lshlrev_b32 v6, 16, v27
    v_and_b32 v7, s55, v27
    v_fmac_f32 v48, v4, v4
    v_fmac_f32 v49, v5, v5
    v_mfma_f32_16x16x32_bf16 v[40:43], v[56:59], v[24:27], v[40:43]
    v_fmac_f32 v50, v6, v6
    v_fmac_f32 v51, v7, v7
    s_waitcnt lgkmcnt(7)
    v_mfma_f32_32x32x16_bf16 v[64:79], v[124:127], v[28:31], v[64:79]
    ds_read_b32 v19, v17
    ds_read_b128 v[36:39], v15
    ds_read_b64_tr_b16 v[148:149], v20 offset:9216
    v_lshlrev_b32 v4, 16, v28
    v_and_b32 v5, s55, v28
    v_lshlrev_b32 v6, 16, v29
    v_and_b32 v7, s55, v29
    v_mfma_f32_32x32x16_bf16 v[80:95], v[128:131], v[28:31], v[80:95]
    ds_read_b64_tr_b16 v[150:151], v20 offset:9984
    ds_read_b64_tr_b16 v[152:153], v20 offset:9280
    ds_read_b64_tr_b16 v[154:155], v20 offset:10048
    v_fmac_f32 v48, v4, v4
    v_fmac_f32 v49, v5, v5
    v_fmac_f32 v50, v6, v6
    v_fmac_f32 v51, v7, v7
    v_lshlrev_b32 v4, 16, v30
    v_mfma_f32_32x32x16_bf16 v[96:111], v[132:135], v[28:31], v[96:111]
    ds_read_b64_tr_b16 v[156:157], v20 offset:9344
    ds_read_b64_tr_b16 v[158:159], v20 offset:10112
    v_and_b32 v5, s55, v30
    v_lshlrev_b32 v6, 16, v31
    v_and_b32 v7, s55, v31
    v_fmac_f32 v48, v4, v4
    v_fmac_f32 v49, v5, v5
    v_mfma_f32_16x16x32_bf16 v[40:43], v[56:59], v[28:31], v[40:43]
    v_fmac_f32 v50, v6, v6
    v_fmac_f32 v51, v7, v7
    s_cmp_eq_u32 s57, 7
    s_cbranch_scc1 Lp1e0
    s_cmp_eq_u32 s57, 5
    s_cselect_b32 s47, -4, 1
    s_mul_i32 s48, s47, 12288
    s_lshl_b32 s47, s47, 14
    v_add_u32 v18, 1, v18
    s_cmp_gt_u32 s57, 3
    s_cbranch_scc1 Lnw_93
    buffer_store_dwordx4 v[200:203], v204, s[28:31], s59 offen sc1
    v_mov_b32 v204, v1
    s_cmp_eq_u32 s57, 1
    s_cselect_b32 s58, s88, s90
    s_cselect_b32 s59, s89, s91
Lnw_93:
    s_cmp_lt_u32 s57, 4
    s_cbranch_scc1 Lnc_94
    s_waitcnt vmcnt(0)
Lnc_94:
    ds_write_b32 v16, v18
    s_waitcnt lgkmcnt(8)
    v_cmp_ge_u32 vcc, s57, v19
    v_mfma_f32_32x32x16_bf16 v[64:79], v[136:139], v[32:35], v[64:79]
    v_lshlrev_b32 v4, 16, v32
    v_and_b32 v5, s55, v32
    v_lshlrev_b32 v6, 16, v33
    v_and_b32 v7, s55, v33
    s_cbranch_vccnz Lsp0
Lsd0:
    v_add_u32 v12, s47, v12
    v_add_u32 v13, s47, v13
    v_add_u32 v14, s47, v14
    v_add_u32 v15, s47, v15
    v_add_u32 v20, s48, v20
    v_mfma_f32_32x32x16_bf16 v[80:95], v[140:143], v[32:35], v[80:95]
    ds_read_b128 v[24:27], v12
    ds_read_b64_tr_b16 v[112:113], v20 offset:0
    ds_read_b64_tr_b16 v[114:115], v20 offset:768
    ds_read_b64_tr_b16 v[116:117], v20 offset:64
    v_fmac_f32 v48, v4, v4
    v_fmac_f32 v49, v5, v5
    v_fmac_f32 v50, v6, v6
    v_fmac_f32 v51, v7, v7
    v_lshlrev_b32 v4, 16, v34
    v_mfma_f32_32x32x16_bf16 v[96:111], v[144:147], v[32:35], v[96:111]
    ds_read_b64_tr_b16 v[118:119], v20 offset:832
    ds_read_b64_tr_b16 v[120:121], v20 offset:128
    ds_read_b64_tr_b16 v[122:123], v20 offset:896
    v_and_b32 v5, s55, v34
    v_lshlrev_b32 v6, 16, v35
    v_and_b32 v7, s55, v35
    v_fmac_f32 v48, v4, v4
    v_fmac_f32 v49, v5, v5
    v_mfma_f32_16x16x32_bf16 v[40:43], v[56:59], v[32:35], v[40:43]
    v_fmac_f32 v50, v6, v6
    v_fmac_f32 v51, v7, v7
    s_waitcnt lgkmcnt(7)
    v_mfma_f32_32x32x16_bf16 v[64:79], v[148:151], v[36:39], v[64:79]
    ds_read_b128 v[28:31], v13
    ds_read_b64_tr_b16 v[124:125], v20 offset:3072
    ds_read_b64_tr_b16 v[126:127], v20 offset:3840
    v_lshlrev_b32 v4, 16, v36
    v_and_b32 v5, s55, v36
    v_lshlrev_b32 v6, 16, v37
    v_and_b32 v7, s55, v37
    v_mfma_f32_32x32x16_bf16 v[80:95], v[152:155], v[36:39], v[80:95]
    ds_read_b64_tr_b16 v[128:129], v20 offset:3136
    ds_read_b64_tr_b16 v[130:131], v20 offset:3904
    v_fmac_f32 v48, v4, v4
    v_fmac_f32 v49, v5, v5
    v_fmac_f32 v50, v6, v6
    v_fmac_f32 v51, v7, v7
    v_lshlrev_b32 v4, 16, v38
    v_mfma_f32_32x32x16_bf16 v[96:111], v[156:159], v[36:39], v[96:111]
    ds_read_b64_tr_b16 v[132:133], v20 offset:3200
    ds_read_b64_tr_b16 v[134:135], v20 offset:3968
    v_and_b32 v5, s55, v38
    v_lshlrev_b32 v6, 16, v39
    v_and_b32 v7, s55, v39
    v_fmac_f32 v48, v4, v4
    v_fmac_f32 v49, v5, v5
    v_mfma_f32_16x16x32_bf16 v[40:43], v[56:59], v[36:39], v[40:43]
    v_fmac_f32 v50, v6, v6
    v_fmac_f32 v51, v7, v7
    s_add_u32 s57, s57, 1
    s_branch Lp10
Lsp0:
Lsp0x:
    ds_read_b32 v19, v17
    s_waitcnt lgkmcnt(0)
    v_cmp_ge_u32 vcc, s57, v19
    s_nop 4
    s_cbranch_vccnz Lsp0x
    s_branch Lsd0
Lp1e0:
    v_lshlrev_b32 v9, 2, v2
    s_lshl_b32 s47, s39, 7
    s_add_u32 s47, s47, 160768
    v_add_u32 v10, s47, v9
    v_add_u32 v9, 161792, v9
    v_lshl_add_u32 v11, v3, 4, s47
    v_lshlrev_b32 v8, 4, v3
    v_add_u32 v8, 161792, v8
    s_waitcnt lgkmcnt(7)
    v_mfma_f32_32x32x16_bf16 v[64:79], v[136:139], v[32:35], v[64:79]
    v_lshlrev_b32 v4, 16, v32
    v_and_b32 v5, s55, v32
    v_lshlrev_b32 v6, 16, v33
    v_and_b32 v7, s55, v33
    v_mfma_f32_32x32x16_bf16 v[80:95], v[140:143], v[32:35], v[80:95]
    v_fmac_f32 v48, v4, v4
    v_fmac_f32 v49, v5, v5
    v_fmac_f32 v50, v6, v6
    v_fmac_f32 v51, v7, v7
    v_lshlrev_b32 v4, 16, v34
    v_mfma_f32_32x32x16_bf16 v[96:111], v[144:147], v[32:35], v[96:111]
    v_and_b32 v5, s55, v34
    v_lshlrev_b32 v6, 16, v35
    v_and_b32 v7, s55, v35
    v_fmac_f32 v48, v4, v4
    v_fmac_f32 v49, v5, v5
    v_mfma_f32_16x16x32_bf16 v[40:43], v[56:59], v[32:35], v[40:43]
    v_fmac_f32 v50, v6, v6
    v_fmac_f32 v51, v7, v7
    s_waitcnt lgkmcnt(0)
    s_barrier
    s_waitcnt lgkmcnt(0)
    v_mfma_f32_32x32x16_bf16 v[64:79], v[148:151], v[36:39], v[64:79]
    ds_read_b128 v[208:211], v8 offset:0
    ds_read_b128 v[212:215], v8 offset:32
    ds_read_b128 v[216:219], v8 offset:64
    v_lshlrev_b32 v4, 16, v36
    v_and_b32 v5, s55, v36
    v_lshlrev_b32 v6, 16, v37
    v_and_b32 v7, s55, v37
    v_mfma_f32_32x32x16_bf16 v[80:95], v[152:155], v[36:39], v[80:95]
    ds_read_b128 v[220:223], v8 offset:96
    ds_read_b128 v[224:227], v8 offset:128
    v_fmac_f32 v48, v4, v4
    v_fmac_f32 v49, v5, v5
    v_fmac_f32 v50, v6, v6
    v_fmac_f32 v51, v7, v7
    v_lshlrev_b32 v4, 16, v38
    v_mfma_f32_32x32x16_bf16 v[96:111], v[156:159], v[36:39], v[96:111]
    ds_read_b128 v[228:231], v8 offset:160
    ds_read_b128 v[232:235], v8 offset:192
    ds_read_b128 v[236:239], v8 offset:224
    ds_read_b128 v[240:243], v8 offset:256
    ds_read_b128 v[244:247], v8 offset:288
    ds_read_b128 v[248:251], v8 offset:320
    ds_read_b128 v[252:255], v8 offset:352
    v_and_b32 v5, s55, v38
    v_lshlrev_b32 v6, 16, v39
    v_and_b32 v7, s55, v39
    v_fmac_f32 v48, v4, v4
    v_fmac_f32 v49, v5, v5
    v_mfma_f32_16x16x32_bf16 v[40:43], v[56:59], v[36:39], v[40:43]
    v_fmac_f32 v50, v6, v6
    v_fmac_f32 v51, v7, v7
    v_add_f32 v48, v48, v49
    v_add_f32 v50, v50, v51
    v_add_f32 v52, v48, v50
    v_mov_b32 v48, v52
    s_nop 1
    v_permlane32_swap_b32 v48, v52
    v_add_f32 v52, v48, v52
    v_permlane16_swap_b32 v40, v41
    v_mov_b32 v53, v40
    s_nop 1
    v_permlane32_swap_b32 v53, v40
    v_mul_f32 v53, 0x3b124925, v53
    v_mul_f32 v52, 0x3b124925, v52
    v_fma_f32 v52, -v53, v53, v52
    v_max_f32 v52, 0, v52
    v_add_f32 v52, 0x3727c5ac, v52
    v_rsq_f32 v52, v52
    s_nop 0
    v_mul_f32 v53, v53, v52
    v_sub_f32 v53, 0, v53
    v_mul_f32 v54, s92, v52
    v_mul_f32 v55, s92, v53
    s_waitcnt lgkmcnt(10)
    v_pk_mul_f32 v[64:65], v[64:65], v[54:55] op_sel:[0,0] op_sel_hi:[1,0]
    v_pk_mul_f32 v[66:67], v[66:67], v[54:55] op_sel:[0,0] op_sel_hi:[1,0]
    v_pk_mul_f32 v[68:69], v[68:69], v[54:55] op_sel:[0,0] op_sel_hi:[1,0]
    v_pk_mul_f32 v[70:71], v[70:71], v[54:55] op_sel:[0,0] op_sel_hi:[1,0]
    v_pk_fma_f32 v[64:65], v[208:209], v[54:55], v[64:65] op_sel:[0,1,0] op_sel_hi:[1,1,1]
    v_pk_fma_f32 v[66:67], v[210:211], v[54:55], v[66:67] op_sel:[0,1,0] op_sel_hi:[1,1,1]
    v_pk_fma_f32 v[68:69], v[212:213], v[54:55], v[68:69] op_sel:[0,1,0] op_sel_hi:[1,1,1]
    v_pk_fma_f32 v[70:71], v[214:215], v[54:55], v[70:71] op_sel:[0,1,0] op_sel_hi:[1,1,1]
    v_cvt_pk_bf16_f32 v64, v64, v65
    v_cvt_pk_bf16_f32 v65, v66, v67
    v_cvt_pk_bf16_f32 v66, v68, v69
    v_cvt_pk_bf16_f32 v67, v70, v71
    s_nop 0
    v_permlane32_swap_b32 v64, v66
    v_permlane32_swap_b32 v65, v67
    v_min_u32 v64, -2, v64
    buffer_store_dwordx4 v[64:67], v1, s[28:31], s86 offen sc1
    s_waitcnt lgkmcnt(8)
    v_pk_mul_f32 v[72:73], v[72:73], v[54:55] op_sel:[0,0] op_sel_hi:[1,0]
    v_pk_mul_f32 v[74:75], v[74:75], v[54:55] op_sel:[0,0] op_sel_hi:[1,0]
    v_pk_mul_f32 v[76:77], v[76:77], v[54:55] op_sel:[0,0] op_sel_hi:[1,0]
    v_pk_mul_f32 v[78:79], v[78:79], v[54:55] op_sel:[0,0] op_sel_hi:[1,0]
    v_pk_fma_f32 v[72:73], v[216:217], v[54:55], v[72:73] op_sel:[0,1,0] op_sel_hi:[1,1,1]
    v_pk_fma_f32 v[74:75], v[218:219], v[54:55], v[74:75] op_sel:[0,1,0] op_sel_hi:[1,1,1]
    v_pk_fma_f32 v[76:77], v[220:221], v[54:55], v[76:77] op_sel:[0,1,0] op_sel_hi:[1,1,1]
    v_pk_fma_f32 v[78:79], v[222:223], v[54:55], v[78:79] op_sel:[0,1,0] op_sel_hi:[1,1,1]
    v_cvt_pk_bf16_f32 v68, v72, v73
    v_cvt_pk_bf16_f32 v69, v74, v75
    v_cvt_pk_bf16_f32 v70, v76, v77
    v_cvt_pk_bf16_f32 v71, v78, v79
    s_nop 0
    v_permlane32_swap_b32 v68, v70
    v_permlane32_swap_b32 v69, v71
    v_min_u32 v68, -2, v68
    buffer_store_dwordx4 v[68:71], v1, s[28:31], s87 offen sc1
    v_mul_f32 v54, s93, v52
    v_mul_f32 v55, s93, v53
    s_waitcnt lgkmcnt(6)
    v_pk_mul_f32 v[80:81], v[80:81], v[54:55] op_sel:[0,0] op_sel_hi:[1,0]
    v_pk_mul_f32 v[82:83], v[82:83], v[54:55] op_sel:[0,0] op_sel_hi:[1,0]
    v_pk_mul_f32 v[84:85], v[84:85], v[54:55] op_sel:[0,0] op_sel_hi:[1,0]
    v_pk_mul_f32 v[86:87], v[86:87], v[54:55] op_sel:[0,0] op_sel_hi:[1,0]
    v_pk_fma_f32 v[80:81], v[224:225], v[54:55], v[80:81] op_sel:[0,1,0] op_sel_hi:[1,1,1]
    v_pk_fma_f32 v[82:83], v[226:227], v[54:55], v[82:83] op_sel:[0,1,0] op_sel_hi:[1,1,1]
    v_pk_fma_f32 v[84:85], v[228:229], v[54:55], v[84:85] op_sel:[0,1,0] op_sel_hi:[1,1,1]
    v_pk_fma_f32 v[86:87], v[230:231], v[54:55], v[86:87] op_sel:[0,1,0] op_sel_hi:[1,1,1]
    v_cvt_pk_bf16_f32 v80, v80, v81
    v_cvt_pk_bf16_f32 v81, v82, v83
    v_cvt_pk_bf16_f32 v82, v84, v85
    v_cvt_pk_bf16_f32 v83, v86, v87
    s_nop 0
    v_permlane32_swap_b32 v80, v82
    v_permlane32_swap_b32 v81, v83
    v_min_u32 v80, -2, v80
    buffer_store_dwordx4 v[80:83], v1, s[28:31], s88 offen sc1
    s_waitcnt lgkmcnt(4)
    v_pk_mul_f32 v[88:89], v[88:89], v[54:55] op_sel:[0,0] op_sel_hi:[1,0]
    v_pk_mul_f32 v[90:91], v[90:91], v[54:55] op_sel:[0,0] op_sel_hi:[1,0]
    v_pk_mul_f32 v[92:93], v[92:93], v[54:55] op_sel:[0,0] op_sel_hi:[1,0]
    v_pk_mul_f32 v[94:95], v[94:95], v[54:55] op_sel:[0,0] op_sel_hi:[1,0]
    v_pk_fma_f32 v[88:89], v[232:233], v[54:55], v[88:89] op_sel:[0,1,0] op_sel_hi:[1,1,1]
    v_pk_fma_f32 v[90:91], v[234:235], v[54:55], v[90:91] op_sel:[0,1,0] op_sel_hi:[1,1,1]
    v_pk_fma_f32 v[92:93], v[236:237], v[54:55], v[92:93] op_sel:[0,1,0] op_sel_hi:[1,1,1]
    v_pk_fma_f32 v[94:95], v[238:239], v[54:55], v[94:95] op_sel:[0,1,0] op_sel_hi:[1,1,1]
    v_cvt_pk_bf16_f32 v84, v88, v89
    v_cvt_pk_bf16_f32 v85, v90, v91
    v_cvt_pk_bf16_f32 v86, v92, v93
    v_cvt_pk_bf16_f32 v87, v94, v95
    s_nop 0
    v_permlane32_swap_b32 v84, v86
    v_permlane32_swap_b32 v85, v87
    v_min_u32 v84, -2, v84
    buffer_store_dwordx4 v[84:87], v1, s[28:31], s89 offen sc1
    v_mul_f32 v54, s94, v52
    v_mul_f32 v55, s94, v53
    s_waitcnt lgkmcnt(2)
    v_pk_mul_f32 v[96:97], v[96:97], v[54:55] op_sel:[0,0] op_sel_hi:[1,0]
    v_pk_mul_f32 v[98:99], v[98:99], v[54:55] op_sel:[0,0] op_sel_hi:[1,0]
    v_pk_mul_f32 v[100:101], v[100:101], v[54:55] op_sel:[0,0] op_sel_hi:[1,0]
    v_pk_mul_f32 v[102:103], v[102:103], v[54:55] op_sel:[0,0] op_sel_hi:[1,0]
    v_pk_fma_f32 v[96:97], v[240:241], v[54:55], v[96:97] op_sel:[0,1,0] op_sel_hi:[1,1,1]
    v_pk_fma_f32 v[98:99], v[242:243], v[54:55], v[98:99] op_sel:[0,1,0] op_sel_hi:[1,1,1]
    v_pk_fma_f32 v[100:101], v[244:245], v[54:55], v[100:101] op_sel:[0,1,0] op_sel_hi:[1,1,1]
    v_pk_fma_f32 v[102:103], v[246:247], v[54:55], v[102:103] op_sel:[0,1,0] op_sel_hi:[1,1,1]
    v_cvt_pk_bf16_f32 v96, v96, v97
    v_cvt_pk_bf16_f32 v97, v98, v99
    v_cvt_pk_bf16_f32 v98, v100, v101
    v_cvt_pk_bf16_f32 v99, v102, v103
    s_nop 0
    v_permlane32_swap_b32 v96, v98
    v_permlane32_swap_b32 v97, v99
    v_min_u32 v96, -2, v96
    buffer_store_dwordx4 v[96:99], v1, s[28:31], s90 offen sc1
    s_waitcnt lgkmcnt(0)
    v_pk_mul_f32 v[104:105], v[104:105], v[54:55] op_sel:[0,0] op_sel_hi:[1,0]
    v_pk_mul_f32 v[106:107], v[106:107], v[54:55] op_sel:[0,0] op_sel_hi:[1,0]
    v_pk_mul_f32 v[108:109], v[108:109], v[54:55] op_sel:[0,0] op_sel_hi:[1,0]
    v_pk_mul_f32 v[110:111], v[110:111], v[54:55] op_sel:[0,0] op_sel_hi:[1,0]
    v_pk_fma_f32 v[104:105], v[248:249], v[54:55], v[104:105] op_sel:[0,1,0] op_sel_hi:[1,1,1]
    v_pk_fma_f32 v[106:107], v[250:251], v[54:55], v[106:107] op_sel:[0,1,0] op_sel_hi:[1,1,1]
    v_pk_fma_f32 v[108:109], v[252:253], v[54:55], v[108:109] op_sel:[0,1,0] op_sel_hi:[1,1,1]
    v_pk_fma_f32 v[110:111], v[254:255], v[54:55], v[110:111] op_sel:[0,1,0] op_sel_hi:[1,1,1]
    v_cvt_pk_bf16_f32 v100, v104, v105
    v_cvt_pk_bf16_f32 v101, v106, v107
    v_cvt_pk_bf16_f32 v102, v108, v109
    v_cvt_pk_bf16_f32 v103, v110, v111
    s_nop 0
    v_permlane32_swap_b32 v100, v102
    v_permlane32_swap_b32 v101, v103
    v_min_u32 v100, -2, v100
    buffer_store_dwordx4 v[100:103], v1, s[28:31], s91 offen sc1
    s_branch LJA
LA1:
    v_mov_b32 v204, v1
    s_mov_b32 s58, s86
    s_mov_b32 s59, s87
Lap_95:
    ds_read_b32 v19, v17
    s_waitcnt lgkmcnt(0)
    v_cmp_gt_u32 vcc, 1, v19
    s_sleep 1
    s_nop 3
    s_cbranch_vccnz Lap_95
    ds_read_b128 v[24:27], v12
    ds_read_b64_tr_b16 v[112:113], v20 offset:0
    ds_read_b64_tr_b16 v[114:115], v20 offset:768
    ds_read_b64_tr_b16 v[116:117], v20 offset:64
    ds_read_b64_tr_b16 v[118:119], v20 offset:832
    ds_read_b64_tr_b16 v[120:121], v20 offset:128
    ds_read_b64_tr_b16 v[122:123], v20 offset:896
    ds_read_b128 v[28:31], v13
    ds_read_b64_tr_b16 v[124:125], v20 offset:3072
    ds_read_b64_tr_b16 v[126:127], v20 offset:3840
    ds_read_b64_tr_b16 v[128:129], v20 offset:3136
    ds_read_b64_tr_b16 v[130:131], v20 offset:3904
    ds_read_b64_tr_b16 v[132:133], v20 offset:3200
    ds_read_b64_tr_b16 v[134:135], v20 offset:3968
    s_mov_b32 s57, 1
Lp11:
    s_cmp_gt_u32 s57, 3
    s_cbranch_scc1 Lnw_96
    buffer_store_dwordx4 v[200:203], v204, s[28:31], s58 offen sc1
Lnw_96:
    s_waitcnt lgkmcnt(7)
    v_mfma_f32_32x32x16_bf16 v[64:79], v[112:115], v[24:27], v[64:79]
    ds_read_b128 v[32:35], v14
    ds_read_b64_tr_b16 v[136:137], v20 offset:6144
    ds_read_b64_tr_b16 v[138:139], v20 offset:6912
    v_lshlrev_b32 v4, 16, v24
    v_and_b32 v5, s55, v24
    v_lshlrev_b32 v6, 16, v25
    v_and_b32 v7, s55, v25
    v_mfma_f32_32x32x16_bf16 v[80:95], v[24:27], v[116:119], v[80:95]
    ds_read_b64_tr_b16 v[140:141], v20 offset:6208
    ds_read_b64_tr_b16 v[142:143], v20 offset:6976
    v_fmac_f32 v48, v4, v4
    v_fmac_f32 v49, v5, v5
    v_fmac_f32 v50, v6, v6
    v_fmac_f32 v51, v7, v7
    v_lshlrev_b32 v4, 16, v26
    v_mfma_f32_32x32x16_bf16 v[96:111], v[24:27], v[120:123], v[96:111]
    ds_read_b64_tr_b16 v[144:145], v20 offset:6272
    ds_read_b64_tr_b16 v[146:147], v20 offset:7040
    v_and_b32 v5, s55, v26
    v_lshlrev_b32 v6, 16, v27
    v_and_b32 v7, s55, v27
    v_fmac_f32 v48, v4, v4
    v_fmac_f32 v49, v5, v5
    v_mfma_f32_16x16x32_bf16 v[40:43], v[56:59], v[24:27], v[40:43]
    v_fmac_f32 v50, v6, v6
    v_fmac_f32 v51, v7, v7
    s_waitcnt lgkmcnt(7)
    v_mfma_f32_32x32x16_bf16 v[64:79], v[124:127], v[28:31], v[64:79]
    ds_read_b32 v19, v17
    ds_read_b128 v[36:39], v15
    ds_read_b64_tr_b16 v[148:149], v20 offset:9216
    v_lshlrev_b32 v4, 16, v28
    v_and_b32 v5, s55, v28
    v_lshlrev_b32 v6, 16, v29
    v_and_b32 v7, s55, v29
    v_mfma_f32_32x32x16_bf16 v[80:95], v[28:31], v[128:131], v[80:95]
    ds_read_b64_tr_b16 v[150:151], v20 offset:9984
    ds_read_b64_tr_b16 v[152:153], v20 offset:9280
    ds_read_b64_tr_b16 v[154:155], v20 offset:10048
    v_fmac_f32 v48, v4, v4
    v_fmac_f32 v49, v5, v5
    v_fmac_f32 v50, v6, v6
    v_fmac_f32 v51, v7, v7
    v_lshlrev_b32 v4, 16, v30
    v_mfma_f32_32x32x16_bf16 v[96:111], v[28:31], v[132:135], v[96:111]
    ds_read_b64_tr_b16 v[156:157], v20 offset:9344
    ds_read_b64_tr_b16 v[158:159], v20 offset:10112
    v_and_b32 v5, s55, v30
    v_lshlrev_b32 v6, 16, v31
    v_and_b32 v7, s55, v31
    v_fmac_f32 v48, v4, v4
    v_fmac_f32 v49, v5, v5
    v_mfma_f32_16x16x32_bf16 v[40:43], v[56:59], v[28:31], v[40:43]
    v_fmac_f32 v50, v6, v6
    v_fmac_f32 v51, v7, v7
    s_cmp_eq_u32 s57, 7
    s_cbranch_scc1 Lp1e1
    s_cmp_eq_u32 s57, 5
    s_cselect_b32 s47, -4, 1
    s_mul_i32 s48, s47, 12288
    s_lshl_b32 s47, s47, 14
    v_add_u32 v18, 1, v18
    s_cmp_gt_u32 s57, 3
    s_cbranch_scc1 Lnw_97
    buffer_store_dwordx4 v[200:203], v204, s[28:31], s59 offen sc1
    v_mov_b32 v204, v22
    s_cmp_eq_u32 s57, 1
    s_cselect_b32 s58, s88, s90
    s_cselect_b32 s59, s89, s91
Lnw_97:
    s_cmp_lt_u32 s57, 4
    s_cbranch_scc1 Lnc_98
    s_waitcnt vmcnt(0)
Lnc_98:
    ds_write_b32 v16, v18
    s_waitcnt lgkmcnt(8)
    v_cmp_ge_u32 vcc, s57, v19
    v_mfma_f32_32x32x16_bf16 v[64:79], v[136:139], v[32:35], v[64:79]
    v_lshlrev_b32 v4, 16, v32
    v_and_b32 v5, s55, v32
    v_lshlrev_b32 v6, 16, v33
    v_and_b32 v7, s55, v33
    s_cbranch_vccnz Lsp1
Lsd1:
    v_add_u32 v12, s47, v12
    v_add_u32 v13, s47, v13
    v_add_u32 v14, s47, v14
    v_add_u32 v15, s47, v15
    v_add_u32 v20, s48, v20
    v_mfma_f32_32x32x16_bf16 v[80:95], v[32:35], v[140:143], v[80:95]
    ds_read_b128 v[24:27], v12
    ds_read_b64_tr_b16 v[112:113], v20 offset:0
    ds_read_b64_tr_b16 v[114:115], v20 offset:768
    ds_read_b64_tr_b16 v[116:117], v20 offset:64
    v_fmac_f32 v48, v4, v4
    v_fmac_f32 v49, v5, v5
    v_fmac_f32 v50, v6, v6
    v_fmac_f32 v51, v7, v7
    v_lshlrev_b32 v4, 16, v34
    v_mfma_f32_32x32x16_bf16 v[96:111], v[32:35], v[144:147], v[96:111]
    ds_read_b64_tr_b16 v[118:119], v20 offset:832
    ds_read_b64_tr_b16 v[120:121], v20 offset:128
    ds_read_b64_tr_b16 v[122:123], v20 offset:896
    v_and_b32 v5, s55, v34
    v_lshlrev_b32 v6, 16, v35
    v_and_b32 v7, s55, v35
    v_fmac_f32 v48, v4, v4
    v_fmac_f32 v49, v5, v5
    v_mfma_f32_16x16x32_bf16 v[40:43], v[56:59], v[32:35], v[40:43]
    v_fmac_f32 v50, v6, v6
    v_fmac_f32 v51, v7, v7
    s_waitcnt lgkmcnt(7)
    v_mfma_f32_32x32x16_bf16 v[64:79], v[148:151], v[36:39], v[64:79]
    ds_read_b128 v[28:31], v13
    ds_read_b64_tr_b16 v[124:125], v20 offset:3072
    ds_read_b64_tr_b16 v[126:127], v20 offset:3840
    v_lshlrev_b32 v4, 16, v36
    v_and_b32 v5, s55, v36
    v_lshlrev_b32 v6, 16, v37
    v_and_b32 v7, s55, v37
    v_mfma_f32_32x32x16_bf16 v[80:95], v[36:39], v[152:155], v[80:95]
    ds_read_b64_tr_b16 v[128:129], v20 offset:3136
    ds_read_b64_tr_b16 v[130:131], v20 offset:3904
    v_fmac_f32 v48, v4, v4
    v_fmac_f32 v49, v5, v5
    v_fmac_f32 v50, v6, v6
    v_fmac_f32 v51, v7, v7
    v_lshlrev_b32 v4, 16, v38
    v_mfma_f32_32x32x16_bf16 v[96:111], v[36:39], v[156:159], v[96:111]
    ds_read_b64_tr_b16 v[132:133], v20 offset:3200
    ds_read_b64_tr_b16 v[134:135], v20 offset:3968
    v_and_b32 v5, s55, v38
    v_lshlrev_b32 v6, 16, v39
    v_and_b32 v7, s55, v39
    v_fmac_f32 v48, v4, v4
    v_fmac_f32 v49, v5, v5
    v_mfma_f32_16x16x32_bf16 v[40:43], v[56:59], v[36:39], v[40:43]
    v_fmac_f32 v50, v6, v6
    v_fmac_f32 v51, v7, v7
    s_add_u32 s57, s57, 1
    s_branch Lp11
Lsp1:
Lsp1x:
    ds_read_b32 v19, v17
    s_waitcnt lgkmcnt(0)
    v_cmp_ge_u32 vcc, s57, v19
    s_nop 4
    s_cbranch_vccnz Lsp1x
    s_branch Lsd1
Lp1e1:
    v_lshlrev_b32 v9, 2, v2
    s_lshl_b32 s47, s39, 7
    s_add_u32 s47, s47, 160768
    v_add_u32 v10, s47, v9
    v_add_u32 v9, 161792, v9
    v_lshl_add_u32 v11, v3, 4, s47
    v_lshlrev_b32 v8, 4, v3
    v_add_u32 v8, 161792, v8
    s_waitcnt lgkmcnt(7)
    v_mfma_f32_32x32x16_bf16 v[64:79], v[136:139], v[32:35], v[64:79]
    v_lshlrev_b32 v4, 16, v32
    v_and_b32 v5, s55, v32
    v_lshlrev_b32 v6, 16, v33
    v_and_b32 v7, s55, v33
    v_mfma_f32_32x32x16_bf16 v[80:95], v[32:35], v[140:143], v[80:95]
    v_fmac_f32 v48, v4, v4
    v_fmac_f32 v49, v5, v5
    v_fmac_f32 v50, v6, v6
    v_fmac_f32 v51, v7, v7
    v_lshlrev_b32 v4, 16, v34
    v_mfma_f32_32x32x16_bf16 v[96:111], v[32:35], v[144:147], v[96:111]
    v_and_b32 v5, s55, v34
    v_lshlrev_b32 v6, 16, v35
    v_and_b32 v7, s55, v35
    v_fmac_f32 v48, v4, v4
    v_fmac_f32 v49, v5, v5
    v_mfma_f32_16x16x32_bf16 v[40:43], v[56:59], v[32:35], v[40:43]
    v_fmac_f32 v50, v6, v6
    v_fmac_f32 v51, v7, v7
    s_waitcnt lgkmcnt(0)
    s_barrier
    s_waitcnt lgkmcnt(0)
    v_mfma_f32_32x32x16_bf16 v[64:79], v[148:151], v[36:39], v[64:79]
    ds_read_b128 v[208:211], v8 offset:0
    ds_read_b128 v[212:215], v8 offset:32
    ds_read_b128 v[216:219], v8 offset:64
    v_lshlrev_b32 v4, 16, v36
    v_and_b32 v5, s55, v36
    v_lshlrev_b32 v6, 16, v37
    v_and_b32 v7, s55, v37
    v_mfma_f32_32x32x16_bf16 v[80:95], v[36:39], v[152:155], v[80:95]
    ds_read_b128 v[220:223], v8 offset:96
    ds_read_b32 v61, v9 offset:128
    v_fmac_f32 v48, v4, v4
    v_fmac_f32 v49, v5, v5
    v_fmac_f32 v50, v6, v6
    v_fmac_f32 v51, v7, v7
    v_lshlrev_b32 v4, 16, v38
    v_mfma_f32_32x32x16_bf16 v[96:111], v[36:39], v[156:159], v[96:111]
    ds_read_b32 v62, v9 offset:256
    v_and_b32 v5, s55, v38
    v_lshlrev_b32 v6, 16, v39
    v_and_b32 v7, s55, v39
    v_fmac_f32 v48, v4, v4
    v_fmac_f32 v49, v5, v5
    v_mfma_f32_16x16x32_bf16 v[40:43], v[56:59], v[36:39], v[40:43]
    v_fmac_f32 v50, v6, v6
    v_fmac_f32 v51, v7, v7
    v_add_f32 v48, v48, v49
    v_add_f32 v50, v50, v51
    v_add_f32 v52, v48, v50
    v_mov_b32 v48, v52
    s_nop 1
    v_permlane32_swap_b32 v48, v52
    v_add_f32 v52, v48, v52
    v_permlane16_swap_b32 v40, v41
    v_mov_b32 v53, v40
    s_nop 1
    v_permlane32_swap_b32 v53, v40
    v_mul_f32 v53, 0x3b124925, v53
    v_mul_f32 v52, 0x3b124925, v52
    v_fma_f32 v52, -v53, v53, v52
    v_max_f32 v52, 0, v52
    v_add_f32 v52, 0x3727c5ac, v52
    v_rsq_f32 v52, v52
    s_nop 0
    v_mul_f32 v53, v53, v52
    v_sub_f32 v53, 0, v53
    ds_write2_b32 v10, v52, v53 offset0:0 offset1:128
    ds_read_b128 v[160:163], v11 offset:0
    ds_read_b128 v[176:179], v11 offset:512
    ds_read_b128 v[164:167], v11 offset:32
    ds_read_b128 v[180:183], v11 offset:544
    ds_read_b128 v[168:171], v11 offset:64
    ds_read_b128 v[184:187], v11 offset:576
    ds_read_b128 v[172:175], v11 offset:96
    ds_read_b128 v[188:191], v11 offset:608
    v_mul_f32 v54, s92, v52
    v_mul_f32 v55, s92, v53
    s_waitcnt lgkmcnt(13)
    v_pk_mul_f32 v[64:65], v[64:65], v[54:55] op_sel:[0,0] op_sel_hi:[1,0]
    v_pk_mul_f32 v[66:67], v[66:67], v[54:55] op_sel:[0,0] op_sel_hi:[1,0]
    v_pk_mul_f32 v[68:69], v[68:69], v[54:55] op_sel:[0,0] op_sel_hi:[1,0]
    v_pk_mul_f32 v[70:71], v[70:71], v[54:55] op_sel:[0,0] op_sel_hi:[1,0]
    v_pk_fma_f32 v[64:65], v[208:209], v[54:55], v[64:65] op_sel:[0,1,0] op_sel_hi:[1,1,1]
    v_pk_fma_f32 v[66:67], v[210:211], v[54:55], v[66:67] op_sel:[0,1,0] op_sel_hi:[1,1,1]
    v_pk_fma_f32 v[68:69], v[212:213], v[54:55], v[68:69] op_sel:[0,1,0] op_sel_hi:[1,1,1]
    v_pk_fma_f32 v[70:71], v[214:215], v[54:55], v[70:71] op_sel:[0,1,0] op_sel_hi:[1,1,1]
    v_cvt_pk_bf16_f32 v64, v64, v65
    v_cvt_pk_bf16_f32 v65, v66, v67
    v_cvt_pk_bf16_f32 v66, v68, v69
    v_cvt_pk_bf16_f32 v67, v70, v71
    s_nop 0
    v_permlane32_swap_b32 v64, v66
    v_permlane32_swap_b32 v65, v67
    v_min_u32 v64, -2, v64
    buffer_store_dwordx4 v[64:67], v1, s[28:31], s86 offen sc1
    s_waitcnt lgkmcnt(11)
    v_pk_mul_f32 v[72:73], v[72:73], v[54:55] op_sel:[0,0] op_sel_hi:[1,0]
    v_pk_mul_f32 v[74:75], v[74:75], v[54:55] op_sel:[0,0] op_sel_hi:[1,0]
    v_pk_mul_f32 v[76:77], v[76:77], v[54:55] op_sel:[0,0] op_sel_hi:[1,0]
    v_pk_mul_f32 v[78:79], v[78:79], v[54:55] op_sel:[0,0] op_sel_hi:[1,0]
    v_pk_fma_f32 v[72:73], v[216:217], v[54:55], v[72:73] op_sel:[0,1,0] op_sel_hi:[1,1,1]
    v_pk_fma_f32 v[74:75], v[218:219], v[54:55], v[74:75] op_sel:[0,1,0] op_sel_hi:[1,1,1]
    v_pk_fma_f32 v[76:77], v[220:221], v[54:55], v[76:77] op_sel:[0,1,0] op_sel_hi:[1,1,1]
    v_pk_fma_f32 v[78:79], v[222:223], v[54:55], v[78:79] op_sel:[0,1,0] op_sel_hi:[1,1,1]
    v_cvt_pk_bf16_f32 v68, v72, v73
    v_cvt_pk_bf16_f32 v69, v74, v75
    v_cvt_pk_bf16_f32 v70, v76, v77
    v_cvt_pk_bf16_f32 v71, v78, v79
    s_nop 0
    v_permlane32_swap_b32 v68, v70
    v_permlane32_swap_b32 v69, v71
    v_min_u32 v68, -2, v68
    buffer_store_dwordx4 v[68:71], v1, s[28:31], s87 offen sc1
    s_waitcnt lgkmcnt(4)
    v_pk_mul_f32 v[80:81], v[80:81], v[160:161]
    v_pk_mul_f32 v[82:83], v[82:83], v[162:163]
    v_pk_mul_f32 v[84:85], v[84:85], v[164:165]
    v_pk_mul_f32 v[86:87], v[86:87], v[166:167]
    v_pk_fma_f32 v[80:81], v[176:177], v[60:61], v[80:81] op_sel:[0,1,0] op_sel_hi:[1,1,1]
    v_pk_fma_f32 v[82:83], v[178:179], v[60:61], v[82:83] op_sel:[0,1,0] op_sel_hi:[1,1,1]
    v_pk_fma_f32 v[84:85], v[180:181], v[60:61], v[84:85] op_sel:[0,1,0] op_sel_hi:[1,1,1]
    v_pk_fma_f32 v[86:87], v[182:183], v[60:61], v[86:87] op_sel:[0,1,0] op_sel_hi:[1,1,1]
    v_cvt_pk_bf16_f32 v80, v80, v81
    v_cvt_pk_bf16_f32 v81, v82, v83
    v_cvt_pk_bf16_f32 v82, v84, v85
    v_cvt_pk_bf16_f32 v83, v86, v87
    v_min_u32 v80, -2, v80
    buffer_store_dwordx4 v[80:83], v22, s[28:31], s88 offen sc1
    s_waitcnt lgkmcnt(0)
    v_pk_mul_f32 v[88:89], v[88:89], v[168:169]
    v_pk_mul_f32 v[90:91], v[90:91], v[170:171]
    v_pk_mul_f32 v[92:93], v[92:93], v[172:173]
    v_pk_mul_f32 v[94:95], v[94:95], v[174:175]
    v_pk_fma_f32 v[88:89], v[184:185], v[60:61], v[88:89] op_sel:[0,1,0] op_sel_hi:[1,1,1]
    v_pk_fma_f32 v[90:91], v[186:187], v[60:61], v[90:91] op_sel:[0,1,0] op_sel_hi:[1,1,1]
    v_pk_fma_f32 v[92:93], v[188:189], v[60:61], v[92:93] op_sel:[0,1,0] op_sel_hi:[1,1,1]
    v_pk_fma_f32 v[94:95], v[190:191], v[60:61], v[94:95] op_sel:[0,1,0] op_sel_hi:[1,1,1]
    v_cvt_pk_bf16_f32 v84, v88, v89
    v_cvt_pk_bf16_f32 v85, v90, v91
    v_cvt_pk_bf16_f32 v86, v92, v93
    v_cvt_pk_bf16_f32 v87, v94, v95
    v_min_u32 v84, -2, v84
    buffer_store_dwordx4 v[84:87], v22, s[28:31], s89 offen sc1
    v_pk_mul_f32 v[96:97], v[96:97], v[160:161]
    v_pk_mul_f32 v[98:99], v[98:99], v[162:163]
    v_pk_mul_f32 v[100:101], v[100:101], v[164:165]
    v_pk_mul_f32 v[102:103], v[102:103], v[166:167]
    v_pk_fma_f32 v[96:97], v[176:177], v[62:63], v[96:97] op_sel:[0,0,0] op_sel_hi:[1,0,1]
    v_pk_fma_f32 v[98:99], v[178:179], v[62:63], v[98:99] op_sel:[0,0,0] op_sel_hi:[1,0,1]
    v_pk_fma_f32 v[100:101], v[180:181], v[62:63], v[100:101] op_sel:[0,0,0] op_sel_hi:[1,0,1]
    v_pk_fma_f32 v[102:103], v[182:183], v[62:63], v[102:103] op_sel:[0,0,0] op_sel_hi:[1,0,1]
    v_cvt_pk_bf16_f32 v96, v96, v97
    v_cvt_pk_bf16_f32 v97, v98, v99
    v_cvt_pk_bf16_f32 v98, v100, v101
    v_cvt_pk_bf16_f32 v99, v102, v103
    v_min_u32 v96, -2, v96
    buffer_store_dwordx4 v[96:99], v22, s[28:31], s90 offen sc1
    v_pk_mul_f32 v[104:105], v[104:105], v[168:169]
    v_pk_mul_f32 v[106:107], v[106:107], v[170:171]
    v_pk_mul_f32 v[108:109], v[108:109], v[172:173]
    v_pk_mul_f32 v[110:111], v[110:111], v[174:175]
    v_pk_fma_f32 v[104:105], v[184:185], v[62:63], v[104:105] op_sel:[0,0,0] op_sel_hi:[1,0,1]
    v_pk_fma_f32 v[106:107], v[186:187], v[62:63], v[106:107] op_sel:[0,0,0] op_sel_hi:[1,0,1]
    v_pk_fma_f32 v[108:109], v[188:189], v[62:63], v[108:109] op_sel:[0,0,0] op_sel_hi:[1,0,1]
    v_pk_fma_f32 v[110:111], v[190:191], v[62:63], v[110:111] op_sel:[0,0,0] op_sel_hi:[1,0,1]
    v_cvt_pk_bf16_f32 v100, v104, v105
    v_cvt_pk_bf16_f32 v101, v106, v107
    v_cvt_pk_bf16_f32 v102, v108, v109
    v_cvt_pk_bf16_f32 v103, v110, v111
    v_min_u32 v100, -2, v100
    buffer_store_dwordx4 v[100:103], v22, s[28:31], s91 offen sc1
    s_branch LJA
LA2:
    v_mov_b32 v204, v22
    s_mov_b32 s58, s86
    s_mov_b32 s59, s87
Lap_99:
    ds_read_b32 v19, v17
    s_waitcnt lgkmcnt(0)
    v_cmp_gt_u32 vcc, 1, v19
    s_sleep 1
    s_nop 3
    s_cbranch_vccnz Lap_99
    ds_read_b128 v[24:27], v12
    ds_read_b64_tr_b16 v[112:113], v20 offset:0
    ds_read_b64_tr_b16 v[114:115], v20 offset:768
    ds_read_b64_tr_b16 v[116:117], v20 offset:64
    ds_read_b64_tr_b16 v[118:119], v20 offset:832
    ds_read_b64_tr_b16 v[120:121], v20 offset:128
    ds_read_b64_tr_b16 v[122:123], v20 offset:896
    ds_read_b128 v[28:31], v13
    ds_read_b64_tr_b16 v[124:125], v20 offset:3072
    ds_read_b64_tr_b16 v[126:127], v20 offset:3840
    ds_read_b64_tr_b16 v[128:129], v20 offset:3136
    ds_read_b64_tr_b16 v[130:131], v20 offset:3904
    ds_read_b64_tr_b16 v[132:133], v20 offset:3200
    ds_read_b64_tr_b16 v[134:135], v20 offset:3968
    s_mov_b32 s57, 1
Lp12:
    s_cmp_gt_u32 s57, 3
    s_cbranch_scc1 Lnw_100
    buffer_store_dwordx4 v[200:203], v204, s[28:31], s58 offen sc1
Lnw_100:
    s_waitcnt lgkmcnt(7)
    v_mfma_f32_32x32x16_bf16 v[64:79], v[24:27], v[112:115], v[64:79]
    ds_read_b128 v[32:35], v14
    ds_read_b64_tr_b16 v[136:137], v20 offset:6144
    ds_read_b64_tr_b16 v[138:139], v20 offset:6912
    v_lshlrev_b32 v4, 16, v24
    v_and_b32 v5, s55, v24
    v_lshlrev_b32 v6, 16, v25
    v_and_b32 v7, s55, v25
    v_mfma_f32_32x32x16_bf16 v[80:95], v[24:27], v[116:119], v[80:95]
    ds_read_b64_tr_b16 v[140:141], v20 offset:6208
    ds_read_b64_tr_b16 v[142:143], v20 offset:6976
    v_fmac_f32 v48, v4, v4
    v_fmac_f32 v49, v5, v5
    v_fmac_f32 v50, v6, v6
    v_fmac_f32 v51, v7, v7
    v_lshlrev_b32 v4, 16, v26
    v_mfma_f32_32x32x16_bf16 v[96:111], v[24:27], v[120:123], v[96:111]
    ds_read_b64_tr_b16 v[144:145], v20 offset:6272
    ds_read_b64_tr_b16 v[146:147], v20 offset:7040
    v_and_b32 v5, s55, v26
    v_lshlrev_b32 v6, 16, v27
    v_and_b32 v7, s55, v27
    v_fmac_f32 v48, v4, v4
    v_fmac_f32 v49, v5, v5
    v_mfma_f32_16x16x32_bf16 v[40:43], v[56:59], v[24:27], v[40:43]
    v_fmac_f32 v50, v6, v6
    v_fmac_f32 v51, v7, v7
    s_waitcnt lgkmcnt(7)
    v_mfma_f32_32x32x16_bf16 v[64:79], v[28:31], v[124:127], v[64:79]
    ds_read_b32 v19, v17
    ds_read_b128 v[36:39], v15
    ds_read_b64_tr_b16 v[148:149], v20 offset:9216
    v_lshlrev_b32 v4, 16, v28
    v_and_b32 v5, s55, v28
    v_lshlrev_b32 v6, 16, v29
    v_and_b32 v7, s55, v29
    v_mfma_f32_32x32x16_bf16 v[80:95], v[28:31], v[128:131], v[80:95]
    ds_read_b64_tr_b16 v[150:151], v20 offset:9984
    ds_read_b64_tr_b16 v[152:153], v20 offset:9280
    ds_read_b64_tr_b16 v[154:155], v20 offset:10048
    v_fmac_f32 v48, v4, v4
    v_fmac_f32 v49, v5, v5
    v_fmac_f32 v50, v6, v6
    v_fmac_f32 v51, v7, v7
    v_lshlrev_b32 v4, 16, v30
    v_mfma_f32_32x32x16_bf16 v[96:111], v[28:31], v[132:135], v[96:111]
    ds_read_b64_tr_b16 v[156:157], v20 offset:9344
    ds_read_b64_tr_b16 v[158:159], v20 offset:10112
    v_and_b32 v5, s55, v30
    v_lshlrev_b32 v6, 16, v31
    v_and_b32 v7, s55, v31
    v_fmac_f32 v48, v4, v4
    v_fmac_f32 v49, v5, v5
    v_mfma_f32_16x16x32_bf16 v[40:43], v[56:59], v[28:31], v[40:43]
    v_fmac_f32 v50, v6, v6
    v_fmac_f32 v51, v7, v7
    s_cmp_eq_u32 s57, 7
    s_cbranch_scc1 Lp1e2
    s_cmp_eq_u32 s57, 5
    s_cselect_b32 s47, -4, 1
    s_mul_i32 s48, s47, 12288
    s_lshl_b32 s47, s47, 14
    v_add_u32 v18, 1, v18
    s_cmp_gt_u32 s57, 3
    s_cbranch_scc1 Lnw_101
    buffer_store_dwordx4 v[200:203], v204, s[28:31], s59 offen sc1
    v_mov_b32 v204, v22
    s_cmp_eq_u32 s57, 1
    s_cselect_b32 s58, s88, s90
    s_cselect_b32 s59, s89, s91
Lnw_101:
    s_cmp_lt_u32 s57, 4
    s_cbranch_scc1 Lnc_102
    s_waitcnt vmcnt(0)
Lnc_102:
    ds_write_b32 v16, v18
    s_waitcnt lgkmcnt(8)
    v_cmp_ge_u32 vcc, s57, v19
    v_mfma_f32_32x32x16_bf16 v[64:79], v[32:35], v[136:139], v[64:79]
    v_lshlrev_b32 v4, 16, v32
    v_and_b32 v5, s55, v32
    v_lshlrev_b32 v6, 16, v33
    v_and_b32 v7, s55, v33
    s_cbranch_vccnz Lsp2
Lsd2:
    v_add_u32 v12, s47, v12
    v_add_u32 v13, s47, v13
    v_add_u32 v14, s47, v14
    v_add_u32 v15, s47, v15
    v_add_u32 v20, s48, v20
    v_mfma_f32_32x32x16_bf16 v[80:95], v[32:35], v[140:143], v[80:95]
    ds_read_b128 v[24:27], v12
    ds_read_b64_tr_b16 v[112:113], v20 offset:0
    ds_read_b64_tr_b16 v[114:115], v20 offset:768
    ds_read_b64_tr_b16 v[116:117], v20 offset:64
    v_fmac_f32 v48, v4, v4
    v_fmac_f32 v49, v5, v5
    v_fmac_f32 v50, v6, v6
    v_fmac_f32 v51, v7, v7
    v_lshlrev_b32 v4, 16, v34
    v_mfma_f32_32x32x16_bf16 v[96:111], v[32:35], v[144:147], v[96:111]
    ds_read_b64_tr_b16 v[118:119], v20 offset:832
    ds_read_b64_tr_b16 v[120:121], v20 offset:128
    ds_read_b64_tr_b16 v[122:123], v20 offset:896
    v_and_b32 v5, s55, v34
    v_lshlrev_b32 v6, 16, v35
    v_and_b32 v7, s55, v35
    v_fmac_f32 v48, v4, v4
    v_fmac_f32 v49, v5, v5
    v_mfma_f32_16x16x32_bf16 v[40:43], v[56:59], v[32:35], v[40:43]
    v_fmac_f32 v50, v6, v6
    v_fmac_f32 v51, v7, v7
    s_waitcnt lgkmcnt(7)
    v_mfma_f32_32x32x16_bf16 v[64:79], v[36:39], v[148:151], v[64:79]
    ds_read_b128 v[28:31], v13
    ds_read_b64_tr_b16 v[124:125], v20 offset:3072
    ds_read_b64_tr_b16 v[126:127], v20 offset:3840
    v_lshlrev_b32 v4, 16, v36
    v_and_b32 v5, s55, v36
    v_lshlrev_b32 v6, 16, v37
    v_and_b32 v7, s55, v37
    v_mfma_f32_32x32x16_bf16 v[80:95], v[36:39], v[152:155], v[80:95]
    ds_read_b64_tr_b16 v[128:129], v20 offset:3136
    ds_read_b64_tr_b16 v[130:131], v20 offset:3904
    v_fmac_f32 v48, v4, v4
    v_fmac_f32 v49, v5, v5
    v_fmac_f32 v50, v6, v6
    v_fmac_f32 v51, v7, v7
    v_lshlrev_b32 v4, 16, v38
    v_mfma_f32_32x32x16_bf16 v[96:111], v[36:39], v[156:159], v[96:111]
    ds_read_b64_tr_b16 v[132:133], v20 offset:3200
    ds_read_b64_tr_b16 v[134:135], v20 offset:3968
    v_and_b32 v5, s55, v38
    v_lshlrev_b32 v6, 16, v39
    v_and_b32 v7, s55, v39
    v_fmac_f32 v48, v4, v4
    v_fmac_f32 v49, v5, v5
    v_mfma_f32_16x16x32_bf16 v[40:43], v[56:59], v[36:39], v[40:43]
    v_fmac_f32 v50, v6, v6
    v_fmac_f32 v51, v7, v7
    s_add_u32 s57, s57, 1
    s_branch Lp12
Lsp2:
Lsp2x:
    ds_read_b32 v19, v17
    s_waitcnt lgkmcnt(0)
    v_cmp_ge_u32 vcc, s57, v19
    s_nop 4
    s_cbranch_vccnz Lsp2x
    s_branch Lsd2
Lp1e2:
    v_lshlrev_b32 v9, 2, v2
    s_lshl_b32 s47, s39, 7
    s_add_u32 s47, s47, 160768
    v_add_u32 v10, s47, v9
    v_add_u32 v9, 161792, v9
    v_lshl_add_u32 v11, v3, 4, s47
    v_lshlrev_b32 v8, 4, v3
    v_add_u32 v8, 161792, v8
    s_waitcnt lgkmcnt(7)
    v_mfma_f32_32x32x16_bf16 v[64:79], v[32:35], v[136:139], v[64:79]
    v_lshlrev_b32 v4, 16, v32
    v_and_b32 v5, s55, v32
    v_lshlrev_b32 v6, 16, v33
    v_and_b32 v7, s55, v33
    v_mfma_f32_32x32x16_bf16 v[80:95], v[32:35], v[140:143], v[80:95]
    v_fmac_f32 v48, v4, v4
    v_fmac_f32 v49, v5, v5
    v_fmac_f32 v50, v6, v6
    v_fmac_f32 v51, v7, v7
    v_lshlrev_b32 v4, 16, v34
    v_mfma_f32_32x32x16_bf16 v[96:111], v[32:35], v[144:147], v[96:111]
    v_and_b32 v5, s55, v34
    v_lshlrev_b32 v6, 16, v35
    v_and_b32 v7, s55, v35
    v_fmac_f32 v48, v4, v4
    v_fmac_f32 v49, v5, v5
    v_mfma_f32_16x16x32_bf16 v[40:43], v[56:59], v[32:35], v[40:43]
    v_fmac_f32 v50, v6, v6
    v_fmac_f32 v51, v7, v7
    s_waitcnt lgkmcnt(0)
    s_barrier
    s_waitcnt lgkmcnt(0)
    v_mfma_f32_32x32x16_bf16 v[64:79], v[36:39], v[148:151], v[64:79]
    ds_read_b32 v60, v9 offset:0
    ds_read_b32 v61, v9 offset:128
    ds_read_b32 v62, v9 offset:256
    v_lshlrev_b32 v4, 16, v36
    v_and_b32 v5, s55, v36
    v_lshlrev_b32 v6, 16, v37
    v_and_b32 v7, s55, v37
    v_mfma_f32_32x32x16_bf16 v[80:95], v[36:39], v[152:155], v[80:95]
    v_fmac_f32 v48, v4, v4
    v_fmac_f32 v49, v5, v5
    v_fmac_f32 v50, v6, v6
    v_fmac_f32 v51, v7, v7
    v_lshlrev_b32 v4, 16, v38
    v_mfma_f32_32x32x16_bf16 v[96:111], v[36:39], v[156:159], v[96:111]
    v_and_b32 v5, s55, v38
    v_lshlrev_b32 v6, 16, v39
    v_and_b32 v7, s55, v39
    v_fmac_f32 v48, v4, v4
    v_fmac_f32 v49, v5, v5
    v_mfma_f32_16x16x32_bf16 v[40:43], v[56:59], v[36:39], v[40:43]
    v_fmac_f32 v50, v6, v6
    v_fmac_f32 v51, v7, v7
    v_add_f32 v48, v48, v49
    v_add_f32 v50, v50, v51
    v_add_f32 v52, v48, v50
    v_mov_b32 v48, v52
    s_nop 1
    v_permlane32_swap_b32 v48, v52
    v_add_f32 v52, v48, v52
    v_permlane16_swap_b32 v40, v41
    v_mov_b32 v53, v40
    s_nop 1
    v_permlane32_swap_b32 v53, v40
    v_mul_f32 v53, 0x3b124925, v53
    v_mul_f32 v52, 0x3b124925, v52
    v_fma_f32 v52, -v53, v53, v52
    v_max_f32 v52, 0, v52
    v_add_f32 v52, 0x3727c5ac, v52
    v_rsq_f32 v52, v52
    s_nop 0
    v_mul_f32 v53, v53, v52
    v_sub_f32 v53, 0, v53
    ds_write2_b32 v10, v52, v53 offset0:0 offset1:128
    ds_read_b128 v[160:163], v11 offset:0
    ds_read_b128 v[176:179], v11 offset:512
    ds_read_b128 v[164:167], v11 offset:32
    ds_read_b128 v[180:183], v11 offset:544
    ds_read_b128 v[168:171], v11 offset:64
    ds_read_b128 v[184:187], v11 offset:576
    ds_read_b128 v[172:175], v11 offset:96
    ds_read_b128 v[188:191], v11 offset:608
    s_waitcnt lgkmcnt(4)
    v_pk_mul_f32 v[64:65], v[64:65], v[160:161]
    v_pk_mul_f32 v[66:67], v[66:67], v[162:163]
    v_pk_mul_f32 v[68:69], v[68:69], v[164:165]
    v_pk_mul_f32 v[70:71], v[70:71], v[166:167]
    v_pk_fma_f32 v[64:65], v[176:177], v[60:61], v[64:65] op_sel:[0,0,0] op_sel_hi:[1,0,1]
    v_pk_fma_f32 v[66:67], v[178:179], v[60:61], v[66:67] op_sel:[0,0,0] op_sel_hi:[1,0,1]
    v_pk_fma_f32 v[68:69], v[180:181], v[60:61], v[68:69] op_sel:[0,0,0] op_sel_hi:[1,0,1]
    v_pk_fma_f32 v[70:71], v[182:183], v[60:61], v[70:71] op_sel:[0,0,0] op_sel_hi:[1,0,1]
    v_cvt_pk_bf16_f32 v64, v64, v65
    v_cvt_pk_bf16_f32 v65, v66, v67
    v_cvt_pk_bf16_f32 v66, v68, v69
    v_cvt_pk_bf16_f32 v67, v70, v71
    v_min_u32 v64, -2, v64
    buffer_store_dwordx4 v[64:67], v22, s[28:31], s86 offen sc1
    s_waitcnt lgkmcnt(0)
    v_pk_mul_f32 v[72:73], v[72:73], v[168:169]
    v_pk_mul_f32 v[74:75], v[74:75], v[170:171]
    v_pk_mul_f32 v[76:77], v[76:77], v[172:173]
    v_pk_mul_f32 v[78:79], v[78:79], v[174:175]
    v_pk_fma_f32 v[72:73], v[184:185], v[60:61], v[72:73] op_sel:[0,0,0] op_sel_hi:[1,0,1]
    v_pk_fma_f32 v[74:75], v[186:187], v[60:61], v[74:75] op_sel:[0,0,0] op_sel_hi:[1,0,1]
    v_pk_fma_f32 v[76:77], v[188:189], v[60:61], v[76:77] op_sel:[0,0,0] op_sel_hi:[1,0,1]
    v_pk_fma_f32 v[78:79], v[190:191], v[60:61], v[78:79] op_sel:[0,0,0] op_sel_hi:[1,0,1]
    v_cvt_pk_bf16_f32 v68, v72, v73
    v_cvt_pk_bf16_f32 v69, v74, v75
    v_cvt_pk_bf16_f32 v70, v76, v77
    v_cvt_pk_bf16_f32 v71, v78, v79
    v_min_u32 v68, -2, v68
    buffer_store_dwordx4 v[68:71], v22, s[28:31], s87 offen sc1
    v_pk_mul_f32 v[80:81], v[80:81], v[160:161]
    v_pk_mul_f32 v[82:83], v[82:83], v[162:163]
    v_pk_mul_f32 v[84:85], v[84:85], v[164:165]
    v_pk_mul_f32 v[86:87], v[86:87], v[166:167]
    v_pk_fma_f32 v[80:81], v[176:177], v[60:61], v[80:81] op_sel:[0,1,0] op_sel_hi:[1,1,1]
    v_pk_fma_f32 v[82:83], v[178:179], v[60:61], v[82:83] op_sel:[0,1,0] op_sel_hi:[1,1,1]
    v_pk_fma_f32 v[84:85], v[180:181], v[60:61], v[84:85] op_sel:[0,1,0] op_sel_hi:[1,1,1]
    v_pk_fma_f32 v[86:87], v[182:183], v[60:61], v[86:87] op_sel:[0,1,0] op_sel_hi:[1,1,1]
    v_cvt_pk_bf16_f32 v80, v80, v81
    v_cvt_pk_bf16_f32 v81, v82, v83
    v_cvt_pk_bf16_f32 v82, v84, v85
    v_cvt_pk_bf16_f32 v83, v86, v87
    v_min_u32 v80, -2, v80
    buffer_store_dwordx4 v[80:83], v22, s[28:31], s88 offen sc1
    v_pk_mul_f32 v[88:89], v[88:89], v[168:169]
    v_pk_mul_f32 v[90:91], v[90:91], v[170:171]
    v_pk_mul_f32 v[92:93], v[92:93], v[172:173]
    v_pk_mul_f32 v[94:95], v[94:95], v[174:175]
    v_pk_fma_f32 v[88:89], v[184:185], v[60:61], v[88:89] op_sel:[0,1,0] op_sel_hi:[1,1,1]
    v_pk_fma_f32 v[90:91], v[186:187], v[60:61], v[90:91] op_sel:[0,1,0] op_sel_hi:[1,1,1]
    v_pk_fma_f32 v[92:93], v[188:189], v[60:61], v[92:93] op_sel:[0,1,0] op_sel_hi:[1,1,1]
    v_pk_fma_f32 v[94:95], v[190:191], v[60:61], v[94:95] op_sel:[0,1,0] op_sel_hi:[1,1,1]
    v_cvt_pk_bf16_f32 v84, v88, v89
    v_cvt_pk_bf16_f32 v85, v90, v91
    v_cvt_pk_bf16_f32 v86, v92, v93
    v_cvt_pk_bf16_f32 v87, v94, v95
    v_min_u32 v84, -2, v84
    buffer_store_dwordx4 v[84:87], v22, s[28:31], s89 offen sc1
    v_pk_mul_f32 v[96:97], v[96:97], v[160:161]
    v_pk_mul_f32 v[98:99], v[98:99], v[162:163]
    v_pk_mul_f32 v[100:101], v[100:101], v[164:165]
    v_pk_mul_f32 v[102:103], v[102:103], v[166:167]
    v_pk_fma_f32 v[96:97], v[176:177], v[62:63], v[96:97] op_sel:[0,0,0] op_sel_hi:[1,0,1]
    v_pk_fma_f32 v[98:99], v[178:179], v[62:63], v[98:99] op_sel:[0,0,0] op_sel_hi:[1,0,1]
    v_pk_fma_f32 v[100:101], v[180:181], v[62:63], v[100:101] op_sel:[0,0,0] op_sel_hi:[1,0,1]
    v_pk_fma_f32 v[102:103], v[182:183], v[62:63], v[102:103] op_sel:[0,0,0] op_sel_hi:[1,0,1]
    v_cvt_pk_bf16_f32 v96, v96, v97
    v_cvt_pk_bf16_f32 v97, v98, v99
    v_cvt_pk_bf16_f32 v98, v100, v101
    v_cvt_pk_bf16_f32 v99, v102, v103
    v_min_u32 v96, -2, v96
    buffer_store_dwordx4 v[96:99], v22, s[28:31], s90 offen sc1
    v_pk_mul_f32 v[104:105], v[104:105], v[168:169]
    v_pk_mul_f32 v[106:107], v[106:107], v[170:171]
    v_pk_mul_f32 v[108:109], v[108:109], v[172:173]
    v_pk_mul_f32 v[110:111], v[110:111], v[174:175]
    v_pk_fma_f32 v[104:105], v[184:185], v[62:63], v[104:105] op_sel:[0,0,0] op_sel_hi:[1,0,1]
    v_pk_fma_f32 v[106:107], v[186:187], v[62:63], v[106:107] op_sel:[0,0,0] op_sel_hi:[1,0,1]
    v_pk_fma_f32 v[108:109], v[188:189], v[62:63], v[108:109] op_sel:[0,0,0] op_sel_hi:[1,0,1]
    v_pk_fma_f32 v[110:111], v[190:191], v[62:63], v[110:111] op_sel:[0,0,0] op_sel_hi:[1,0,1]
    v_cvt_pk_bf16_f32 v100, v104, v105
    v_cvt_pk_bf16_f32 v101, v106, v107
    v_cvt_pk_bf16_f32 v102, v108, v109
    v_cvt_pk_bf16_f32 v103, v110, v111
    v_min_u32 v100, -2, v100
    buffer_store_dwordx4 v[100:103], v22, s[28:31], s91 offen sc1
LJA:
    s_waitcnt vmcnt(0)
LJA2:
    v_lshlrev_b32 v6, 2, v0
    v_add_u32 v6, 155648, v6
    v_mov_b32 v7, 1
    ds_add_u32 v6, v7 offset:2048
    s_mul_i32 s47, s62, 7
    s_lshr_b32 s47, s47, 1
    s_lshl_b32 s47, s47, 9
    s_add_u32 s47, s47, 28672
    v_add_u32 v8, s47, v1
    s_mul_i32 s47, s62, 448
    s_add_u32 s47, s47, 55296
    v_mul_u32_u24 v4, 0x1c00, v3
    v_lshl_add_u32 v4, v2, 4, v4
    v_add_u32 v9, s47, v4
    v_add_u32 v10, 0x3400, v9
    s_lshl_b32 s50, s63, 2
    s_add_u32 s50, s50, s39
    s_mul_i32 s50, s50, 86016
    v_subrev_u32 v11, 0x7000, v8
Lpw_103:
    ds_read_b32 v4, v6 offset:2048
    s_waitcnt lgkmcnt(0)
    v_cmp_gt_u32 vcc, 16, v4
    s_sleep 1
    s_nop 3
    s_cbranch_vccnz Lpw_103
    s_mov_b32 s48, 0
Lq_104:
    buffer_load_dwordx4 v[16:19], v11, s[28:31], s50 offen offset:0 sc1
    buffer_load_dwordx4 v[20:23], v11, s[28:31], s50 offen offset:1024 sc1
    s_waitcnt vmcnt(0)
    v_max_u32 v4, v16, v20
    v_cmp_eq_u32 vcc, -1, v4
    s_nop 4
    s_cbranch_vccz Lqk_105
    s_sleep 4
    s_add_u32 s48, s48, 1
    s_cmp_lt_u32 s48, 262144
    s_cbranch_scc1 Lq_104
Lqk_105:
    s_bitcmp1_b32 s62, 0
    s_cselect_b32 s48, -1, 0
    s_mov_b32 s49, 0
    s_mov_b32 s50, 0
    s_cselect_b32 s51, 0, -1
    v_cndmask_b32 v16, v16, 0, s[48:49]
    v_cndmask_b32 v22, v22, 0, s[50:51]
    v_cndmask_b32 v17, v17, 0, s[48:49]
    v_cndmask_b32 v23, v23, 0, s[50:51]
    v_mov_b32 v32, 0
    v_mov_b32 v33, 0
    v_mov_b32 v34, 0
    v_mov_b32 v35, 0
    v_mov_b32 v36, 0
    v_mov_b32 v37, 0
    v_mov_b32 v38, 0
    v_mov_b32 v39, 0
    v_mov_b32 v40, 0
    v_mov_b32 v41, 0
    v_mov_b32 v42, 0
    v_mov_b32 v43, 0
    v_mov_b32 v44, 0
    v_mov_b32 v45, 0
    v_mov_b32 v46, 0
    v_mov_b32 v47, 0
    v_mov_b32 v104, 0
    v_mov_b32 v136, 0
    v_mov_b32 v105, 0
    v_mov_b32 v137, 0
    v_mov_b32 v106, 0
    v_mov_b32 v138, 0
    v_mov_b32 v107, 0
    v_mov_b32 v139, 0
    v_mov_b32 v108, 0
    v_mov_b32 v140, 0
    v_mov_b32 v109, 0
    v_mov_b32 v141, 0
    v_mov_b32 v110, 0
    v_mov_b32 v142, 0
    v_mov_b32 v111, 0
    v_mov_b32 v143, 0
Lr0_106:
    ds_read_b32 v5, v6
    s_waitcnt lgkmcnt(0)
    v_cmp_gt_u32 vcc, 4, v5
    s_sleep 1
    s_nop 3
    s_cbranch_vccnz Lr0_106
    s_setprio 1
    ds_read_b128 v[112:115], v1 offset:0
    ds_read_b128 v[116:119], v1 offset:1024
    ds_read_b128 v[120:123], v1 offset:4096
    ds_read_b128 v[124:127], v1 offset:5120
    s_waitcnt lgkmcnt(2)
    v_mfma_f32_32x32x16_bf16 v[80:95], v[112:115], v[16:19], 0
    v_mfma_f32_32x32x16_bf16 v[80:95], v[116:119], v[20:23], v[80:95]
    s_mov_b32 s52, 4
    s_mov_b32 s53, 0
    s_nop 9
    v_max3_f32 v4, v80, v81, v82
    v_max3_f32 v4, v4, v83, v84
    v_max3_f32 v4, v4, v85, v86
    v_max3_f32 v4, v4, v87, v88
    v_max3_f32 v4, v4, v89, v90
    v_max3_f32 v4, v4, v91, v92
    v_max3_f32 v4, v4, v93, v94
    v_max_f32 v4, v4, v95
    v_mov_b32 v48, v4
    s_nop 1
    v_permlane32_swap_b32 v4, v48
    v_max_f32 v4, v4, v48
    v_sub_f32 v48, 0, v4
    v_add_f32 v64, v48, v80
    v_add_f32 v65, v48, v81
    v_add_f32 v66, v48, v82
    v_add_f32 v67, v48, v83
    v_add_f32 v68, v48, v84
    v_add_f32 v69, v48, v85
    v_add_f32 v70, v48, v86
    v_add_f32 v71, v48, v87
    v_add_f32 v72, v48, v88
    v_add_f32 v73, v48, v89
    v_add_f32 v74, v48, v90
    v_add_f32 v75, v48, v91
    v_add_f32 v76, v48, v92
    v_add_f32 v77, v48, v93
    v_add_f32 v78, v48, v94
    v_add_f32 v79, v48, v95
    v_mov_b32 v49, v48
    v_mov_b32 v50, v48
    v_mov_b32 v51, v48
    v_mov_b32 v52, v48
    v_mov_b32 v53, v48
    v_mov_b32 v54, v48
    v_mov_b32 v55, v48
    v_mov_b32 v56, v48
    v_mov_b32 v57, v48
    v_mov_b32 v58, v48
    v_mov_b32 v59, v48
    v_mov_b32 v60, v48
    v_mov_b32 v61, v48
    v_mov_b32 v62, v48
    v_mov_b32 v63, v48
    s_and_b32 s94, s37, 7
    s_lshl_b32 s94, s94, 3
    s_add_u32 s94, s94, s38
    s_mul_i32 s94, s94, 25088
    s_add_u32 s94, s94, 19922944
    v_mul_u32_u24 v13, 24, v3
    v_min_u32 v12, 23, v2
    v_add_lshl_u32 v13, v13, v12, 4
Lattn:
    s_waitcnt lgkmcnt(0)
    v_mfma_f32_32x32x16_bf16 v[80:95], v[120:123], v[16:19], v[48:63]
    ds_read_b128 v[128:131], v1 offset:2048
    ds_read_b128 v[112:115], v1 offset:8192
    v_exp_f32 v64, v64
    v_exp_f32 v65, v65
    v_exp_f32 v66, v66
    v_exp_f32 v67, v67
    v_mfma_f32_32x32x16_bf16 v[32:47], v[136:139], v[104:107], v[32:47]
    ds_read_b128 v[132:135], v1 offset:3072
    ds_read_b128 v[116:119], v1 offset:9216
    v_exp_f32 v68, v68
    v_exp_f32 v69, v69
    v_exp_f32 v70, v70
    v_exp_f32 v71, v71
    v_cvt_pk_bf16_f32 v96, v64, v65
    v_cvt_pk_bf16_f32 v97, v66, v67
    v_mfma_f32_32x32x16_bf16 v[80:95], v[124:127], v[20:23], v[80:95]
    v_exp_f32 v72, v72
    v_exp_f32 v73, v73
    v_exp_f32 v74, v74
    v_exp_f32 v75, v75
    v_cvt_pk_bf16_f32 v98, v68, v69
    v_cvt_pk_bf16_f32 v99, v70, v71
    v_mfma_f32_32x32x16_bf16 v[32:47], v[140:143], v[108:111], v[32:47]
    v_exp_f32 v76, v76
    v_exp_f32 v77, v77
    v_exp_f32 v78, v78
    v_exp_f32 v79, v79
    v_cvt_pk_bf16_f32 v100, v72, v73
    v_cvt_pk_bf16_f32 v101, v74, v75
    v_cvt_pk_bf16_f32 v102, v76, v77
    v_cvt_pk_bf16_f32 v103, v78, v79
    s_waitcnt lgkmcnt(0)
    v_mfma_f32_32x32x16_bf16 v[64:79], v[112:115], v[16:19], v[48:63]
    ds_read_b128 v[136:139], v1 offset:6144
    ds_read_b128 v[120:123], v1 offset:12288
    v_exp_f32 v80, v80
    v_exp_f32 v81, v81
    v_exp_f32 v82, v82
    v_exp_f32 v83, v83
    v_mfma_f32_32x32x16_bf16 v[32:47], v[128:131], v[96:99], v[32:47]
    ds_read_b128 v[140:143], v1 offset:7168
    ds_read_b128 v[124:127], v1 offset:13312
    v_exp_f32 v84, v84
    v_exp_f32 v85, v85
    v_exp_f32 v86, v86
    v_exp_f32 v87, v87
    v_cvt_pk_bf16_f32 v104, v80, v81
    v_cvt_pk_bf16_f32 v105, v82, v83
    v_mfma_f32_32x32x16_bf16 v[64:79], v[116:119], v[20:23], v[64:79]
    ds_read_b32 v5, v6 offset:256
    v_exp_f32 v88, v88
    v_exp_f32 v89, v89
    v_exp_f32 v90, v90
    v_exp_f32 v91, v91
    v_cvt_pk_bf16_f32 v106, v84, v85
    v_cvt_pk_bf16_f32 v107, v86, v87
    v_mfma_f32_32x32x16_bf16 v[32:47], v[132:135], v[100:103], v[32:47]
    v_exp_f32 v92, v92
    v_exp_f32 v93, v93
    v_exp_f32 v94, v94
    v_exp_f32 v95, v95
    v_cvt_pk_bf16_f32 v108, v88, v89
    v_cvt_pk_bf16_f32 v109, v90, v91
    v_cvt_pk_bf16_f32 v110, v92, v93
    v_cvt_pk_bf16_f32 v111, v94, v95
    s_waitcnt lgkmcnt(0)
    v_cmp_gt_u32 vcc, s52, v5
    v_mfma_f32_32x32x16_bf16 v[80:95], v[120:123], v[16:19], v[48:63]
    ds_read_b128 v[128:131], v1 offset:10240
    v_exp_f32 v64, v64
    v_exp_f32 v65, v65
    v_exp_f32 v66, v66
    v_exp_f32 v67, v67
    s_cbranch_vccnz Lsl_107
Lbk_108:
    v_mfma_f32_32x32x16_bf16 v[32:47], v[136:139], v[104:107], v[32:47]
    ds_read_b128 v[132:135], v1 offset:11264
    ds_read_b128 v[112:115], v1 offset:16384
    v_exp_f32 v68, v68
    v_exp_f32 v69, v69
    v_exp_f32 v70, v70
    v_exp_f32 v71, v71
    v_cvt_pk_bf16_f32 v96, v64, v65
    v_cvt_pk_bf16_f32 v97, v66, v67
    v_mfma_f32_32x32x16_bf16 v[80:95], v[124:127], v[20:23], v[80:95]
    ds_read_b128 v[116:119], v1 offset:17408
    v_exp_f32 v72, v72
    v_exp_f32 v73, v73
    v_exp_f32 v74, v74
    v_exp_f32 v75, v75
    v_cvt_pk_bf16_f32 v98, v68, v69
    v_cvt_pk_bf16_f32 v99, v70, v71
    v_mfma_f32_32x32x16_bf16 v[32:47], v[140:143], v[108:111], v[32:47]
    v_exp_f32 v76, v76
    v_exp_f32 v77, v77
    v_exp_f32 v78, v78
    v_exp_f32 v79, v79
    v_cvt_pk_bf16_f32 v100, v72, v73
    v_cvt_pk_bf16_f32 v101, v74, v75
    v_cvt_pk_bf16_f32 v102, v76, v77
    v_cvt_pk_bf16_f32 v103, v78, v79
    s_waitcnt lgkmcnt(0)
    v_mfma_f32_32x32x16_bf16 v[64:79], v[112:115], v[16:19], v[48:63]
    ds_read_b128 v[136:139], v1 offset:14336
    ds_read_b128 v[120:123], v1 offset:20480
    v_exp_f32 v80, v80
    v_exp_f32 v81, v81
    v_exp_f32 v82, v82
    v_exp_f32 v83, v83
    v_mfma_f32_32x32x16_bf16 v[32:47], v[128:131], v[96:99], v[32:47]
    ds_read_b128 v[140:143], v1 offset:15360
    ds_read_b128 v[124:127], v1 offset:21504
    v_exp_f32 v84, v84
    v_exp_f32 v85, v85
    v_exp_f32 v86, v86
    v_exp_f32 v87, v87
    v_cvt_pk_bf16_f32 v104, v80, v81
    v_cvt_pk_bf16_f32 v105, v82, v83
    v_mfma_f32_32x32x16_bf16 v[64:79], v[116:119], v[20:23], v[64:79]
    ds_add_u32 v6, v7 offset:1024
    v_exp_f32 v88, v88
    v_exp_f32 v89, v89
    v_exp_f32 v90, v90
    v_exp_f32 v91, v91
    v_cvt_pk_bf16_f32 v106, v84, v85
    v_cvt_pk_bf16_f32 v107, v86, v87
    v_mfma_f32_32x32x16_bf16 v[32:47], v[132:135], v[100:103], v[32:47]
    v_exp_f32 v92, v92
    v_exp_f32 v93, v93
    v_exp_f32 v94, v94
    v_exp_f32 v95, v95
    v_cvt_pk_bf16_f32 v108, v88, v89
    v_cvt_pk_bf16_f32 v109, v90, v91
    v_cvt_pk_bf16_f32 v110, v92, v93
    v_cvt_pk_bf16_f32 v111, v94, v95
    s_waitcnt lgkmcnt(0)
    v_mfma_f32_32x32x16_bf16 v[80:95], v[120:123], v[16:19], v[48:63]
    ds_read_b128 v[128:131], v1 offset:18432
    ds_read_b128 v[112:115], v1 offset:24576
    v_exp_f32 v64, v64
    v_exp_f32 v65, v65
    v_exp_f32 v66, v66
    v_exp_f32 v67, v67
    v_mfma_f32_32x32x16_bf16 v[32:47], v[136:139], v[104:107], v[32:47]
    ds_read_b128 v[132:135], v1 offset:19456
    ds_read_b128 v[116:119], v1 offset:25600
    v_exp_f32 v68, v68
    v_exp_f32 v69, v69
    v_exp_f32 v70, v70
    v_exp_f32 v71, v71
    v_cvt_pk_bf16_f32 v96, v64, v65
    v_cvt_pk_bf16_f32 v97, v66, v67
    v_mfma_f32_32x32x16_bf16 v[80:95], v[124:127], v[20:23], v[80:95]
    v_exp_f32 v72, v72
    v_exp_f32 v73, v73
    v_exp_f32 v74, v74
    v_exp_f32 v75, v75
    v_cvt_pk_bf16_f32 v98, v68, v69
    v_cvt_pk_bf16_f32 v99, v70, v71
    v_mfma_f32_32x32x16_bf16 v[32:47], v[140:143], v[108:111], v[32:47]
    v_exp_f32 v76, v76
    v_exp_f32 v77, v77
    v_exp_f32 v78, v78
    v_exp_f32 v79, v79
    v_cvt_pk_bf16_f32 v100, v72, v73
    v_cvt_pk_bf16_f32 v101, v74, v75
    v_cvt_pk_bf16_f32 v102, v76, v77
    v_cvt_pk_bf16_f32 v103, v78, v79
    s_waitcnt lgkmcnt(0)
    v_mfma_f32_32x32x16_bf16 v[64:79], v[112:115], v[16:19], v[48:63]
    ds_read_b128 v[136:139], v1 offset:22528
    ds_read_b128 v[120:123], v1 offset:28672
    v_exp_f32 v80, v80
    v_exp_f32 v81, v81
    v_exp_f32 v82, v82
    v_exp_f32 v83, v83
    v_mfma_f32_32x32x16_bf16 v[32:47], v[128:131], v[96:99], v[32:47]
    ds_read_b128 v[140:143], v1 offset:23552
    ds_read_b128 v[124:127], v1 offset:29696
    v_exp_f32 v84, v84
    v_exp_f32 v85, v85
    v_exp_f32 v86, v86
    v_exp_f32 v87, v87
    v_cvt_pk_bf16_f32 v104, v80, v81
    v_cvt_pk_bf16_f32 v105, v82, v83
    v_mfma_f32_32x32x16_bf16 v[64:79], v[116:119], v[20:23], v[64:79]
    ds_read_b32 v5, v6 offset:512
    v_exp_f32 v88, v88
    v_exp_f32 v89, v89
    v_exp_f32 v90, v90
    v_exp_f32 v91, v91
    v_cvt_pk_bf16_f32 v106, v84, v85
    v_cvt_pk_bf16_f32 v107, v86, v87
    v_mfma_f32_32x32x16_bf16 v[32:47], v[132:135], v[100:103], v[32:47]
    v_exp_f32 v92, v92
    v_exp_f32 v93, v93
    v_exp_f32 v94, v94
    v_exp_f32 v95, v95
    v_cvt_pk_bf16_f32 v108, v88, v89
    v_cvt_pk_bf16_f32 v109, v90, v91
    v_cvt_pk_bf16_f32 v110, v92, v93
    v_cvt_pk_bf16_f32 v111, v94, v95
    s_waitcnt lgkmcnt(0)
    v_cmp_gt_u32 vcc, s52, v5
    v_mfma_f32_32x32x16_bf16 v[80:95], v[120:123], v[16:19], v[48:63]
    ds_read_b128 v[128:131], v1 offset:26624
    v_exp_f32 v64, v64
    v_exp_f32 v65, v65
    v_exp_f32 v66, v66
    v_exp_f32 v67, v67
    s_cbranch_vccnz Lsl_109
Lbk_110:
    v_mfma_f32_32x32x16_bf16 v[32:47], v[136:139], v[104:107], v[32:47]
    ds_read_b128 v[132:135], v1 offset:27648
    ds_read_b128 v[112:115], v1 offset:32768
    v_exp_f32 v68, v68
    v_exp_f32 v69, v69
    v_exp_f32 v70, v70
    v_exp_f32 v71, v71
    v_cvt_pk_bf16_f32 v96, v64, v65
    v_cvt_pk_bf16_f32 v97, v66, v67
    v_mfma_f32_32x32x16_bf16 v[80:95], v[124:127], v[20:23], v[80:95]
    ds_read_b128 v[116:119], v1 offset:33792
    v_exp_f32 v72, v72
    v_exp_f32 v73, v73
    v_exp_f32 v74, v74
    v_exp_f32 v75, v75
    v_cvt_pk_bf16_f32 v98, v68, v69
    v_cvt_pk_bf16_f32 v99, v70, v71
    v_mfma_f32_32x32x16_bf16 v[32:47], v[140:143], v[108:111], v[32:47]
    v_exp_f32 v76, v76
    v_exp_f32 v77, v77
    v_exp_f32 v78, v78
    v_exp_f32 v79, v79
    v_cvt_pk_bf16_f32 v100, v72, v73
    v_cvt_pk_bf16_f32 v101, v74, v75
    v_cvt_pk_bf16_f32 v102, v76, v77
    v_cvt_pk_bf16_f32 v103, v78, v79
    s_waitcnt lgkmcnt(0)
    v_mfma_f32_32x32x16_bf16 v[64:79], v[112:115], v[16:19], v[48:63]
    ds_read_b128 v[136:139], v1 offset:30720
    ds_read_b128 v[120:123], v1 offset:36864
    v_exp_f32 v80, v80
    v_exp_f32 v81, v81
    v_exp_f32 v82, v82
    v_exp_f32 v83, v83
    v_mfma_f32_32x32x16_bf16 v[32:47], v[128:131], v[96:99], v[32:47]
    ds_read_b128 v[140:143], v1 offset:31744
    ds_read_b128 v[124:127], v1 offset:37888
    v_exp_f32 v84, v84
    v_exp_f32 v85, v85
    v_exp_f32 v86, v86
    v_exp_f32 v87, v87
    v_cvt_pk_bf16_f32 v104, v80, v81
    v_cvt_pk_bf16_f32 v105, v82, v83
    v_mfma_f32_32x32x16_bf16 v[64:79], v[116:119], v[20:23], v[64:79]
    ds_add_u32 v6, v7 offset:1280
    v_exp_f32 v88, v88
    v_exp_f32 v89, v89
    v_exp_f32 v90, v90
    v_exp_f32 v91, v91
    v_cvt_pk_bf16_f32 v106, v84, v85
    v_cvt_pk_bf16_f32 v107, v86, v87
    v_mfma_f32_32x32x16_bf16 v[32:47], v[132:135], v[100:103], v[32:47]
    v_exp_f32 v92, v92
    v_exp_f32 v93, v93
    v_exp_f32 v94, v94
    v_exp_f32 v95, v95
    v_cvt_pk_bf16_f32 v108, v88, v89
    v_cvt_pk_bf16_f32 v109, v90, v91
    v_cvt_pk_bf16_f32 v110, v92, v93
    v_cvt_pk_bf16_f32 v111, v94, v95
    s_waitcnt lgkmcnt(0)
    v_mfma_f32_32x32x16_bf16 v[80:95], v[120:123], v[16:19], v[48:63]
    ds_read_b128 v[128:131], v1 offset:34816
    ds_read_b128 v[112:115], v1 offset:40960
    v_exp_f32 v64, v64
    v_exp_f32 v65, v65
    v_exp_f32 v66, v66
    v_exp_f32 v67, v67
    v_mfma_f32_32x32x16_bf16 v[32:47], v[136:139], v[104:107], v[32:47]
    ds_read_b128 v[132:135], v1 offset:35840
    ds_read_b128 v[116:119], v1 offset:41984
    v_exp_f32 v68, v68
    v_exp_f32 v69, v69
    v_exp_f32 v70, v70
    v_exp_f32 v71, v71
    v_cvt_pk_bf16_f32 v96, v64, v65
    v_cvt_pk_bf16_f32 v97, v66, v67
    v_mfma_f32_32x32x16_bf16 v[80:95], v[124:127], v[20:23], v[80:95]
    v_exp_f32 v72, v72
    v_exp_f32 v73, v73
    v_exp_f32 v74, v74
    v_exp_f32 v75, v75
    v_cvt_pk_bf16_f32 v98, v68, v69
    v_cvt_pk_bf16_f32 v99, v70, v71
    v_mfma_f32_32x32x16_bf16 v[32:47], v[140:143], v[108:111], v[32:47]
    v_exp_f32 v76, v76
    v_exp_f32 v77, v77
    v_exp_f32 v78, v78
    v_exp_f32 v79, v79
    v_cvt_pk_bf16_f32 v100, v72, v73
    v_cvt_pk_bf16_f32 v101, v74, v75
    v_cvt_pk_bf16_f32 v102, v76, v77
    v_cvt_pk_bf16_f32 v103, v78, v79
    s_waitcnt lgkmcnt(0)
    v_mfma_f32_32x32x16_bf16 v[64:79], v[112:115], v[16:19], v[48:63]
    ds_read_b128 v[136:139], v1 offset:38912
    ds_read_b128 v[120:123], v1 offset:45056
    v_exp_f32 v80, v80
    v_exp_f32 v81, v81
    v_exp_f32 v82, v82
    v_exp_f32 v83, v83
    v_mfma_f32_32x32x16_bf16 v[32:47], v[128:131], v[96:99], v[32:47]
    ds_read_b128 v[140:143], v1 offset:39936
    ds_read_b128 v[124:127], v1 offset:46080
    v_exp_f32 v84, v84
    v_exp_f32 v85, v85
    v_exp_f32 v86, v86
    v_exp_f32 v87, v87
    v_cvt_pk_bf16_f32 v104, v80, v81
    v_cvt_pk_bf16_f32 v105, v82, v83
    v_mfma_f32_32x32x16_bf16 v[64:79], v[116:119], v[20:23], v[64:79]
    ds_read_b32 v5, v6 offset:768
    v_exp_f32 v88, v88
    v_exp_f32 v89, v89
    v_exp_f32 v90, v90
    v_exp_f32 v91, v91
    v_cvt_pk_bf16_f32 v106, v84, v85
    v_cvt_pk_bf16_f32 v107, v86, v87
    v_mfma_f32_32x32x16_bf16 v[32:47], v[132:135], v[100:103], v[32:47]
    v_exp_f32 v92, v92
    v_exp_f32 v93, v93
    v_exp_f32 v94, v94
    v_exp_f32 v95, v95
    v_cvt_pk_bf16_f32 v108, v88, v89
    v_cvt_pk_bf16_f32 v109, v90, v91
    v_cvt_pk_bf16_f32 v110, v92, v93
    v_cvt_pk_bf16_f32 v111, v94, v95
    s_waitcnt lgkmcnt(0)
    v_cmp_gt_u32 vcc, s52, v5
    v_mfma_f32_32x32x16_bf16 v[80:95], v[120:123], v[16:19], v[48:63]
    ds_read_b128 v[128:131], v1 offset:43008
    v_exp_f32 v64, v64
    v_exp_f32 v65, v65
    v_exp_f32 v66, v66
    v_exp_f32 v67, v67
    s_cbranch_vccnz Lsl_111
Lbk_112:
    v_mfma_f32_32x32x16_bf16 v[32:47], v[136:139], v[104:107], v[32:47]
    ds_read_b128 v[132:135], v1 offset:44032
    ds_read_b128 v[112:115], v1 offset:49152
    v_exp_f32 v68, v68
    v_exp_f32 v69, v69
    v_exp_f32 v70, v70
    v_exp_f32 v71, v71
    v_cvt_pk_bf16_f32 v96, v64, v65
    v_cvt_pk_bf16_f32 v97, v66, v67
    v_mfma_f32_32x32x16_bf16 v[80:95], v[124:127], v[20:23], v[80:95]
    ds_read_b128 v[116:119], v1 offset:50176
    v_exp_f32 v72, v72
    v_exp_f32 v73, v73
    v_exp_f32 v74, v74
    v_exp_f32 v75, v75
    v_cvt_pk_bf16_f32 v98, v68, v69
    v_cvt_pk_bf16_f32 v99, v70, v71
    v_mfma_f32_32x32x16_bf16 v[32:47], v[140:143], v[108:111], v[32:47]
    v_exp_f32 v76, v76
    v_exp_f32 v77, v77
    v_exp_f32 v78, v78
    v_exp_f32 v79, v79
    v_cvt_pk_bf16_f32 v100, v72, v73
    v_cvt_pk_bf16_f32 v101, v74, v75
    v_cvt_pk_bf16_f32 v102, v76, v77
    v_cvt_pk_bf16_f32 v103, v78, v79
    s_waitcnt lgkmcnt(0)
    v_mfma_f32_32x32x16_bf16 v[64:79], v[112:115], v[16:19], v[48:63]
    ds_read_b128 v[136:139], v1 offset:47104
    ds_read_b128 v[120:123], v1 offset:53248
    v_exp_f32 v80, v80
    v_exp_f32 v81, v81
    v_exp_f32 v82, v82
    v_exp_f32 v83, v83
    v_mfma_f32_32x32x16_bf16 v[32:47], v[128:131], v[96:99], v[32:47]
    ds_read_b128 v[140:143], v1 offset:48128
    ds_read_b128 v[124:127], v1 offset:54272
    v_exp_f32 v84, v84
    v_exp_f32 v85, v85
    v_exp_f32 v86, v86
    v_exp_f32 v87, v87
    v_cvt_pk_bf16_f32 v104, v80, v81
    v_cvt_pk_bf16_f32 v105, v82, v83
    v_mfma_f32_32x32x16_bf16 v[64:79], v[116:119], v[20:23], v[64:79]
    ds_add_u32 v6, v7 offset:1536
    v_exp_f32 v88, v88
    v_exp_f32 v89, v89
    v_exp_f32 v90, v90
    v_exp_f32 v91, v91
    v_cvt_pk_bf16_f32 v106, v84, v85
    v_cvt_pk_bf16_f32 v107, v86, v87
    v_mfma_f32_32x32x16_bf16 v[32:47], v[132:135], v[100:103], v[32:47]
    v_exp_f32 v92, v92
    v_exp_f32 v93, v93
    v_exp_f32 v94, v94
    v_exp_f32 v95, v95
    v_cvt_pk_bf16_f32 v108, v88, v89
    v_cvt_pk_bf16_f32 v109, v90, v91
    v_cvt_pk_bf16_f32 v110, v92, v93
    v_cvt_pk_bf16_f32 v111, v94, v95
    s_waitcnt lgkmcnt(0)
    v_mfma_f32_32x32x16_bf16 v[80:95], v[120:123], v[16:19], v[48:63]
    ds_read_b128 v[128:131], v1 offset:51200
    ds_read_b128 v[112:115], v1 offset:57344
    v_exp_f32 v64, v64
    v_exp_f32 v65, v65
    v_exp_f32 v66, v66
    v_exp_f32 v67, v67
    v_mfma_f32_32x32x16_bf16 v[32:47], v[136:139], v[104:107], v[32:47]
    ds_read_b128 v[132:135], v1 offset:52224
    ds_read_b128 v[116:119], v1 offset:58368
    v_exp_f32 v68, v68
    v_exp_f32 v69, v69
    v_exp_f32 v70, v70
    v_exp_f32 v71, v71
    v_cvt_pk_bf16_f32 v96, v64, v65
    v_cvt_pk_bf16_f32 v97, v66, v67
    v_mfma_f32_32x32x16_bf16 v[80:95], v[124:127], v[20:23], v[80:95]
    s_add_u32 s52, s52, 4
    s_cmp_eq_u32 s52, 20
    s_cselect_b32 s51, 0, s52
    v_exp_f32 v72, v72
    v_exp_f32 v73, v73
    v_exp_f32 v74, v74
    v_exp_f32 v75, v75
    v_cvt_pk_bf16_f32 v98, v68, v69
    v_cvt_pk_bf16_f32 v99, v70, v71
    v_mfma_f32_32x32x16_bf16 v[32:47], v[140:143], v[108:111], v[32:47]
    v_exp_f32 v76, v76
    v_exp_f32 v77, v77
    v_exp_f32 v78, v78
    v_exp_f32 v79, v79
    v_cvt_pk_bf16_f32 v100, v72, v73
    v_cvt_pk_bf16_f32 v101, v74, v75
    v_cvt_pk_bf16_f32 v102, v76, v77
    v_cvt_pk_bf16_f32 v103, v78, v79
    s_waitcnt lgkmcnt(0)
    v_mfma_f32_32x32x16_bf16 v[64:79], v[112:115], v[16:19], v[48:63]
    ds_read_b128 v[136:139], v1 offset:55296
    ds_read_b128 v[120:123], v1 offset:61440
    v_exp_f32 v80, v80
    v_exp_f32 v81, v81
    v_exp_f32 v82, v82
    v_exp_f32 v83, v83
    v_mfma_f32_32x32x16_bf16 v[32:47], v[128:131], v[96:99], v[32:47]
    ds_read_b128 v[140:143], v1 offset:56320
    ds_read_b128 v[124:127], v1 offset:62464
    v_exp_f32 v84, v84
    v_exp_f32 v85, v85
    v_exp_f32 v86, v86
    v_exp_f32 v87, v87
    v_cvt_pk_bf16_f32 v104, v80, v81
    v_cvt_pk_bf16_f32 v105, v82, v83
    v_mfma_f32_32x32x16_bf16 v[64:79], v[116:119], v[20:23], v[64:79]
    ds_read_b32 v5, v6 offset:0
    v_exp_f32 v88, v88
    v_exp_f32 v89, v89
    v_exp_f32 v90, v90
    v_exp_f32 v91, v91
    v_cvt_pk_bf16_f32 v106, v84, v85
    v_cvt_pk_bf16_f32 v107, v86, v87
    v_mfma_f32_32x32x16_bf16 v[32:47], v[132:135], v[100:103], v[32:47]
    v_exp_f32 v92, v92
    v_exp_f32 v93, v93
    v_exp_f32 v94, v94
    v_exp_f32 v95, v95
    v_cvt_pk_bf16_f32 v108, v88, v89
    v_cvt_pk_bf16_f32 v109, v90, v91
    v_cvt_pk_bf16_f32 v110, v92, v93
    v_cvt_pk_bf16_f32 v111, v94, v95
    s_waitcnt lgkmcnt(0)
    v_cmp_gt_u32 vcc, s51, v5
    v_mfma_f32_32x32x16_bf16 v[80:95], v[120:123], v[16:19], v[48:63]
    ds_read_b128 v[128:131], v1 offset:59392
    v_exp_f32 v64, v64
    v_exp_f32 v65, v65
    v_exp_f32 v66, v66
    v_exp_f32 v67, v67
    s_cbranch_vccnz Lsl_113
Lbk_114:
    v_mfma_f32_32x32x16_bf16 v[32:47], v[136:139], v[104:107], v[32:47]
    ds_read_b128 v[132:135], v1 offset:60416
    ds_read_b128 v[112:115], v1 offset:0
    v_exp_f32 v68, v68
    v_exp_f32 v69, v69
    v_exp_f32 v70, v70
    v_exp_f32 v71, v71
    v_cvt_pk_bf16_f32 v96, v64, v65
    v_cvt_pk_bf16_f32 v97, v66, v67
    v_mfma_f32_32x32x16_bf16 v[80:95], v[124:127], v[20:23], v[80:95]
    ds_read_b128 v[116:119], v1 offset:1024
    v_exp_f32 v72, v72
    v_exp_f32 v73, v73
    v_exp_f32 v74, v74
    v_exp_f32 v75, v75
    v_cvt_pk_bf16_f32 v98, v68, v69
    v_cvt_pk_bf16_f32 v99, v70, v71
    v_mfma_f32_32x32x16_bf16 v[32:47], v[140:143], v[108:111], v[32:47]
    v_exp_f32 v76, v76
    v_exp_f32 v77, v77
    v_exp_f32 v78, v78
    v_exp_f32 v79, v79
    v_cvt_pk_bf16_f32 v100, v72, v73
    v_cvt_pk_bf16_f32 v101, v74, v75
    v_cvt_pk_bf16_f32 v102, v76, v77
    v_cvt_pk_bf16_f32 v103, v78, v79
    s_waitcnt lgkmcnt(0)
    v_mfma_f32_32x32x16_bf16 v[64:79], v[112:115], v[16:19], v[48:63]
    ds_read_b128 v[136:139], v1 offset:63488
    ds_read_b128 v[120:123], v1 offset:4096
    v_exp_f32 v80, v80
    v_exp_f32 v81, v81
    v_exp_f32 v82, v82
    v_exp_f32 v83, v83
    v_mfma_f32_32x32x16_bf16 v[32:47], v[128:131], v[96:99], v[32:47]
    ds_read_b128 v[140:143], v1 offset:64512
    ds_read_b128 v[124:127], v1 offset:5120
    v_exp_f32 v84, v84
    v_exp_f32 v85, v85
    v_exp_f32 v86, v86
    v_exp_f32 v87, v87
    v_cvt_pk_bf16_f32 v104, v80, v81
    v_cvt_pk_bf16_f32 v105, v82, v83
    v_mfma_f32_32x32x16_bf16 v[64:79], v[116:119], v[20:23], v[64:79]
    ds_add_u32 v6, v7 offset:1792
    v_exp_f32 v88, v88
    v_exp_f32 v89, v89
    v_exp_f32 v90, v90
    v_exp_f32 v91, v91
    v_cvt_pk_bf16_f32 v106, v84, v85
    v_cvt_pk_bf16_f32 v107, v86, v87
    v_mfma_f32_32x32x16_bf16 v[32:47], v[132:135], v[100:103], v[32:47]
    v_exp_f32 v92, v92
    v_exp_f32 v93, v93
    v_exp_f32 v94, v94
    v_exp_f32 v95, v95
    v_cvt_pk_bf16_f32 v108, v88, v89
    v_cvt_pk_bf16_f32 v109, v90, v91
    v_cvt_pk_bf16_f32 v110, v92, v93
    v_cvt_pk_bf16_f32 v111, v94, v95
    s_cmp_lt_u32 s52, 16
    s_cbranch_scc1 Lattn
    s_waitcnt lgkmcnt(0)
    v_mfma_f32_32x32x16_bf16 v[80:95], v[120:123], v[16:19], v[48:63]
    ds_read_b128 v[128:131], v1 offset:2048
    ds_read_b128 v[112:115], v1 offset:8192
    v_exp_f32 v64, v64
    v_exp_f32 v65, v65
    v_exp_f32 v66, v66
    v_exp_f32 v67, v67
    v_mfma_f32_32x32x16_bf16 v[32:47], v[136:139], v[104:107], v[32:47]
    ds_read_b128 v[132:135], v1 offset:3072
    ds_read_b128 v[116:119], v1 offset:9216
    v_exp_f32 v68, v68
    v_exp_f32 v69, v69
    v_exp_f32 v70, v70
    v_exp_f32 v71, v71
    v_cvt_pk_bf16_f32 v96, v64, v65
    v_cvt_pk_bf16_f32 v97, v66, v67
    v_mfma_f32_32x32x16_bf16 v[80:95], v[124:127], v[20:23], v[80:95]
    v_exp_f32 v72, v72
    v_exp_f32 v73, v73
    v_exp_f32 v74, v74
    v_exp_f32 v75, v75
    v_cvt_pk_bf16_f32 v98, v68, v69
    v_cvt_pk_bf16_f32 v99, v70, v71
    v_mfma_f32_32x32x16_bf16 v[32:47], v[140:143], v[108:111], v[32:47]
    v_exp_f32 v76, v76
    v_exp_f32 v77, v77
    v_exp_f32 v78, v78
    v_exp_f32 v79, v79
    v_cvt_pk_bf16_f32 v100, v72, v73
    v_cvt_pk_bf16_f32 v101, v74, v75
    v_cvt_pk_bf16_f32 v102, v76, v77
    v_cvt_pk_bf16_f32 v103, v78, v79
    s_waitcnt lgkmcnt(0)
    v_mfma_f32_32x32x16_bf16 v[64:79], v[112:115], v[16:19], v[48:63]
    buffer_load_dwordx4 v[184:187], v1, s[28:31], s94 offen offset:0
    ds_read_b128 v[136:139], v1 offset:6144
    ds_read_b128 v[120:123], v1 offset:12288
    v_exp_f32 v80, v80
    v_exp_f32 v81, v81
    v_exp_f32 v82, v82
    v_exp_f32 v83, v83
    v_mfma_f32_32x32x16_bf16 v[32:47], v[128:131], v[96:99], v[32:47]
    ds_read_b128 v[140:143], v1 offset:7168
    ds_read_b128 v[124:127], v1 offset:13312
    v_exp_f32 v84, v84
    v_exp_f32 v85, v85
    v_exp_f32 v86, v86
    v_exp_f32 v87, v87
    v_cvt_pk_bf16_f32 v104, v80, v81
    v_cvt_pk_bf16_f32 v105, v82, v83
    v_mfma_f32_32x32x16_bf16 v[64:79], v[116:119], v[20:23], v[64:79]
    ds_read_b32 v5, v6 offset:256
    v_exp_f32 v88, v88
    v_exp_f32 v89, v89
    v_exp_f32 v90, v90
    v_exp_f32 v91, v91
    v_cvt_pk_bf16_f32 v106, v84, v85
    v_cvt_pk_bf16_f32 v107, v86, v87
    v_mfma_f32_32x32x16_bf16 v[32:47], v[132:135], v[100:103], v[32:47]
    buffer_load_dwordx4 v[188:191], v13, s[28:31], s94 offen offset:1024
    v_exp_f32 v92, v92
    v_exp_f32 v93, v93
    v_exp_f32 v94, v94
    v_exp_f32 v95, v95
    v_cvt_pk_bf16_f32 v108, v88, v89
    v_cvt_pk_bf16_f32 v109, v90, v91
    v_cvt_pk_bf16_f32 v110, v92, v93
    v_cvt_pk_bf16_f32 v111, v94, v95
    s_waitcnt lgkmcnt(0)
    v_cmp_gt_u32 vcc, s52, v5
    v_mfma_f32_32x32x16_bf16 v[80:95], v[120:123], v[16:19], v[48:63]
    ds_read_b128 v[128:131], v1 offset:10240
    v_exp_f32 v64, v64
    v_exp_f32 v65, v65
    v_exp_f32 v66, v66
    v_exp_f32 v67, v67
    s_cbranch_vccnz Lsl_115
Lbk_116:
    v_mfma_f32_32x32x16_bf16 v[32:47], v[136:139], v[104:107], v[32:47]
    ds_read_b128 v[132:135], v1 offset:11264
    ds_read_b128 v[112:115], v1 offset:16384
    v_exp_f32 v68, v68
    v_exp_f32 v69, v69
    v_exp_f32 v70, v70
    v_exp_f32 v71, v71
    v_cvt_pk_bf16_f32 v96, v64, v65
    v_cvt_pk_bf16_f32 v97, v66, v67
    v_mfma_f32_32x32x16_bf16 v[80:95], v[124:127], v[20:23], v[80:95]
    buffer_load_dwordx4 v[192:195], v1, s[28:31], s94 offen offset:1792
    ds_read_b128 v[116:119], v1 offset:17408
    v_exp_f32 v72, v72
    v_exp_f32 v73, v73
    v_exp_f32 v74, v74
    v_exp_f32 v75, v75
    v_cvt_pk_bf16_f32 v98, v68, v69
    v_cvt_pk_bf16_f32 v99, v70, v71
    v_mfma_f32_32x32x16_bf16 v[32:47], v[140:143], v[108:111], v[32:47]
    v_exp_f32 v76, v76
    v_exp_f32 v77, v77
    v_exp_f32 v78, v78
    v_exp_f32 v79, v79
    v_cvt_pk_bf16_f32 v100, v72, v73
    v_cvt_pk_bf16_f32 v101, v74, v75
    v_cvt_pk_bf16_f32 v102, v76, v77
    v_cvt_pk_bf16_f32 v103, v78, v79
    s_waitcnt lgkmcnt(0)
    v_mfma_f32_32x32x16_bf16 v[64:79], v[112:115], v[16:19], v[48:63]
    ds_read_b128 v[136:139], v1 offset:14336
    ds_read_b128 v[120:123], v1 offset:20480
    v_exp_f32 v80, v80
    v_exp_f32 v81, v81
    v_exp_f32 v82, v82
    v_exp_f32 v83, v83
    v_mfma_f32_32x32x16_bf16 v[32:47], v[128:131], v[96:99], v[32:47]
    buffer_load_dwordx4 v[196:199], v13, s[28:31], s94 offen offset:2816
    ds_read_b128 v[140:143], v1 offset:15360
    ds_read_b128 v[124:127], v1 offset:21504
    v_exp_f32 v84, v84
    v_exp_f32 v85, v85
    v_exp_f32 v86, v86
    v_exp_f32 v87, v87
    v_cvt_pk_bf16_f32 v104, v80, v81
    v_cvt_pk_bf16_f32 v105, v82, v83
    v_mfma_f32_32x32x16_bf16 v[64:79], v[116:119], v[20:23], v[64:79]
    ds_add_u32 v6, v7 offset:1024
    v_exp_f32 v88, v88
    v_exp_f32 v89, v89
    v_exp_f32 v90, v90
    v_exp_f32 v91, v91
    v_cvt_pk_bf16_f32 v106, v84, v85
    v_cvt_pk_bf16_f32 v107, v86, v87
    v_mfma_f32_32x32x16_bf16 v[32:47], v[132:135], v[100:103], v[32:47]
    v_exp_f32 v92, v92
    v_exp_f32 v93, v93
    v_exp_f32 v94, v94
    v_exp_f32 v95, v95
    v_cvt_pk_bf16_f32 v108, v88, v89
    v_cvt_pk_bf16_f32 v109, v90, v91
    v_cvt_pk_bf16_f32 v110, v92, v93
    v_cvt_pk_bf16_f32 v111, v94, v95
    s_waitcnt lgkmcnt(0)
    v_mfma_f32_32x32x16_bf16 v[80:95], v[120:123], v[16:19], v[48:63]
    s_add_u32 s94, s94, 3584
    buffer_load_dwordx4 v[200:203], v1, s[28:31], s94 offen offset:0
    ds_read_b128 v[128:131], v1 offset:18432
    ds_read_b128 v[112:115], v1 offset:24576
    v_exp_f32 v64, v64
    v_exp_f32 v65, v65
    v_exp_f32 v66, v66
    v_exp_f32 v67, v67
    v_mfma_f32_32x32x16_bf16 v[32:47], v[136:139], v[104:107], v[32:47]
    ds_read_b128 v[132:135], v1 offset:19456
    ds_read_b128 v[116:119], v1 offset:25600
    v_exp_f32 v68, v68
    v_exp_f32 v69, v69
    v_exp_f32 v70, v70
    v_exp_f32 v71, v71
    v_cvt_pk_bf16_f32 v96, v64, v65
    v_cvt_pk_bf16_f32 v97, v66, v67
    v_mfma_f32_32x32x16_bf16 v[80:95], v[124:127], v[20:23], v[80:95]
    v_exp_f32 v72, v72
    v_exp_f32 v73, v73
    v_exp_f32 v74, v74
    v_exp_f32 v75, v75
    v_cvt_pk_bf16_f32 v98, v68, v69
    v_cvt_pk_bf16_f32 v99, v70, v71
    v_mfma_f32_32x32x16_bf16 v[32:47], v[140:143], v[108:111], v[32:47]
    buffer_load_dwordx4 v[204:207], v13, s[28:31], s94 offen offset:1024
    v_exp_f32 v76, v76
    v_exp_f32 v77, v77
    v_exp_f32 v78, v78
    v_exp_f32 v79, v79
    v_cvt_pk_bf16_f32 v100, v72, v73
    v_cvt_pk_bf16_f32 v101, v74, v75
    v_cvt_pk_bf16_f32 v102, v76, v77
    v_cvt_pk_bf16_f32 v103, v78, v79
    s_waitcnt lgkmcnt(0)
    v_mfma_f32_32x32x16_bf16 v[64:79], v[112:115], v[16:19], v[48:63]
    ds_read_b128 v[136:139], v1 offset:22528
    ds_read_b128 v[120:123], v1 offset:28672
    v_exp_f32 v80, v80
    v_exp_f32 v81, v81
    v_exp_f32 v82, v82
    v_exp_f32 v83, v83
    v_mfma_f32_32x32x16_bf16 v[32:47], v[128:131], v[96:99], v[32:47]
    ds_read_b128 v[140:143], v1 offset:23552
    ds_read_b128 v[124:127], v1 offset:29696
    v_exp_f32 v84, v84
    v_exp_f32 v85, v85
    v_exp_f32 v86, v86
    v_exp_f32 v87, v87
    v_cvt_pk_bf16_f32 v104, v80, v81
    v_cvt_pk_bf16_f32 v105, v82, v83
    v_mfma_f32_32x32x16_bf16 v[64:79], v[116:119], v[20:23], v[64:79]
    buffer_load_dwordx4 v[208:211], v1, s[28:31], s94 offen offset:1792
    ds_read_b32 v5, v6 offset:512
    v_exp_f32 v88, v88
    v_exp_f32 v89, v89
    v_exp_f32 v90, v90
    v_exp_f32 v91, v91
    v_cvt_pk_bf16_f32 v106, v84, v85
    v_cvt_pk_bf16_f32 v107, v86, v87
    v_mfma_f32_32x32x16_bf16 v[32:47], v[132:135], v[100:103], v[32:47]
    v_exp_f32 v92, v92
    v_exp_f32 v93, v93
    v_exp_f32 v94, v94
    v_exp_f32 v95, v95
    v_cvt_pk_bf16_f32 v108, v88, v89
    v_cvt_pk_bf16_f32 v109, v90, v91
    v_cvt_pk_bf16_f32 v110, v92, v93
    v_cvt_pk_bf16_f32 v111, v94, v95
    s_waitcnt lgkmcnt(0)
    v_cmp_gt_u32 vcc, s52, v5
    v_mfma_f32_32x32x16_bf16 v[80:95], v[120:123], v[16:19], v[48:63]
    ds_read_b128 v[128:131], v1 offset:26624
    v_exp_f32 v64, v64
    v_exp_f32 v65, v65
    v_exp_f32 v66, v66
    v_exp_f32 v67, v67
    s_cbranch_vccnz Lsl_117
Lbk_118:
    v_mfma_f32_32x32x16_bf16 v[32:47], v[136:139], v[104:107], v[32:47]
    buffer_load_dwordx4 v[212:215], v13, s[28:31], s94 offen offset:2816
    ds_read_b128 v[132:135], v1 offset:27648
    ds_read_b128 v[112:115], v1 offset:32768
    v_exp_f32 v68, v68
    v_exp_f32 v69, v69
    v_exp_f32 v70, v70
    v_exp_f32 v71, v71
    v_cvt_pk_bf16_f32 v96, v64, v65
    v_cvt_pk_bf16_f32 v97, v66, v67
    v_mfma_f32_32x32x16_bf16 v[80:95], v[124:127], v[20:23], v[80:95]
    ds_read_b128 v[116:119], v1 offset:33792
    v_exp_f32 v72, v72
    v_exp_f32 v73, v73
    v_exp_f32 v74, v74
    v_exp_f32 v75, v75
    v_cvt_pk_bf16_f32 v98, v68, v69
    v_cvt_pk_bf16_f32 v99, v70, v71
    v_mfma_f32_32x32x16_bf16 v[32:47], v[140:143], v[108:111], v[32:47]
    v_exp_f32 v76, v76
    v_exp_f32 v77, v77
    v_exp_f32 v78, v78
    v_exp_f32 v79, v79
    v_cvt_pk_bf16_f32 v100, v72, v73
    v_cvt_pk_bf16_f32 v101, v74, v75
    v_cvt_pk_bf16_f32 v102, v76, v77
    v_cvt_pk_bf16_f32 v103, v78, v79
    s_waitcnt lgkmcnt(0)
    v_mfma_f32_32x32x16_bf16 v[64:79], v[112:115], v[16:19], v[48:63]
    s_add_u32 s94, s94, 3584
    buffer_load_dwordx4 v[216:219], v1, s[28:31], s94 offen offset:0
    ds_read_b128 v[136:139], v1 offset:30720
    ds_read_b128 v[120:123], v1 offset:36864
    v_exp_f32 v80, v80
    v_exp_f32 v81, v81
    v_exp_f32 v82, v82
    v_exp_f32 v83, v83
    v_mfma_f32_32x32x16_bf16 v[32:47], v[128:131], v[96:99], v[32:47]
    ds_read_b128 v[140:143], v1 offset:31744
    ds_read_b128 v[124:127], v1 offset:37888
    v_exp_f32 v84, v84
    v_exp_f32 v85, v85
    v_exp_f32 v86, v86
    v_exp_f32 v87, v87
    v_cvt_pk_bf16_f32 v104, v80, v81
    v_cvt_pk_bf16_f32 v105, v82, v83
    v_mfma_f32_32x32x16_bf16 v[64:79], v[116:119], v[20:23], v[64:79]
    ds_add_u32 v6, v7 offset:1280
    v_exp_f32 v88, v88
    v_exp_f32 v89, v89
    v_exp_f32 v90, v90
    v_exp_f32 v91, v91
    v_cvt_pk_bf16_f32 v106, v84, v85
    v_cvt_pk_bf16_f32 v107, v86, v87
    v_mfma_f32_32x32x16_bf16 v[32:47], v[132:135], v[100:103], v[32:47]
    buffer_load_dwordx4 v[220:223], v13, s[28:31], s94 offen offset:1024
    v_exp_f32 v92, v92
    v_exp_f32 v93, v93
    v_exp_f32 v94, v94
    v_exp_f32 v95, v95
    v_cvt_pk_bf16_f32 v108, v88, v89
    v_cvt_pk_bf16_f32 v109, v90, v91
    v_cvt_pk_bf16_f32 v110, v92, v93
    v_cvt_pk_bf16_f32 v111, v94, v95
    s_waitcnt lgkmcnt(0)
    v_mfma_f32_32x32x16_bf16 v[80:95], v[120:123], v[16:19], v[48:63]
    ds_read_b128 v[128:131], v1 offset:34816
    ds_read_b128 v[112:115], v1 offset:40960
    v_exp_f32 v64, v64
    v_exp_f32 v65, v65
    v_exp_f32 v66, v66
    v_exp_f32 v67, v67
    v_mfma_f32_32x32x16_bf16 v[32:47], v[136:139], v[104:107], v[32:47]
    ds_read_b128 v[132:135], v1 offset:35840
    ds_read_b128 v[116:119], v1 offset:41984
    v_exp_f32 v68, v68
    v_exp_f32 v69, v69
    v_exp_f32 v70, v70
    v_exp_f32 v71, v71
    v_cvt_pk_bf16_f32 v96, v64, v65
    v_cvt_pk_bf16_f32 v97, v66, v67
    v_mfma_f32_32x32x16_bf16 v[80:95], v[124:127], v[20:23], v[80:95]
    buffer_load_dwordx4 v[224:227], v1, s[28:31], s94 offen offset:1792
    v_exp_f32 v72, v72
    v_exp_f32 v73, v73
    v_exp_f32 v74, v74
    v_exp_f32 v75, v75
    v_cvt_pk_bf16_f32 v98, v68, v69
    v_cvt_pk_bf16_f32 v99, v70, v71
    v_mfma_f32_32x32x16_bf16 v[32:47], v[140:143], v[108:111], v[32:47]
    v_exp_f32 v76, v76
    v_exp_f32 v77, v77
    v_exp_f32 v78, v78
    v_exp_f32 v79, v79
    v_cvt_pk_bf16_f32 v100, v72, v73
    v_cvt_pk_bf16_f32 v101, v74, v75
    v_cvt_pk_bf16_f32 v102, v76, v77
    v_cvt_pk_bf16_f32 v103, v78, v79
    s_waitcnt lgkmcnt(0)
    v_mfma_f32_32x32x16_bf16 v[64:79], v[112:115], v[16:19], v[48:63]
    ds_read_b128 v[136:139], v1 offset:38912
    ds_read_b128 v[120:123], v1 offset:45056
    v_exp_f32 v80, v80
    v_exp_f32 v81, v81
    v_exp_f32 v82, v82
    v_exp_f32 v83, v83
    v_mfma_f32_32x32x16_bf16 v[32:47], v[128:131], v[96:99], v[32:47]
    buffer_load_dwordx4 v[228:231], v13, s[28:31], s94 offen offset:2816
    ds_read_b128 v[140:143], v1 offset:39936
    ds_read_b128 v[124:127], v1 offset:46080
    v_exp_f32 v84, v84
    v_exp_f32 v85, v85
    v_exp_f32 v86, v86
    v_exp_f32 v87, v87
    v_cvt_pk_bf16_f32 v104, v80, v81
    v_cvt_pk_bf16_f32 v105, v82, v83
    v_mfma_f32_32x32x16_bf16 v[64:79], v[116:119], v[20:23], v[64:79]
    ds_read_b32 v5, v6 offset:768
    v_exp_f32 v88, v88
    v_exp_f32 v89, v89
    v_exp_f32 v90, v90
    v_exp_f32 v91, v91
    v_cvt_pk_bf16_f32 v106, v84, v85
    v_cvt_pk_bf16_f32 v107, v86, v87
    v_mfma_f32_32x32x16_bf16 v[32:47], v[132:135], v[100:103], v[32:47]
    v_exp_f32 v92, v92
    v_exp_f32 v93, v93
    v_exp_f32 v94, v94
    v_exp_f32 v95, v95
    v_cvt_pk_bf16_f32 v108, v88, v89
    v_cvt_pk_bf16_f32 v109, v90, v91
    v_cvt_pk_bf16_f32 v110, v92, v93
    v_cvt_pk_bf16_f32 v111, v94, v95
    s_waitcnt lgkmcnt(0)
    v_cmp_gt_u32 vcc, s52, v5
    v_mfma_f32_32x32x16_bf16 v[80:95], v[120:123], v[16:19], v[48:63]
    s_add_u32 s94, s94, 3584
    buffer_load_dwordx4 v[232:235], v1, s[28:31], s94 offen offset:0
    ds_read_b128 v[128:131], v1 offset:43008
    v_exp_f32 v64, v64
    v_exp_f32 v65, v65
    v_exp_f32 v66, v66
    v_exp_f32 v67, v67
    s_cbranch_vccnz Lsl_119
Lbk_120:
    v_mfma_f32_32x32x16_bf16 v[32:47], v[136:139], v[104:107], v[32:47]
    ds_read_b128 v[132:135], v1 offset:44032
    ds_read_b128 v[112:115], v1 offset:49152
    v_exp_f32 v68, v68
    v_exp_f32 v69, v69
    v_exp_f32 v70, v70
    v_exp_f32 v71, v71
    v_cvt_pk_bf16_f32 v96, v64, v65
    v_cvt_pk_bf16_f32 v97, v66, v67
    v_mfma_f32_32x32x16_bf16 v[80:95], v[124:127], v[20:23], v[80:95]
    ds_read_b128 v[116:119], v1 offset:50176
    v_exp_f32 v72, v72
    v_exp_f32 v73, v73
    v_exp_f32 v74, v74
    v_exp_f32 v75, v75
    v_cvt_pk_bf16_f32 v98, v68, v69
    v_cvt_pk_bf16_f32 v99, v70, v71
    v_mfma_f32_32x32x16_bf16 v[32:47], v[140:143], v[108:111], v[32:47]
    buffer_load_dwordx4 v[236:239], v13, s[28:31], s94 offen offset:1024
    v_exp_f32 v76, v76
    v_exp_f32 v77, v77
    v_exp_f32 v78, v78
    v_exp_f32 v79, v79
    v_cvt_pk_bf16_f32 v100, v72, v73
    v_cvt_pk_bf16_f32 v101, v74, v75
    v_cvt_pk_bf16_f32 v102, v76, v77
    v_cvt_pk_bf16_f32 v103, v78, v79
    s_waitcnt lgkmcnt(0)
    v_mfma_f32_32x32x16_bf16 v[64:79], v[112:115], v[16:19], v[48:63]
    ds_read_b128 v[136:139], v1 offset:47104
    ds_read_b128 v[120:123], v1 offset:53248
    v_exp_f32 v80, v80
    v_exp_f32 v81, v81
    v_exp_f32 v82, v82
    v_exp_f32 v83, v83
    v_mfma_f32_32x32x16_bf16 v[32:47], v[128:131], v[96:99], v[32:47]
    ds_read_b128 v[140:143], v1 offset:48128
    ds_read_b128 v[124:127], v1 offset:54272
    v_exp_f32 v84, v84
    v_exp_f32 v85, v85
    v_exp_f32 v86, v86
    v_exp_f32 v87, v87
    v_cvt_pk_bf16_f32 v104, v80, v81
    v_cvt_pk_bf16_f32 v105, v82, v83
    v_mfma_f32_32x32x16_bf16 v[64:79], v[116:119], v[20:23], v[64:79]
    buffer_load_dwordx4 v[240:243], v1, s[28:31], s94 offen offset:1792
    ds_add_u32 v6, v7 offset:1536
    v_exp_f32 v88, v88
    v_exp_f32 v89, v89
    v_exp_f32 v90, v90
    v_exp_f32 v91, v91
    v_cvt_pk_bf16_f32 v106, v84, v85
    v_cvt_pk_bf16_f32 v107, v86, v87
    v_mfma_f32_32x32x16_bf16 v[32:47], v[132:135], v[100:103], v[32:47]
    v_exp_f32 v92, v92
    v_exp_f32 v93, v93
    v_exp_f32 v94, v94
    v_exp_f32 v95, v95
    v_cvt_pk_bf16_f32 v108, v88, v89
    v_cvt_pk_bf16_f32 v109, v90, v91
    v_cvt_pk_bf16_f32 v110, v92, v93
    v_cvt_pk_bf16_f32 v111, v94, v95
    s_waitcnt lgkmcnt(0)
    v_mfma_f32_32x32x16_bf16 v[80:95], v[120:123], v[16:19], v[48:63]
    ds_read_b128 v[128:131], v1 offset:51200
    ds_read_b128 v[112:115], v1 offset:57344
    v_exp_f32 v64, v64
    v_exp_f32 v65, v65
    v_exp_f32 v66, v66
    v_exp_f32 v67, v67
    v_mfma_f32_32x32x16_bf16 v[32:47], v[136:139], v[104:107], v[32:47]
    buffer_load_dwordx4 v[244:247], v13, s[28:31], s94 offen offset:2816
    ds_read_b128 v[132:135], v1 offset:52224
    ds_read_b128 v[116:119], v1 offset:58368
    v_exp_f32 v68, v68
    v_exp_f32 v69, v69
    v_exp_f32 v70, v70
    v_exp_f32 v71, v71
    v_cvt_pk_bf16_f32 v96, v64, v65
    v_cvt_pk_bf16_f32 v97, v66, v67
    v_mfma_f32_32x32x16_bf16 v[80:95], v[124:127], v[20:23], v[80:95]
    s_add_u32 s52, s52, 4
    s_cmp_eq_u32 s52, 20
    s_cselect_b32 s51, 0, s52
    v_exp_f32 v72, v72
    v_exp_f32 v73, v73
    v_exp_f32 v74, v74
    v_exp_f32 v75, v75
    v_cvt_pk_bf16_f32 v98, v68, v69
    v_cvt_pk_bf16_f32 v99, v70, v71
    v_mfma_f32_32x32x16_bf16 v[32:47], v[140:143], v[108:111], v[32:47]
    v_exp_f32 v76, v76
    v_exp_f32 v77, v77
    v_exp_f32 v78, v78
    v_exp_f32 v79, v79
    v_cvt_pk_bf16_f32 v100, v72, v73
    v_cvt_pk_bf16_f32 v101, v74, v75
    v_cvt_pk_bf16_f32 v102, v76, v77
    v_cvt_pk_bf16_f32 v103, v78, v79
    s_waitcnt lgkmcnt(0)
    v_mfma_f32_32x32x16_bf16 v[64:79], v[112:115], v[16:19], v[48:63]
    s_add_u32 s94, s94, 3584
    buffer_load_dwordx4 v[248:251], v1, s[28:31], s94 offen offset:0
    ds_read_b128 v[136:139], v1 offset:55296
    ds_read_b128 v[120:123], v1 offset:61440
    v_exp_f32 v80, v80
    v_exp_f32 v81, v81
    v_exp_f32 v82, v82
    v_exp_f32 v83, v83
    v_mfma_f32_32x32x16_bf16 v[32:47], v[128:131], v[96:99], v[32:47]
    ds_read_b128 v[140:143], v1 offset:56320
    ds_read_b128 v[124:127], v1 offset:62464
    v_exp_f32 v84, v84
    v_exp_f32 v85, v85
    v_exp_f32 v86, v86
    v_exp_f32 v87, v87
    v_cvt_pk_bf16_f32 v104, v80, v81
    v_cvt_pk_bf16_f32 v105, v82, v83
    v_mfma_f32_32x32x16_bf16 v[64:79], v[116:119], v[20:23], v[64:79]
    ds_read_b32 v5, v6 offset:0
    v_exp_f32 v88, v88
    v_exp_f32 v89, v89
    v_exp_f32 v90, v90
    v_exp_f32 v91, v91
    v_cvt_pk_bf16_f32 v106, v84, v85
    v_cvt_pk_bf16_f32 v107, v86, v87
    v_mfma_f32_32x32x16_bf16 v[32:47], v[132:135], v[100:103], v[32:47]
    buffer_load_dwordx4 v[252:255], v13, s[28:31], s94 offen offset:1024
    v_exp_f32 v92, v92
    v_exp_f32 v93, v93
    v_exp_f32 v94, v94
    v_exp_f32 v95, v95
    v_cvt_pk_bf16_f32 v108, v88, v89
    v_cvt_pk_bf16_f32 v109, v90, v91
    v_cvt_pk_bf16_f32 v110, v92, v93
    v_cvt_pk_bf16_f32 v111, v94, v95
    s_waitcnt lgkmcnt(0)
    v_cmp_gt_u32 vcc, s51, v5
    v_mfma_f32_32x32x16_bf16 v[80:95], v[120:123], v[16:19], v[48:63]
    ds_read_b128 v[128:131], v1 offset:59392
    v_exp_f32 v64, v64
    v_exp_f32 v65, v65
    v_exp_f32 v66, v66
    v_exp_f32 v67, v67
    s_cbranch_vccnz Lsl_121
Lbk_122:
    v_mfma_f32_32x32x16_bf16 v[32:47], v[136:139], v[104:107], v[32:47]
    ds_read_b128 v[132:135], v1 offset:60416
    ds_read_b128 v[112:115], v1 offset:0
    v_exp_f32 v68, v68
    v_exp_f32 v69, v69
    v_exp_f32 v70, v70
    v_exp_f32 v71, v71
    v_cvt_pk_bf16_f32 v96, v64, v65
    v_cvt_pk_bf16_f32 v97, v66, v67
    v_mfma_f32_32x32x16_bf16 v[80:95], v[124:127], v[20:23], v[80:95]
    ds_read_b128 v[116:119], v1 offset:1024
    v_exp_f32 v72, v72
    v_exp_f32 v73, v73
    v_exp_f32 v74, v74
    v_exp_f32 v75, v75
    v_cvt_pk_bf16_f32 v98, v68, v69
    v_cvt_pk_bf16_f32 v99, v70, v71
    v_mfma_f32_32x32x16_bf16 v[32:47], v[140:143], v[108:111], v[32:47]
    v_exp_f32 v76, v76
    v_exp_f32 v77, v77
    v_exp_f32 v78, v78
    v_exp_f32 v79, v79
    v_cvt_pk_bf16_f32 v100, v72, v73
    v_cvt_pk_bf16_f32 v101, v74, v75
    v_cvt_pk_bf16_f32 v102, v76, v77
    v_cvt_pk_bf16_f32 v103, v78, v79
    s_waitcnt lgkmcnt(0)
    v_mfma_f32_32x32x16_bf16 v[64:79], v[112:115], v[16:19], v[48:63]
    ds_read_b128 v[136:139], v1 offset:63488
    ds_read_b128 v[120:123], v1 offset:4096
    v_exp_f32 v80, v80
    v_exp_f32 v81, v81
    v_exp_f32 v82, v82
    v_exp_f32 v83, v83
    v_mfma_f32_32x32x16_bf16 v[32:47], v[128:131], v[96:99], v[32:47]
    ds_read_b128 v[140:143], v1 offset:64512
    ds_read_b128 v[124:127], v1 offset:5120
    v_exp_f32 v84, v84
    v_exp_f32 v85, v85
    v_exp_f32 v86, v86
    v_exp_f32 v87, v87
    v_cvt_pk_bf16_f32 v104, v80, v81
    v_cvt_pk_bf16_f32 v105, v82, v83
    v_mfma_f32_32x32x16_bf16 v[64:79], v[116:119], v[20:23], v[64:79]
    ds_add_u32 v6, v7 offset:1792
    v_exp_f32 v88, v88
    v_exp_f32 v89, v89
    v_exp_f32 v90, v90
    v_exp_f32 v91, v91
    v_cvt_pk_bf16_f32 v106, v84, v85
    v_cvt_pk_bf16_f32 v107, v86, v87
    v_mfma_f32_32x32x16_bf16 v[32:47], v[132:135], v[100:103], v[32:47]
    v_exp_f32 v92, v92
    v_exp_f32 v93, v93
    v_exp_f32 v94, v94
    v_exp_f32 v95, v95
    v_cvt_pk_bf16_f32 v108, v88, v89
    v_cvt_pk_bf16_f32 v109, v90, v91
    v_cvt_pk_bf16_f32 v110, v92, v93
    v_cvt_pk_bf16_f32 v111, v94, v95
    s_waitcnt lgkmcnt(0)
    v_mfma_f32_32x32x16_bf16 v[32:47], v[136:139], v[104:107], v[32:47]
    v_mfma_f32_32x32x16_bf16 v[32:47], v[140:143], v[108:111], v[32:47]
    s_lshl_b32 s47, s63, 2
    s_add_u32 s47, s47, s39
    s_lshl_b32 s47, s47, 4
    s_add_u32 s47, s47, s62
    s_lshl_b32 s47, s47, 11
    s_add_u32 s54, s47, 29360128
    s_mov_b32 s53, 0
Lofin:
    s_nop 6
    v_mov_b32 v4, v44
    v_mov_b32 v5, v44
    s_nop 1
    v_permlane32_swap_b32 v4, v5
    v_rcp_f32 v4, v5
    s_mov_b32 s47, 0x71800000
    s_mov_b32 s48, 0x21800000
    v_add_f32_e64 v72, |v32|, |v33|
    v_add_f32_e64 v73, |v34|, |v35|
    v_add_f32_e64 v74, |v36|, |v37|
    v_add_f32_e64 v75, |v38|, |v39|
    v_add_f32_e64 v76, |v40|, |v41|
    v_add_f32_e64 v77, |v42|, |v43|
    v_add_f32_e64 v78, |v44|, |v45|
    v_add_f32_e64 v79, |v46|, |v47|
    v_cmp_ngt_f32 s[48:49], v5, s48
    v_pk_add_f32 v[72:73], v[72:73], v[76:77]
    v_pk_add_f32 v[74:75], v[74:75], v[78:79]
    v_pk_mul_f32 v[32:33], v[32:33], v[4:5] op_sel_hi:[1,0]
    v_pk_mul_f32 v[34:35], v[34:35], v[4:5] op_sel_hi:[1,0]
    v_pk_add_f32 v[72:73], v[72:73], v[74:75]
    v_pk_mul_f32 v[36:37], v[36:37], v[4:5] op_sel_hi:[1,0]
    v_pk_mul_f32 v[38:39], v[38:39], v[4:5] op_sel_hi:[1,0]
    v_add_f32 v6, v72, v73
    v_pk_mul_f32 v[40:41], v[40:41], v[4:5] op_sel_hi:[1,0]
    v_pk_mul_f32 v[42:43], v[42:43], v[4:5] op_sel_hi:[1,0]
    v_cmp_nlt_f32 vcc, v6, s47
    v_pk_mul_f32 v[44:45], v[44:45], v[4:5] op_sel_hi:[1,0]
    v_pk_mul_f32 v[46:47], v[46:47], v[4:5] op_sel_hi:[1,0]
    v_cvt_pk_bf16_f32 v64, v32, v33
    v_cvt_pk_bf16_f32 v65, v34, v35
    v_cvt_pk_bf16_f32 v66, v36, v37
    v_cvt_pk_bf16_f32 v67, v38, v39
    v_cvt_pk_bf16_f32 v68, v40, v41
    v_cvt_pk_bf16_f32 v69, v42, v43
    v_cvt_pk_bf16_f32 v70, v44, v45
    v_cvt_pk_bf16_f32 v71, v46, v47
    s_or_b64 vcc, vcc, s[48:49]
    s_cbranch_vccz Lonorm
    s_cmp_eq_u32 s53, 0
    s_cbranch_scc1 Lfallback
Lonorm:
    v_cndmask_b32 v70, v70, 0, s[42:43]
    v_cndmask_b32 v71, v71, 0, s[42:43]
    v_min_u32 v64, -2, v64
    v_min_u32 v68, -2, v68
    buffer_store_dwordx4 v[64:67], v1, s[28:31], s54 offen sc1
    buffer_store_dwordx4 v[68:71], v1, s[28:31], s54 offen offset:1024 sc1
    s_setprio 0
    s_barrier
    s_lshl_b32 s50, s36, 2
    s_lshr_b32 s51, s37, 2
    s_add_u32 s59, s50, s51
    s_and_b32 s47, s37, 7
    s_mul_i32 s93, s47, 0
    s_add_u32 s93, s93, s38
    s_and_b32 s93, s93, 7
    s_mov_b32 s86, 0
    s_add_u32 s87, s86, 1
    s_cmp_eq_u32 s87, 7
    s_cselect_b32 s87, 0, s87
    s_add_u32 s88, s87, 1
    s_cmp_eq_u32 s88, 7
    s_cselect_b32 s88, 0, s88
    s_add_u32 s89, s88, 1
    s_cmp_eq_u32 s89, 7
    s_cselect_b32 s89, 0, s89
    s_add_u32 s90, s89, 1
    s_cmp_eq_u32 s90, 7
    s_cselect_b32 s90, 0, s90
    s_add_u32 s91, s90, 1
    s_cmp_eq_u32 s91, 7
    s_cselect_b32 s91, 0, s91
    s_add_u32 s92, s91, 1
    s_cmp_eq_u32 s92, 7
    s_cselect_b32 s92, 0, s92
    v_mov_b32 v5, 162176
    ds_read_b32 v4, v5
    s_waitcnt lgkmcnt(0)
    v_readfirstlane_b32 s3, v4
    s_and_b32 s50, s37, 7
    s_mul_i32 s50, s50, 112
    s_mul_i32 s52, s93, 14
    s_add_u32 s52, s50, s52
    s_mul_i32 s52, s52, 1792
    s_add_u32 s52, s52, 19922944
    v_mul_u32_u24 v21, 24, v3
    v_min_u32 v20, 23, v2
    v_add_lshl_u32 v21, v21, v20, 4
    s_mul_i32 s50, s90, 3584
    s_add_u32 s50, s50, s52
    buffer_load_dwordx4 v[72:75], v1, s[28:31], s50 offen offset:1792
    buffer_load_dwordx4 v[76:79], v21, s[28:31], s50 offen offset:2816
    s_mul_i32 s50, s91, 3584
    s_add_u32 s50, s50, s52
    buffer_load_dwordx4 v[80:83], v1, s[28:31], s50 offen offset:0
    buffer_load_dwordx4 v[84:87], v21, s[28:31], s50 offen offset:1024
    buffer_load_dwordx4 v[88:91], v1, s[28:31], s50 offen offset:1792
    buffer_load_dwordx4 v[92:95], v21, s[28:31], s50 offen offset:2816
    s_mul_i32 s50, s92, 3584
    s_add_u32 s50, s50, s52
    buffer_load_dwordx4 v[96:99], v1, s[28:31], s50 offen offset:0
    buffer_load_dwordx4 v[100:103], v21, s[28:31], s50 offen offset:1024
    buffer_load_dwordx4 v[104:107], v1, s[28:31], s50 offen offset:1792
    buffer_load_dwordx4 v[108:111], v21, s[28:31], s50 offen offset:2816
    s_cmp_eq_u32 s38, 3
    s_cbranch_scc1 Lp3a_123
    s_mov_b32 s48, 0x00020001
    s_mov_b32 s49, 0x00020001
    v_mov_b32 v4, 0x3f803f80
    v_cndmask_b32 v8, 0, v4, s[48:49]
    v_mov_b32 v9, v8
    v_mov_b32 v10, v8
    v_mov_b32 v11, v8
    s_mul_i32 s47, s39, 28672
    s_add_u32 s47, s47, 69632
    v_add_u32 v7, s47, v1
    ds_read_b128 v[112:115], v7 offset:0
    ds_read_b128 v[116:119], v7 offset:1024
    ds_read_b128 v[120:123], v7 offset:2048
    ds_read_b128 v[124:127], v7 offset:3072
    ds_read_b128 v[128:131], v7 offset:4096
    ds_read_b128 v[132:135], v7 offset:5120
    ds_read_b128 v[136:139], v7 offset:6144
    ds_read_b128 v[140:143], v7 offset:7168
    s_waitcnt lgkmcnt(4)
    v_mfma_f32_16x16x32_bf16 v[12:15], v[8:11], v[112:115], 0
    v_mfma_f32_16x16x32_bf16 v[12:15], v[8:11], v[116:119], v[12:15]
    v_mfma_f32_16x16x32_bf16 v[12:15], v[8:11], v[120:123], v[12:15]
    v_mfma_f32_16x16x32_bf16 v[12:15], v[8:11], v[124:127], v[12:15]
    ds_read_b128 v[112:115], v7 offset:8192
    ds_read_b128 v[116:119], v7 offset:9216
    ds_read_b128 v[120:123], v7 offset:10240
    ds_read_b128 v[124:127], v7 offset:11264
    s_waitcnt lgkmcnt(4)
    v_mfma_f32_16x16x32_bf16 v[12:15], v[8:11], v[128:131], v[12:15]
    v_mfma_f32_16x16x32_bf16 v[12:15], v[8:11], v[132:135], v[12:15]
    v_mfma_f32_16x16x32_bf16 v[12:15], v[8:11], v[136:139], v[12:15]
    v_mfma_f32_16x16x32_bf16 v[12:15], v[8:11], v[140:143], v[12:15]
    ds_read_b128 v[128:131], v7 offset:12288
    ds_read_b128 v[132:135], v7 offset:13312
    ds_read_b128 v[136:139], v7 offset:14336
    ds_read_b128 v[140:143], v7 offset:15360
    s_waitcnt lgkmcnt(4)
    v_mfma_f32_16x16x32_bf16 v[12:15], v[8:11], v[112:115], v[12:15]
    v_mfma_f32_16x16x32_bf16 v[12:15], v[8:11], v[116:119], v[12:15]
    v_mfma_f32_16x16x32_bf16 v[12:15], v[8:11], v[120:123], v[12:15]
    v_mfma_f32_16x16x32_bf16 v[12:15], v[8:11], v[124:127], v[12:15]
    ds_read_b128 v[112:115], v7 offset:16384
    ds_read_b128 v[116:119], v7 offset:17408
    ds_read_b128 v[120:123], v7 offset:18432
    ds_read_b128 v[124:127], v7 offset:19456
    s_waitcnt lgkmcnt(4)
    v_mfma_f32_16x16x32_bf16 v[12:15], v[8:11], v[128:131], v[12:15]
    v_mfma_f32_16x16x32_bf16 v[12:15], v[8:11], v[132:135], v[12:15]
    v_mfma_f32_16x16x32_bf16 v[12:15], v[8:11], v[136:139], v[12:15]
    v_mfma_f32_16x16x32_bf16 v[12:15], v[8:11], v[140:143], v[12:15]
    ds_read_b128 v[128:131], v7 offset:20480
    ds_read_b128 v[132:135], v7 offset:21504
    ds_read_b128 v[136:139], v7 offset:22528
    ds_read_b128 v[140:143], v7 offset:23552
    s_waitcnt lgkmcnt(4)
    v_mfma_f32_16x16x32_bf16 v[12:15], v[8:11], v[112:115], v[12:15]
    v_mfma_f32_16x16x32_bf16 v[12:15], v[8:11], v[116:119], v[12:15]
    v_mfma_f32_16x16x32_bf16 v[12:15], v[8:11], v[120:123], v[12:15]
    v_mfma_f32_16x16x32_bf16 v[12:15], v[8:11], v[124:127], v[12:15]
    ds_read_b128 v[112:115], v7 offset:24576
    ds_read_b128 v[116:119], v7 offset:25600
    ds_read_b128 v[120:123], v7 offset:26624
    ds_read_b128 v[124:127], v7 offset:27648
    s_waitcnt lgkmcnt(4)
    v_mfma_f32_16x16x32_bf16 v[12:15], v[8:11], v[128:131], v[12:15]
    v_mfma_f32_16x16x32_bf16 v[12:15], v[8:11], v[132:135], v[12:15]
    v_mfma_f32_16x16x32_bf16 v[12:15], v[8:11], v[136:139], v[12:15]
    v_mfma_f32_16x16x32_bf16 v[12:15], v[8:11], v[140:143], v[12:15]
    s_waitcnt lgkmcnt(0)
    v_mfma_f32_16x16x32_bf16 v[12:15], v[8:11], v[112:115], v[12:15]
    v_mfma_f32_16x16x32_bf16 v[12:15], v[8:11], v[116:119], v[12:15]
    v_mfma_f32_16x16x32_bf16 v[12:15], v[8:11], v[120:123], v[12:15]
    v_mfma_f32_16x16x32_bf16 v[12:15], v[8:11], v[124:127], v[12:15]
    s_lshl_b32 s47, s38, 7
    s_add_u32 s47, s47, 162816
    v_lshl_add_u32 v4, v0, 2, s47
    v_lshl_add_u32 v5, v3, 4, s47
    s_mov_b64 exec, 0xffff
    s_nop 2
    ds_write_b32 v4, v12
    ds_write_b32 v4, v13 offset:64
    s_mov_b64 exec, -1
    ds_read_b128 v[56:59], v5 offset:0
    ds_read_b128 v[60:63], v5 offset:32
    ds_read_b128 v[64:67], v5 offset:64
    ds_read_b128 v[68:71], v5 offset:96
    s_waitcnt lgkmcnt(0)
Lp3a_123:
    s_barrier
    s_barrier
    s_lshl_b32 s50, s36, 2
    s_lshr_b32 s51, s37, 3
    s_lshl_b32 s51, s51, 1
    s_add_u32 s59, s50, s51
    s_mul_i32 s50, s59, 28672
    s_mul_i32 s51, s38, 7168
    s_add_u32 s50, s50, s51
    s_add_u32 s50, s50, 6291456
    s_add_u32 s52, s50, 4096
    v_add_u32 v6, s51, v1
    s_add_u32 m0, s51, 0
    s_nop 0
    buffer_load_dwordx4 v1, s[28:31], s50 offen offset:0 sc1 lds
    buffer_load_dwordx4 v1, s[28:31], s50 offen offset:1024 sc1 lds
    buffer_load_dwordx4 v1, s[28:31], s50 offen offset:2048 sc1 lds
    buffer_load_dwordx4 v1, s[28:31], s50 offen offset:3072 sc1 lds
    s_add_u32 m0, s51, 4096
    s_nop 0
    buffer_load_dwordx4 v1, s[28:31], s52 offen offset:0 sc1 lds
    buffer_load_dwordx4 v1, s[28:31], s52 offen offset:1024 sc1 lds
    buffer_load_dwordx4 v1, s[28:31], s52 offen offset:2048 sc1 lds
    s_waitcnt vmcnt(0)
    s_mov_b32 s48, 0
Lvr_124:
    ds_read_b64 v[24:25], v6 offset:0
    ds_read_b64 v[26:27], v6 offset:1024
    ds_read_b64 v[28:29], v6 offset:2048
    ds_read_b64 v[30:31], v6 offset:3072
    ds_read_b64 v[32:33], v6 offset:4096
    ds_read_b64 v[34:35], v6 offset:5120
    ds_read_b64 v[36:37], v6 offset:6144
    s_waitcnt lgkmcnt(0)
    v_max3_u32 v24, v24, v26, v28
    v_max3_u32 v24, v24, v30, v32
    v_max3_u32 v24, v24, v34, v36
    v_cmp_eq_u32 vcc, -1, v24
    s_nop 4
    s_cbranch_vccz Lvk_125
    s_add_u32 m0, s51, 0
    s_nop 0
    buffer_load_dwordx4 v1, s[28:31], s50 offen offset:0 sc1 lds
    buffer_load_dwordx4 v1, s[28:31], s50 offen offset:1024 sc1 lds
    buffer_load_dwordx4 v1, s[28:31], s50 offen offset:2048 sc1 lds
    buffer_load_dwordx4 v1, s[28:31], s50 offen offset:3072 sc1 lds
    s_add_u32 m0, s51, 4096
    s_nop 0
    buffer_load_dwordx4 v1, s[28:31], s52 offen offset:0 sc1 lds
    buffer_load_dwordx4 v1, s[28:31], s52 offen offset:1024 sc1 lds
    buffer_load_dwordx4 v1, s[28:31], s52 offen offset:2048 sc1 lds
    s_waitcnt vmcnt(0)
    s_add_u32 s48, s48, 1
    s_cmp_lt_u32 s48, 262144
    s_cbranch_scc1 Lvr_124
Lvk_125:
    s_cmp_eq_u32 s38, 3
    s_cbranch_scc1 Lp4s_126
    s_mul_i32 s47, s39, 28672
    s_add_u32 s47, s47, 69632
    v_add_u32 v7, s47, v1
    s_barrier
    s_and_b32 s51, s37, 7
    s_mul_i32 s51, s51, 7
    s_add_u32 s51, s51, s39
    s_add_u32 s51, s51, 4
    s_lshl_b32 s51, s51, 1
    s_mul_i32 s54, s59, 112
    s_add_u32 s54, s54, s51
    s_lshl_b32 s54, s54, 10
    s_add_u32 s54, s54, 8388608
    s_add_u32 s55, s54, 114688
    ds_read_b128 v[8:11], v1 offset:0
    ds_read_b128 v[16:19], v7 offset:0
    ds_read_b128 v[12:15], v1 offset:1024
    ds_read_b128 v[20:23], v7 offset:1024
    s_waitcnt lgkmcnt(2)
    v_mfma_f32_32x32x16_bf16 v[24:39], v[16:19], v[8:11], 0
    ds_read_b128 v[8:11], v1 offset:2048
    ds_read_b128 v[16:19], v7 offset:2048
    s_waitcnt lgkmcnt(2)
    v_mfma_f32_32x32x16_bf16 v[24:39], v[20:23], v[12:15], v[24:39]
    ds_read_b128 v[12:15], v1 offset:3072
    ds_read_b128 v[20:23], v7 offset:3072
    s_waitcnt lgkmcnt(2)
    v_mfma_f32_32x32x16_bf16 v[24:39], v[16:19], v[8:11], v[24:39]
    ds_read_b128 v[8:11], v1 offset:4096
    ds_read_b128 v[16:19], v7 offset:4096
    s_waitcnt lgkmcnt(2)
    v_mfma_f32_32x32x16_bf16 v[24:39], v[20:23], v[12:15], v[24:39]
    ds_read_b128 v[12:15], v1 offset:5120
    ds_read_b128 v[20:23], v7 offset:5120
    s_waitcnt lgkmcnt(2)
    v_mfma_f32_32x32x16_bf16 v[24:39], v[16:19], v[8:11], v[24:39]
    ds_read_b128 v[8:11], v1 offset:6144
    ds_read_b128 v[16:19], v7 offset:6144
    s_waitcnt lgkmcnt(2)
    v_mfma_f32_32x32x16_bf16 v[24:39], v[20:23], v[12:15], v[24:39]
    ds_read_b128 v[12:15], v1 offset:7168
    ds_read_b128 v[20:23], v7 offset:7168
    s_waitcnt lgkmcnt(2)
    v_mfma_f32_32x32x16_bf16 v[24:39], v[16:19], v[8:11], v[24:39]
    ds_read_b128 v[8:11], v1 offset:8192
    ds_read_b128 v[16:19], v7 offset:8192
    s_waitcnt lgkmcnt(2)
    v_mfma_f32_32x32x16_bf16 v[24:39], v[20:23], v[12:15], v[24:39]
    ds_read_b128 v[12:15], v1 offset:9216
    ds_read_b128 v[20:23], v7 offset:9216
    s_waitcnt lgkmcnt(2)
    v_mfma_f32_32x32x16_bf16 v[24:39], v[16:19], v[8:11], v[24:39]
    ds_read_b128 v[8:11], v1 offset:10240
    ds_read_b128 v[16:19], v7 offset:10240
    s_waitcnt lgkmcnt(2)
    v_mfma_f32_32x32x16_bf16 v[24:39], v[20:23], v[12:15], v[24:39]
    ds_read_b128 v[12:15], v1 offset:11264
    ds_read_b128 v[20:23], v7 offset:11264
    s_waitcnt lgkmcnt(2)
    v_mfma_f32_32x32x16_bf16 v[24:39], v[16:19], v[8:11], v[24:39]
    ds_read_b128 v[8:11], v1 offset:12288
    ds_read_b128 v[16:19], v7 offset:12288
    s_waitcnt lgkmcnt(2)
    v_mfma_f32_32x32x16_bf16 v[24:39], v[20:23], v[12:15], v[24:39]
    ds_read_b128 v[12:15], v1 offset:13312
    ds_read_b128 v[20:23], v7 offset:13312
    s_waitcnt lgkmcnt(2)
    v_mfma_f32_32x32x16_bf16 v[24:39], v[16:19], v[8:11], v[24:39]
    ds_read_b128 v[8:11], v1 offset:14336
    ds_read_b128 v[16:19], v7 offset:14336
    s_waitcnt lgkmcnt(2)
    v_mfma_f32_32x32x16_bf16 v[24:39], v[20:23], v[12:15], v[24:39]
    ds_read_b128 v[12:15], v1 offset:15360
    ds_read_b128 v[20:23], v7 offset:15360
    s_waitcnt lgkmcnt(2)
    v_mfma_f32_32x32x16_bf16 v[24:39], v[16:19], v[8:11], v[24:39]
    ds_read_b128 v[8:11], v1 offset:16384
    ds_read_b128 v[16:19], v7 offset:16384
    s_waitcnt lgkmcnt(2)
    v_mfma_f32_32x32x16_bf16 v[24:39], v[20:23], v[12:15], v[24:39]
    ds_read_b128 v[12:15], v1 offset:17408
    ds_read_b128 v[20:23], v7 offset:17408
    s_waitcnt lgkmcnt(2)
    v_mfma_f32_32x32x16_bf16 v[24:39], v[16:19], v[8:11], v[24:39]
    ds_read_b128 v[8:11], v1 offset:18432
    ds_read_b128 v[16:19], v7 offset:18432
    s_waitcnt lgkmcnt(2)
    v_mfma_f32_32x32x16_bf16 v[24:39], v[20:23], v[12:15], v[24:39]
    ds_read_b128 v[12:15], v1 offset:19456
    ds_read_b128 v[20:23], v7 offset:19456
    s_waitcnt lgkmcnt(2)
    v_mfma_f32_32x32x16_bf16 v[24:39], v[16:19], v[8:11], v[24:39]
    ds_read_b128 v[8:11], v1 offset:20480
    ds_read_b128 v[16:19], v7 offset:20480
    s_waitcnt lgkmcnt(2)
    v_mfma_f32_32x32x16_bf16 v[24:39], v[20:23], v[12:15], v[24:39]
    ds_read_b128 v[12:15], v1 offset:21504
    ds_read_b128 v[20:23], v7 offset:21504
    s_waitcnt lgkmcnt(2)
    v_mfma_f32_32x32x16_bf16 v[24:39], v[16:19], v[8:11], v[24:39]
    ds_read_b128 v[8:11], v1 offset:22528
    ds_read_b128 v[16:19], v7 offset:22528
    s_waitcnt lgkmcnt(2)
    v_mfma_f32_32x32x16_bf16 v[24:39], v[20:23], v[12:15], v[24:39]
    ds_read_b128 v[12:15], v1 offset:23552
    ds_read_b128 v[20:23], v7 offset:23552
    s_waitcnt lgkmcnt(2)
    v_mfma_f32_32x32x16_bf16 v[24:39], v[16:19], v[8:11], v[24:39]
    ds_read_b128 v[8:11], v1 offset:24576
    ds_read_b128 v[16:19], v7 offset:24576
    s_waitcnt lgkmcnt(2)
    v_mfma_f32_32x32x16_bf16 v[24:39], v[20:23], v[12:15], v[24:39]
    ds_read_b128 v[12:15], v1 offset:25600
    ds_read_b128 v[20:23], v7 offset:25600
    s_waitcnt lgkmcnt(2)
    v_mfma_f32_32x32x16_bf16 v[24:39], v[16:19], v[8:11], v[24:39]
    ds_read_b128 v[8:11], v1 offset:26624
    ds_read_b128 v[16:19], v7 offset:26624
    s_waitcnt lgkmcnt(2)
    v_mfma_f32_32x32x16_bf16 v[24:39], v[20:23], v[12:15], v[24:39]
    s_barrier
    v_lshlrev_b32 v180, 3, v2
    v_add_u32 v180, 162304, v180
    ds_read_b64 v[182:183], v180 offset:256
    ds_read_b64 v[180:181], v180
    ds_read_b128 v[12:15], v1 offset:27648
    ds_read_b128 v[20:23], v7 offset:27648
    s_waitcnt lgkmcnt(2)
    v_mfma_f32_32x32x16_bf16 v[24:39], v[16:19], v[8:11], v[24:39]
    ds_read_b128 v[8:11], v1 offset:28672
    ds_read_b128 v[16:19], v7 offset:0
    s_waitcnt lgkmcnt(2)
    v_mfma_f32_32x32x16_bf16 v[24:39], v[20:23], v[12:15], v[24:39]
    ds_read_b128 v[12:15], v1 offset:29696
    ds_read_b128 v[20:23], v7 offset:1024
    s_waitcnt lgkmcnt(2)
    v_mfma_f32_32x32x16_bf16 v[40:55], v[16:19], v[8:11], 0
    ds_read_b128 v[8:11], v1 offset:30720
    ds_read_b128 v[16:19], v7 offset:2048
    s_waitcnt lgkmcnt(2)
    v_mfma_f32_32x32x16_bf16 v[40:55], v[20:23], v[12:15], v[40:55]
    s_nop 3
    v_mul_f32 v24, v24, v180
    v_fmac_f32 v24, v181, v56
    v_mul_f32 v25, v25, v180
    v_fmac_f32 v25, v181, v57
    v_mul_f32 v26, v26, v180
    v_fmac_f32 v26, v181, v58
    v_mul_f32 v27, v27, v180
    v_fmac_f32 v27, v181, v59
    v_mul_f32 v28, v28, v180
    v_fmac_f32 v28, v181, v60
    v_mul_f32 v29, v29, v180
    v_fmac_f32 v29, v181, v61
    v_mul_f32 v30, v30, v180
    v_fmac_f32 v30, v181, v62
    v_mul_f32 v31, v31, v180
    v_fmac_f32 v31, v181, v63
    ds_read_b128 v[12:15], v1 offset:31744
    ds_read_b128 v[20:23], v7 offset:3072
    s_waitcnt lgkmcnt(2)
    v_mfma_f32_32x32x16_bf16 v[40:55], v[16:19], v[8:11], v[40:55]
    v_mul_f32 v32, v32, v180
    v_fmac_f32 v32, v181, v64
    v_mul_f32 v33, v33, v180
    v_fmac_f32 v33, v181, v65
    v_mul_f32 v34, v34, v180
    v_fmac_f32 v34, v181, v66
    v_mul_f32 v35, v35, v180
    v_fmac_f32 v35, v181, v67
    v_mul_f32 v36, v36, v180
    v_fmac_f32 v36, v181, v68
    v_mul_f32 v37, v37, v180
    v_fmac_f32 v37, v181, v69
    v_mul_f32 v38, v38, v180
    v_fmac_f32 v38, v181, v70
    v_mul_f32 v39, v39, v180
    v_fmac_f32 v39, v181, v71
    ds_read_b128 v[8:11], v1 offset:32768
    ds_read_b128 v[16:19], v7 offset:4096
    s_waitcnt lgkmcnt(2)
    v_mfma_f32_32x32x16_bf16 v[40:55], v[20:23], v[12:15], v[40:55]
    v_cvt_pk_bf16_f32 v24, v24, v25
    v_pk_max_i16 v24, v24, 0
    v_cvt_pk_bf16_f32 v25, v26, v27
    v_pk_max_i16 v25, v25, 0
    v_cvt_pk_bf16_f32 v26, v28, v29
    v_pk_max_i16 v26, v26, 0
    v_cvt_pk_bf16_f32 v27, v30, v31
    v_pk_max_i16 v27, v27, 0
    v_cvt_pk_bf16_f32 v28, v32, v33
    v_pk_max_i16 v28, v28, 0
    v_cvt_pk_bf16_f32 v29, v34, v35
    v_pk_max_i16 v29, v29, 0
    v_cvt_pk_bf16_f32 v30, v36, v37
    v_pk_max_i16 v30, v30, 0
    v_cvt_pk_bf16_f32 v31, v38, v39
    v_pk_max_i16 v31, v31, 0
    buffer_store_dwordx4 v[24:27], v1, s[28:31], s54 offen sc1
    buffer_store_dwordx4 v[28:31], v1, s[28:31], s54 offen offset:1024 sc1
    ds_read_b128 v[12:15], v1 offset:33792
    ds_read_b128 v[20:23], v7 offset:5120
    s_waitcnt lgkmcnt(2)
    v_mfma_f32_32x32x16_bf16 v[40:55], v[16:19], v[8:11], v[40:55]
    ds_read_b128 v[8:11], v1 offset:34816
    ds_read_b128 v[16:19], v7 offset:6144
    s_waitcnt lgkmcnt(2)
    v_mfma_f32_32x32x16_bf16 v[40:55], v[20:23], v[12:15], v[40:55]
    ds_read_b128 v[12:15], v1 offset:35840
    ds_read_b128 v[20:23], v7 offset:7168
    s_waitcnt lgkmcnt(2)
    v_mfma_f32_32x32x16_bf16 v[40:55], v[16:19], v[8:11], v[40:55]
    ds_read_b128 v[8:11], v1 offset:36864
    ds_read_b128 v[16:19], v7 offset:8192
    s_waitcnt lgkmcnt(2)
    v_mfma_f32_32x32x16_bf16 v[40:55], v[20:23], v[12:15], v[40:55]
    ds_read_b128 v[12:15], v1 offset:37888
    ds_read_b128 v[20:23], v7 offset:9216
    s_waitcnt lgkmcnt(2)
    v_mfma_f32_32x32x16_bf16 v[40:55], v[16:19], v[8:11], v[40:55]
    ds_read_b128 v[8:11], v1 offset:38912
    ds_read_b128 v[16:19], v7 offset:10240
    s_waitcnt lgkmcnt(2)
    v_mfma_f32_32x32x16_bf16 v[40:55], v[20:23], v[12:15], v[40:55]
    ds_read_b128 v[12:15], v1 offset:39936
    ds_read_b128 v[20:23], v7 offset:11264
    s_waitcnt lgkmcnt(2)
    v_mfma_f32_32x32x16_bf16 v[40:55], v[16:19], v[8:11], v[40:55]
    ds_read_b128 v[8:11], v1 offset:40960
    ds_read_b128 v[16:19], v7 offset:12288
    s_waitcnt lgkmcnt(2)
    v_mfma_f32_32x32x16_bf16 v[40:55], v[20:23], v[12:15], v[40:55]
    ds_read_b128 v[12:15], v1 offset:41984
    ds_read_b128 v[20:23], v7 offset:13312
    s_waitcnt lgkmcnt(2)
    v_mfma_f32_32x32x16_bf16 v[40:55], v[16:19], v[8:11], v[40:55]
    ds_read_b128 v[8:11], v1 offset:43008
    ds_read_b128 v[16:19], v7 offset:14336
    s_waitcnt lgkmcnt(2)
    v_mfma_f32_32x32x16_bf16 v[40:55], v[20:23], v[12:15], v[40:55]
    ds_read_b128 v[12:15], v1 offset:44032
    ds_read_b128 v[20:23], v7 offset:15360
    s_waitcnt lgkmcnt(2)
    v_mfma_f32_32x32x16_bf16 v[40:55], v[16:19], v[8:11], v[40:55]
    ds_read_b128 v[8:11], v1 offset:45056
    ds_read_b128 v[16:19], v7 offset:16384
    s_waitcnt lgkmcnt(2)
    v_mfma_f32_32x32x16_bf16 v[40:55], v[20:23], v[12:15], v[40:55]
    ds_read_b128 v[12:15], v1 offset:46080
    ds_read_b128 v[20:23], v7 offset:17408
    s_waitcnt lgkmcnt(2)
    v_mfma_f32_32x32x16_bf16 v[40:55], v[16:19], v[8:11], v[40:55]
    ds_read_b128 v[8:11], v1 offset:47104
    ds_read_b128 v[16:19], v7 offset:18432
    s_waitcnt lgkmcnt(2)
    v_mfma_f32_32x32x16_bf16 v[40:55], v[20:23], v[12:15], v[40:55]
    ds_read_b128 v[12:15], v1 offset:48128
    ds_read_b128 v[20:23], v7 offset:19456
    s_waitcnt lgkmcnt(2)
    v_mfma_f32_32x32x16_bf16 v[40:55], v[16:19], v[8:11], v[40:55]
    ds_read_b128 v[8:11], v1 offset:49152
    ds_read_b128 v[16:19], v7 offset:20480
    s_waitcnt lgkmcnt(2)
    v_mfma_f32_32x32x16_bf16 v[40:55], v[20:23], v[12:15], v[40:55]
    ds_read_b128 v[12:15], v1 offset:50176
    ds_read_b128 v[20:23], v7 offset:21504
    s_waitcnt lgkmcnt(2)
    v_mfma_f32_32x32x16_bf16 v[40:55], v[16:19], v[8:11], v[40:55]
    ds_read_b128 v[8:11], v1 offset:51200
    ds_read_b128 v[16:19], v7 offset:22528
    s_waitcnt lgkmcnt(2)
    v_mfma_f32_32x32x16_bf16 v[40:55], v[20:23], v[12:15], v[40:55]
    ds_read_b128 v[12:15], v1 offset:52224
    ds_read_b128 v[20:23], v7 offset:23552
    s_waitcnt lgkmcnt(2)
    v_mfma_f32_32x32x16_bf16 v[40:55], v[16:19], v[8:11], v[40:55]
    ds_read_b128 v[8:11], v1 offset:53248
    ds_read_b128 v[16:19], v7 offset:24576
    s_waitcnt lgkmcnt(2)
    v_mfma_f32_32x32x16_bf16 v[40:55], v[20:23], v[12:15], v[40:55]
    ds_read_b128 v[12:15], v1 offset:54272
    ds_read_b128 v[20:23], v7 offset:25600
    s_waitcnt lgkmcnt(2)
    v_mfma_f32_32x32x16_bf16 v[40:55], v[16:19], v[8:11], v[40:55]
    ds_read_b128 v[8:11], v1 offset:55296
    ds_read_b128 v[16:19], v7 offset:26624
    s_waitcnt lgkmcnt(2)
    v_mfma_f32_32x32x16_bf16 v[40:55], v[20:23], v[12:15], v[40:55]
    ds_read_b128 v[12:15], v1 offset:56320
    ds_read_b128 v[20:23], v7 offset:27648
    s_waitcnt lgkmcnt(2)
    v_mfma_f32_32x32x16_bf16 v[40:55], v[16:19], v[8:11], v[40:55]
    s_waitcnt lgkmcnt(0)
    v_mfma_f32_32x32x16_bf16 v[40:55], v[20:23], v[12:15], v[40:55]
    s_and_b32 s51, s37, 7
    s_mul_i32 s51, s51, 7
    s_cmp_gt_u32 s38, 3
    s_subb_u32 s52, s38, 0
    s_add_u32 s52, s51, s52
    s_lshr_b32 s53, s52, 1
    s_lshl_b32 s53, s53, 10
    s_and_b32 s52, s52, 1
    s_lshl_b32 s52, s52, 3
    s_add_u32 s53, s53, s52
    v_add_u32 v20, s53, v1
    ds_read_b64 v[176:177], v20 offset:0
    ds_read_b64 v[178:179], v20 offset:28672
    s_mul_i32 s94, s59, 112
    s_mul_i32 s51, s93, 14
    s_add_u32 s94, s94, s51
    s_lshl_b32 s94, s94, 10
    s_add_u32 s94, s94, 8388608
    s_add_u32 s95, s94, 114688
    v_mul_f32 v40, v40, v182
    v_fmac_f32 v40, v183, v56
    v_mul_f32 v41, v41, v182
    v_fmac_f32 v41, v183, v57
    v_mul_f32 v42, v42, v182
    v_fmac_f32 v42, v183, v58
    v_mul_f32 v43, v43, v182
    v_fmac_f32 v43, v183, v59
    v_mul_f32 v44, v44, v182
    v_fmac_f32 v44, v183, v60
    v_mul_f32 v45, v45, v182
    v_fmac_f32 v45, v183, v61
    v_mul_f32 v46, v46, v182
    v_fmac_f32 v46, v183, v62
    v_mul_f32 v47, v47, v182
    v_fmac_f32 v47, v183, v63
    v_mul_f32 v48, v48, v182
    v_fmac_f32 v48, v183, v64
    v_mul_f32 v49, v49, v182
    v_fmac_f32 v49, v183, v65
    v_mul_f32 v50, v50, v182
    v_fmac_f32 v50, v183, v66
    v_mul_f32 v51, v51, v182
    v_fmac_f32 v51, v183, v67
    v_mul_f32 v52, v52, v182
    v_fmac_f32 v52, v183, v68
    v_mul_f32 v53, v53, v182
    v_fmac_f32 v53, v183, v69
    v_mul_f32 v54, v54, v182
    v_fmac_f32 v54, v183, v70
    v_mul_f32 v55, v55, v182
    v_fmac_f32 v55, v183, v71
    v_cvt_pk_bf16_f32 v40, v40, v41
    v_pk_max_i16 v40, v40, 0
    v_cvt_pk_bf16_f32 v41, v42, v43
    v_pk_max_i16 v41, v41, 0
    v_cvt_pk_bf16_f32 v42, v44, v45
    v_pk_max_i16 v42, v42, 0
    v_cvt_pk_bf16_f32 v43, v46, v47
    v_pk_max_i16 v43, v43, 0
    v_cvt_pk_bf16_f32 v44, v48, v49
    v_pk_max_i16 v44, v44, 0
    v_cvt_pk_bf16_f32 v45, v50, v51
    v_pk_max_i16 v45, v45, 0
    v_cvt_pk_bf16_f32 v46, v52, v53
    v_pk_max_i16 v46, v46, 0
    v_cvt_pk_bf16_f32 v47, v54, v55
    v_pk_max_i16 v47, v47, 0
    buffer_store_dwordx4 v[40:43], v1, s[28:31], s55 offen sc1
    buffer_store_dwordx4 v[44:47], v1, s[28:31], s55 offen offset:1024 sc1
    s_lshl_b32 s47, s86, 11
    s_add_u32 s47, s47, s94
    buffer_load_dwordx4 v[112:115], v1, s[28:31], s47 offen offset:0
    buffer_load_dwordx4 v[116:119], v1, s[28:31], s47 offen offset:1024
    s_lshl_b32 s47, s87, 11
    s_add_u32 s47, s47, s94
    buffer_load_dwordx4 v[120:123], v1, s[28:31], s47 offen offset:0
    buffer_load_dwordx4 v[124:127], v1, s[28:31], s47 offen offset:1024
    s_lshl_b32 s47, s88, 11
    s_add_u32 s47, s47, s94
    buffer_load_dwordx4 v[128:131], v1, s[28:31], s47 offen offset:0
    buffer_load_dwordx4 v[132:135], v1, s[28:31], s47 offen offset:1024
    s_branch Lp4r_127
Lp4s_126:
    s_lshl_b32 s50, s59, 12
    s_add_u32 s50, s50, 22020096
    v_lshlrev_b32 v4, 3, v2
    v_lshl_add_u32 v4, v3, 12, v4
    s_barrier
    s_mov_b32 s48, 0
Lsp_128:
    buffer_load_dwordx2 v[112:113], v4, s[28:31], s50 offen offset:0 sc1
    buffer_load_dwordx2 v[114:115], v4, s[28:31], s50 offen offset:256 sc1
    buffer_load_dwordx2 v[116:117], v4, s[28:31], s50 offen offset:512 sc1
    buffer_load_dwordx2 v[118:119], v4, s[28:31], s50 offen offset:768 sc1
    buffer_load_dwordx2 v[120:121], v4, s[28:31], s50 offen offset:1024 sc1
    buffer_load_dwordx2 v[122:123], v4, s[28:31], s50 offen offset:1280 sc1
    buffer_load_dwordx2 v[124:125], v4, s[28:31], s50 offen offset:1536 sc1
    buffer_load_dwordx2 v[126:127], v4, s[28:31], s50 offen offset:1792 sc1
    buffer_load_dwordx2 v[128:129], v4, s[28:31], s50 offen offset:2048 sc1
    buffer_load_dwordx2 v[130:131], v4, s[28:31], s50 offen offset:2304 sc1
    buffer_load_dwordx2 v[132:133], v4, s[28:31], s50 offen offset:2560 sc1
    buffer_load_dwordx2 v[134:135], v4, s[28:31], s50 offen offset:2816 sc1
    buffer_load_dwordx2 v[136:137], v4, s[28:31], s50 offen offset:3072 sc1
    buffer_load_dwordx2 v[138:139], v4, s[28:31], s50 offen offset:3328 sc1
    buffer_load_dwordx2 v[140:141], v4, s[28:31], s50 offen offset:3584 sc1
    buffer_load_dwordx2 v[142:143], v4, s[28:31], s50 offen offset:3840 sc1
    s_waitcnt vmcnt(0)
    v_max3_u32 v5, v112, v114, v116
    v_max3_u32 v5, v5, v118, v120
    v_max3_u32 v5, v5, v122, v124
    v_max3_u32 v5, v5, v126, v128
    v_max3_u32 v5, v5, v130, v132
    v_max3_u32 v5, v5, v134, v136
    v_max3_u32 v5, v5, v138, v140
    v_max_u32 v5, v5, v142
    v_cmp_eq_u32 vcc, -1, v5
    s_nop 4
    s_cbranch_vccz Lsk_129
    s_add_u32 s48, s48, 1
    s_cmp_lt_u32 s48, 262144
    s_cbranch_scc1 Lsp_128
Lsk_129:
    v_add_f32 v112, v112, v128
    v_add_f32 v113, v113, v129
    v_add_f32 v114, v114, v130
    v_add_f32 v115, v115, v131
    v_add_f32 v116, v116, v132
    v_add_f32 v117, v117, v133
    v_add_f32 v118, v118, v134
    v_add_f32 v119, v119, v135
    v_add_f32 v120, v120, v136
    v_add_f32 v121, v121, v137
    v_add_f32 v122, v122, v138
    v_add_f32 v123, v123, v139
    v_add_f32 v124, v124, v140
    v_add_f32 v125, v125, v141
    v_add_f32 v126, v126, v142
    v_add_f32 v127, v127, v143
    v_add_f32 v112, v112, v120
    v_add_f32 v113, v113, v121
    v_add_f32 v114, v114, v122
    v_add_f32 v115, v115, v123
    v_add_f32 v116, v116, v124
    v_add_f32 v117, v117, v125
    v_add_f32 v118, v118, v126
    v_add_f32 v119, v119, v127
    v_add_f32 v112, v112, v116
    v_add_f32 v113, v113, v117
    v_add_f32 v114, v114, v118
    v_add_f32 v115, v115, v119
    v_add_f32 v112, v112, v114
    v_add_f32 v113, v113, v115
    v_mul_f32 v112, 0x3b124925, v112
    v_mul_f32 v113, 0x3b124925, v113
    v_fma_f32 v113, -v112, v112, v113
    v_max_f32 v113, 0, v113
    v_add_f32 v113, 0x3727c5ac, v113
    v_rsq_f32 v113, v113
    s_nop 0
    v_mul_f32 v112, v112, v113
    v_sub_f32 v112, 0, v112
    v_lshlrev_b32 v4, 3, v0
    v_add_u32 v4, 162304, v4
    ds_write2_b32 v4, v113, v112 offset0:0 offset1:1
    s_waitcnt lgkmcnt(0)
    s_barrier
    s_and_b32 s51, s37, 7
    s_mul_i32 s51, s51, 7
    s_cmp_gt_u32 s38, 3
    s_subb_u32 s52, s38, 0
    s_add_u32 s52, s51, s52
    s_lshr_b32 s53, s52, 1
    s_lshl_b32 s53, s53, 10
    s_and_b32 s52, s52, 1
    s_lshl_b32 s52, s52, 3
    s_add_u32 s53, s53, s52
    v_add_u32 v20, s53, v1
    ds_read_b64 v[176:177], v20 offset:0
    ds_read_b64 v[178:179], v20 offset:28672
    s_mul_i32 s94, s59, 112
    s_mul_i32 s51, s93, 14
    s_add_u32 s94, s94, s51
    s_lshl_b32 s94, s94, 10
    s_add_u32 s94, s94, 8388608
    s_add_u32 s95, s94, 114688
    v_lshlrev_b32 v20, 2, v0
    v_add_u32 v20, 155648, v20
Lpw_130:
    ds_read_b32 v4, v20 offset:2048
    s_waitcnt lgkmcnt(0)
    v_cmp_gt_u32 vcc, 120, v4
    s_sleep 2
    s_nop 3
    s_cbranch_vccnz Lpw_130
    s_lshl_b32 s47, s86, 11
    s_add_u32 s47, s47, s94
    buffer_load_dwordx4 v[112:115], v1, s[28:31], s47 offen offset:0
    buffer_load_dwordx4 v[116:119], v1, s[28:31], s47 offen offset:1024
    s_lshl_b32 s47, s87, 11
    s_add_u32 s47, s47, s94
    buffer_load_dwordx4 v[120:123], v1, s[28:31], s47 offen offset:0
    buffer_load_dwordx4 v[124:127], v1, s[28:31], s47 offen offset:1024
    s_lshl_b32 s47, s88, 11
    s_add_u32 s47, s47, s94
    buffer_load_dwordx4 v[128:131], v1, s[28:31], s47 offen offset:0
    buffer_load_dwordx4 v[132:135], v1, s[28:31], s47 offen offset:1024
Lp4r_127:
Ljoin:
    s_waitcnt vmcnt(4)
    v_max_u32 v4, v112, v116
    v_cmp_eq_u32 vcc, -1, v4
    s_nop 4
    s_cbranch_vccnz Lhr_131
Lhk_132:
    s_lshl_b32 s47, s89, 11
    s_add_u32 s47, s47, s94
    buffer_load_dwordx4 v[136:139], v1, s[28:31], s47 offen offset:0
    buffer_load_dwordx4 v[140:143], v1, s[28:31], s47 offen offset:1024
    v_mfma_f32_32x32x16_bf16 v[8:23], v[184:187], v[112:115], 0
    v_mfma_f32_32x32x16_bf16 v[24:39], v[188:191], v[112:115], 0
    v_mfma_f32_32x32x16_bf16 v[8:23], v[192:195], v[116:119], v[8:23]
    v_mfma_f32_32x32x16_bf16 v[24:39], v[196:199], v[116:119], v[24:39]
    s_waitcnt vmcnt(4)
    v_max_u32 v4, v120, v124
    v_cmp_eq_u32 vcc, -1, v4
    s_nop 4
    s_cbranch_vccnz Lhr_133
Lhk_134:
    s_lshl_b32 s47, s90, 11
    s_add_u32 s47, s47, s94
    buffer_load_dwordx4 v[144:147], v1, s[28:31], s47 offen offset:0
    buffer_load_dwordx4 v[148:151], v1, s[28:31], s47 offen offset:1024
    v_mfma_f32_32x32x16_bf16 v[8:23], v[200:203], v[120:123], v[8:23]
    v_mfma_f32_32x32x16_bf16 v[24:39], v[204:207], v[120:123], v[24:39]
    v_mfma_f32_32x32x16_bf16 v[8:23], v[208:211], v[124:127], v[8:23]
    v_mfma_f32_32x32x16_bf16 v[24:39], v[212:215], v[124:127], v[24:39]
    s_waitcnt vmcnt(4)
    v_max_u32 v4, v128, v132
    v_cmp_eq_u32 vcc, -1, v4
    s_nop 4
    s_cbranch_vccnz Lhr_135
Lhk_136:
    s_lshl_b32 s47, s91, 11
    s_add_u32 s47, s47, s94
    buffer_load_dwordx4 v[152:155], v1, s[28:31], s47 offen offset:0
    buffer_load_dwordx4 v[156:159], v1, s[28:31], s47 offen offset:1024
    v_mfma_f32_32x32x16_bf16 v[8:23], v[216:219], v[128:131], v[8:23]
    v_mfma_f32_32x32x16_bf16 v[24:39], v[220:223], v[128:131], v[24:39]
    v_mfma_f32_32x32x16_bf16 v[8:23], v[224:227], v[132:135], v[8:23]
    v_mfma_f32_32x32x16_bf16 v[24:39], v[228:231], v[132:135], v[24:39]
    s_waitcnt vmcnt(4)
    v_max_u32 v4, v136, v140
    v_cmp_eq_u32 vcc, -1, v4
    s_nop 4
    s_cbranch_vccnz Lhr_137
Lhk_138:
    s_lshl_b32 s47, s92, 11
    s_add_u32 s47, s47, s94
    buffer_load_dwordx4 v[160:163], v1, s[28:31], s47 offen offset:0
    buffer_load_dwordx4 v[164:167], v1, s[28:31], s47 offen offset:1024
    v_mfma_f32_32x32x16_bf16 v[8:23], v[232:235], v[136:139], v[8:23]
    v_mfma_f32_32x32x16_bf16 v[24:39], v[236:239], v[136:139], v[24:39]
    v_mfma_f32_32x32x16_bf16 v[8:23], v[240:243], v[140:143], v[8:23]
    v_mfma_f32_32x32x16_bf16 v[24:39], v[244:247], v[140:143], v[24:39]
    s_waitcnt vmcnt(4)
    v_max_u32 v4, v144, v148
    v_cmp_eq_u32 vcc, -1, v4
    s_nop 4
    s_cbranch_vccnz Lhr_139
Lhk_140:
    s_lshl_b32 s47, s86, 11
    s_add_u32 s47, s47, s95
    buffer_load_dwordx4 v[168:171], v1, s[28:31], s47 offen offset:0
    buffer_load_dwordx4 v[172:175], v1, s[28:31], s47 offen offset:1024
    v_mfma_f32_32x32x16_bf16 v[8:23], v[248:251], v[144:147], v[8:23]
    v_mfma_f32_32x32x16_bf16 v[24:39], v[252:255], v[144:147], v[24:39]
    v_mfma_f32_32x32x16_bf16 v[8:23], v[72:75], v[148:151], v[8:23]
    v_mfma_f32_32x32x16_bf16 v[24:39], v[76:79], v[148:151], v[24:39]
    s_waitcnt vmcnt(4)
    v_max_u32 v4, v152, v156
    v_cmp_eq_u32 vcc, -1, v4
    s_nop 4
    s_cbranch_vccnz Lhr_141
Lhk_142:
    s_lshl_b32 s47, s87, 11
    s_add_u32 s47, s47, s95
    buffer_load_dwordx4 v[112:115], v1, s[28:31], s47 offen offset:0
    buffer_load_dwordx4 v[116:119], v1, s[28:31], s47 offen offset:1024
    v_mfma_f32_32x32x16_bf16 v[8:23], v[80:83], v[152:155], v[8:23]
    v_mfma_f32_32x32x16_bf16 v[24:39], v[84:87], v[152:155], v[24:39]
    v_mfma_f32_32x32x16_bf16 v[8:23], v[88:91], v[156:159], v[8:23]
    v_mfma_f32_32x32x16_bf16 v[24:39], v[92:95], v[156:159], v[24:39]
    s_waitcnt vmcnt(4)
    v_max_u32 v4, v160, v164
    v_cmp_eq_u32 vcc, -1, v4
    s_nop 4
    s_cbranch_vccnz Lhr_143
Lhk_144:
    s_lshl_b32 s47, s88, 11
    s_add_u32 s47, s47, s95
    buffer_load_dwordx4 v[120:123], v1, s[28:31], s47 offen offset:0
    buffer_load_dwordx4 v[124:127], v1, s[28:31], s47 offen offset:1024
    v_mfma_f32_32x32x16_bf16 v[8:23], v[96:99], v[160:163], v[8:23]
    v_mfma_f32_32x32x16_bf16 v[24:39], v[100:103], v[160:163], v[24:39]
    v_mfma_f32_32x32x16_bf16 v[8:23], v[104:107], v[164:167], v[8:23]
    v_mfma_f32_32x32x16_bf16 v[24:39], v[108:111], v[164:167], v[24:39]
    s_waitcnt vmcnt(4)
    v_max_u32 v4, v168, v172
    v_cmp_eq_u32 vcc, -1, v4
    s_nop 4
    s_cbranch_vccnz Lhr_145
Lhk_146:
    s_lshl_b32 s47, s89, 11
    s_add_u32 s47, s47, s95
    buffer_load_dwordx4 v[128:131], v1, s[28:31], s47 offen offset:0
    buffer_load_dwordx4 v[132:135], v1, s[28:31], s47 offen offset:1024
    v_mfma_f32_32x32x16_bf16 v[40:55], v[184:187], v[168:171], 0
    v_mfma_f32_32x32x16_bf16 v[56:71], v[188:191], v[168:171], 0
    v_mfma_f32_32x32x16_bf16 v[40:55], v[192:195], v[172:175], v[40:55]
    v_mfma_f32_32x32x16_bf16 v[56:71], v[196:199], v[172:175], v[56:71]
    s_waitcnt lgkmcnt(0)
    s_barrier
    s_mul_i32 s47, s38, 14336
    v_add_u32 v5, s47, v1
    ds_write_b128 v5, v[8:11] offset:0
    ds_write_b128 v5, v[12:15] offset:1024
    ds_write_b128 v5, v[16:19] offset:2048
    ds_write_b128 v5, v[20:23] offset:3072
    ds_write_b128 v5, v[24:27] offset:4096
    ds_write_b128 v5, v[28:31] offset:5120
    ds_write_b128 v5, v[32:35] offset:6144
    v_lshlrev_b32 v182, 2, v0
    v_add_u32 v182, 158464, v182
    v_mov_b32 v183, 1
    ds_add_u32 v182, v183
    s_waitcnt vmcnt(4)
    v_max_u32 v4, v112, v116
    v_cmp_eq_u32 vcc, -1, v4
    s_nop 4
    s_cbranch_vccnz Lhr_147
Lhk_148:
    s_lshl_b32 s47, s90, 11
    s_add_u32 s47, s47, s95
    buffer_load_dwordx4 v[136:139], v1, s[28:31], s47 offen offset:0
    buffer_load_dwordx4 v[140:143], v1, s[28:31], s47 offen offset:1024
    v_mfma_f32_32x32x16_bf16 v[40:55], v[200:203], v[112:115], v[40:55]
    v_mfma_f32_32x32x16_bf16 v[56:71], v[204:207], v[112:115], v[56:71]
    v_mfma_f32_32x32x16_bf16 v[40:55], v[208:211], v[116:119], v[40:55]
    v_mfma_f32_32x32x16_bf16 v[56:71], v[212:215], v[116:119], v[56:71]
    s_waitcnt vmcnt(4)
    v_max_u32 v4, v120, v124
    v_cmp_eq_u32 vcc, -1, v4
    s_nop 4
    s_cbranch_vccnz Lhr_149
Lhk_150:
    s_lshl_b32 s47, s91, 11
    s_add_u32 s47, s47, s95
    buffer_load_dwordx4 v[144:147], v1, s[28:31], s47 offen offset:0
    buffer_load_dwordx4 v[148:151], v1, s[28:31], s47 offen offset:1024
    v_mfma_f32_32x32x16_bf16 v[40:55], v[216:219], v[120:123], v[40:55]
    v_mfma_f32_32x32x16_bf16 v[56:71], v[220:223], v[120:123], v[56:71]
    v_mfma_f32_32x32x16_bf16 v[40:55], v[224:227], v[124:127], v[40:55]
    v_mfma_f32_32x32x16_bf16 v[56:71], v[228:231], v[124:127], v[56:71]
    s_waitcnt vmcnt(4)
    v_max_u32 v4, v128, v132
    v_cmp_eq_u32 vcc, -1, v4
    s_nop 4
    s_cbranch_vccnz Lhr_151
Lhk_152:
    s_lshl_b32 s47, s92, 11
    s_add_u32 s47, s47, s95
    buffer_load_dwordx4 v[152:155], v1, s[28:31], s47 offen offset:0
    buffer_load_dwordx4 v[156:159], v1, s[28:31], s47 offen offset:1024
    v_mfma_f32_32x32x16_bf16 v[40:55], v[232:235], v[128:131], v[40:55]
    v_mfma_f32_32x32x16_bf16 v[56:71], v[236:239], v[128:131], v[56:71]
    v_mfma_f32_32x32x16_bf16 v[40:55], v[240:243], v[132:135], v[40:55]
    v_mfma_f32_32x32x16_bf16 v[56:71], v[244:247], v[132:135], v[56:71]
    s_cmp_gt_u32 s38, 3
    s_subb_u32 s51, s38, 0
    s_lshl_b32 s52, s51, 10
    v_add_u32 v180, s52, v1
    v_add_u32 v181, 57344, v180
    s_waitcnt lgkmcnt(0)
    ds_read_b32 v183, v182
    ds_read_b128 v[8:11], v180 offset:0
    ds_read_b128 v[12:15], v180 offset:14336
    ds_read_b128 v[16:19], v180 offset:28672
    ds_read_b128 v[20:23], v180 offset:43008
    ds_read_b128 v[24:27], v181 offset:0
    ds_read_b128 v[28:31], v181 offset:14336
    ds_read_b128 v[32:35], v181 offset:28672
    ds_read_b128 v[36:39], v181 offset:43008
    s_mul_i32 s50, s59, 28672
    s_lshl_b32 s51, s51, 4
    s_add_u32 s50, s50, s51
    s_and_b32 s51, s37, 7
    s_mul_i32 s51, s51, 112
    s_add_u32 s50, s50, s51
    s_add_u32 s52, s50, 28672
    s_cmp_eq_u32 s38, 3
    s_cselect_b32 s51, 0x40000000, 0
    v_mul_u32_u24 v6, 0x380, v2
    v_lshl_add_u32 v6, v3, 3, v6
    v_add_u32 v6, s51, v6
    s_waitcnt vmcnt(4)
    v_max_u32 v4, v136, v140
    v_cmp_eq_u32 vcc, -1, v4
    s_nop 4
    s_cbranch_vccnz Lhr_153
Lhk_154:
    v_mfma_f32_32x32x16_bf16 v[40:55], v[248:251], v[136:139], v[40:55]
    v_mfma_f32_32x32x16_bf16 v[56:71], v[252:255], v[136:139], v[56:71]
    v_mfma_f32_32x32x16_bf16 v[40:55], v[72:75], v[140:143], v[40:55]
    v_mfma_f32_32x32x16_bf16 v[56:71], v[76:79], v[140:143], v[56:71]
    s_waitcnt vmcnt(2)
    v_max_u32 v4, v144, v148
    v_cmp_eq_u32 vcc, -1, v4
    s_nop 4
    s_cbranch_vccnz Lhr_155
Lhk_156:
    v_mfma_f32_32x32x16_bf16 v[40:55], v[80:83], v[144:147], v[40:55]
    s_waitcnt lgkmcnt(0)
    v_cmp_gt_u32 vcc, 8, v183
    s_nop 4
    s_cbranch_vccnz Lrr_157
Lrk_158:
    v_pk_add_f32 v[36:37], v[36:37], v[8:9]
    v_pk_add_f32 v[38:39], v[38:39], v[10:11]
    v_pk_add_f32 v[36:37], v[36:37], v[12:13]
    v_pk_add_f32 v[38:39], v[38:39], v[14:15]
    v_pk_add_f32 v[36:37], v[36:37], v[16:17]
    v_pk_add_f32 v[38:39], v[38:39], v[18:19]
    v_pk_add_f32 v[36:37], v[36:37], v[20:21]
    v_pk_add_f32 v[38:39], v[38:39], v[22:23]
    v_pk_add_f32 v[36:37], v[36:37], v[24:25]
    v_pk_add_f32 v[38:39], v[38:39], v[26:27]
    v_pk_add_f32 v[36:37], v[36:37], v[28:29]
    v_pk_add_f32 v[38:39], v[38:39], v[30:31]
    v_pk_add_f32 v[36:37], v[36:37], v[32:33]
    v_pk_add_f32 v[38:39], v[38:39], v[34:35]
    v_lshlrev_b32 v8, 16, v176
    v_and_b32 v9, 0xffff0000, v176
    v_lshlrev_b32 v10, 16, v177
    v_and_b32 v11, 0xffff0000, v177
    v_pk_add_f32 v[36:37], v[36:37], v[8:9]
    v_pk_add_f32 v[38:39], v[38:39], v[10:11]
    v_cvt_pk_bf16_f32 v182, v36, v37
    v_cvt_pk_bf16_f32 v183, v38, v39
    v_mfma_f32_32x32x16_bf16 v[56:71], v[84:87], v[144:147], v[56:71]
    v_mfma_f32_32x32x16_bf16 v[40:55], v[88:91], v[148:151], v[40:55]
    v_mfma_f32_32x32x16_bf16 v[56:71], v[92:95], v[148:151], v[56:71]
    s_waitcnt vmcnt(0)
    v_max_u32 v4, v152, v156
    v_cmp_eq_u32 vcc, -1, v4
    s_nop 4
    s_cbranch_vccnz Lhr_159
Lhk_160:
    buffer_store_dwordx2 v[182:183], v6, s[24:27], s50 offen
    v_mfma_f32_32x32x16_bf16 v[40:55], v[96:99], v[152:155], v[40:55]
    v_mfma_f32_32x32x16_bf16 v[56:71], v[100:103], v[152:155], v[56:71]
    v_mfma_f32_32x32x16_bf16 v[40:55], v[104:107], v[156:159], v[40:55]
    v_mfma_f32_32x32x16_bf16 v[56:71], v[108:111], v[156:159], v[56:71]
Ljoin2:
    s_mul_i32 s47, s38, 14336
    v_add_u32 v5, s47, v1
    s_nop 8
    ds_write_b128 v5, v[40:43] offset:7168
    ds_write_b128 v5, v[44:47] offset:8192
    ds_write_b128 v5, v[48:51] offset:9216
    ds_write_b128 v5, v[52:55] offset:10240
    ds_write_b128 v5, v[56:59] offset:11264
    ds_write_b128 v5, v[60:63] offset:12288
    ds_write_b128 v5, v[64:67] offset:13312
    s_waitcnt lgkmcnt(0)
    s_barrier
    ds_read_b128 v[8:11], v180 offset:7168
    ds_read_b128 v[12:15], v180 offset:21504
    ds_read_b128 v[16:19], v180 offset:35840
    ds_read_b128 v[20:23], v180 offset:50176
    ds_read_b128 v[24:27], v181 offset:7168
    ds_read_b128 v[28:31], v181 offset:21504
    ds_read_b128 v[32:35], v181 offset:35840
    ds_read_b128 v[36:39], v181 offset:50176
    v_lshlrev_b32 v112, 16, v178
    v_and_b32 v113, 0xffff0000, v178
    v_lshlrev_b32 v114, 16, v179
    v_and_b32 v115, 0xffff0000, v179
    s_waitcnt lgkmcnt(7)
    v_pk_add_f32 v[112:113], v[112:113], v[8:9]
    v_pk_add_f32 v[114:115], v[114:115], v[10:11]
    s_waitcnt lgkmcnt(6)
    v_pk_add_f32 v[112:113], v[112:113], v[12:13]
    v_pk_add_f32 v[114:115], v[114:115], v[14:15]
    s_waitcnt lgkmcnt(5)
    v_pk_add_f32 v[112:113], v[112:113], v[16:17]
    v_pk_add_f32 v[114:115], v[114:115], v[18:19]
    s_waitcnt lgkmcnt(4)
    v_pk_add_f32 v[112:113], v[112:113], v[20:21]
    v_pk_add_f32 v[114:115], v[114:115], v[22:23]
    s_waitcnt lgkmcnt(3)
    v_pk_add_f32 v[112:113], v[112:113], v[24:25]
    v_pk_add_f32 v[114:115], v[114:115], v[26:27]
    s_waitcnt lgkmcnt(2)
    v_pk_add_f32 v[112:113], v[112:113], v[28:29]
    v_pk_add_f32 v[114:115], v[114:115], v[30:31]
    s_waitcnt lgkmcnt(1)
    v_pk_add_f32 v[112:113], v[112:113], v[32:33]
    v_pk_add_f32 v[114:115], v[114:115], v[34:35]
    s_waitcnt lgkmcnt(0)
    v_pk_add_f32 v[112:113], v[112:113], v[36:37]
    v_pk_add_f32 v[114:115], v[114:115], v[38:39]
    v_cvt_pk_bf16_f32 v182, v112, v113
    v_cvt_pk_bf16_f32 v183, v114, v115
    buffer_store_dwordx2 v[182:183], v6, s[24:27], s52 offen
Lend:
    s_endpgm
Lsl_107:
    s_sleep 1
    ds_read_b32 v5, v6 offset:256
    s_waitcnt lgkmcnt(0)
    v_cmp_gt_u32 vcc, s52, v5
    s_nop 4
    s_cbranch_vccnz Lsl_107
    s_branch Lbk_108
Lsl_109:
    s_sleep 1
    ds_read_b32 v5, v6 offset:512
    s_waitcnt lgkmcnt(0)
    v_cmp_gt_u32 vcc, s52, v5
    s_nop 4
    s_cbranch_vccnz Lsl_109
    s_branch Lbk_110
Lsl_111:
    s_sleep 1
    ds_read_b32 v5, v6 offset:768
    s_waitcnt lgkmcnt(0)
    v_cmp_gt_u32 vcc, s52, v5
    s_nop 4
    s_cbranch_vccnz Lsl_111
    s_branch Lbk_112
Lsl_113:
    s_sleep 1
    ds_read_b32 v5, v6 offset:0
    s_waitcnt lgkmcnt(0)
    v_cmp_gt_u32 vcc, s51, v5
    s_nop 4
    s_cbranch_vccnz Lsl_113
    s_branch Lbk_114
Lsl_115:
    s_sleep 1
    ds_read_b32 v5, v6 offset:256
    s_waitcnt lgkmcnt(0)
    v_cmp_gt_u32 vcc, s52, v5
    s_nop 4
    s_cbranch_vccnz Lsl_115
    s_branch Lbk_116
Lsl_117:
    s_sleep 1
    ds_read_b32 v5, v6 offset:512
    s_waitcnt lgkmcnt(0)
    v_cmp_gt_u32 vcc, s52, v5
    s_nop 4
    s_cbranch_vccnz Lsl_117
    s_branch Lbk_118
Lsl_119:
    s_sleep 1
    ds_read_b32 v5, v6 offset:768
    s_waitcnt lgkmcnt(0)
    v_cmp_gt_u32 vcc, s52, v5
    s_nop 4
    s_cbranch_vccnz Lsl_119
    s_branch Lbk_120
Lsl_121:
    s_sleep 1
    ds_read_b32 v5, v6 offset:0
    s_waitcnt lgkmcnt(0)
    v_cmp_gt_u32 vcc, s51, v5
    s_nop 4
    s_cbranch_vccnz Lsl_121
    s_branch Lbk_122
Lfallback:
    v_mov_b32 v6, 0xff800000
    s_mov_b32 s50, 0
    s_mov_b32 s48, 0
    v_mov_b32 v120, 0
    v_mov_b32 v124, 0
Lfb1:
    buffer_load_dwordx4 v[112:115], v8, s[28:31], s50 offen offset:0 sc1
    buffer_load_dwordx4 v[116:119], v8, s[28:31], s50 offen offset:1024 sc1
    s_not_b64 exec, s[44:45]
    buffer_load_dwordx4 v[120:123], v9, s[28:31], s50 offen offset:2048 sc1
    buffer_load_dwordx4 v[124:127], v10, s[28:31], s50 offen offset:3072 sc1
    s_mov_b64 exec, -1
    s_waitcnt vmcnt(0)
    v_max3_u32 v5, v112, v116, v120
    v_max_u32 v5, v5, v124
    v_cmp_eq_u32 vcc, -1, v5
    s_nop 4
    s_cbranch_vccz Lfb1k
    s_sleep 8
    s_add_u32 s48, s48, 1
    s_cmp_lt_u32 s48, 262144
    s_cbranch_scc1 Lfb1
Lfb1k:
    v_mfma_f32_32x32x16_bf16 v[64:79], v[112:115], v[16:19], 0
    v_mfma_f32_32x32x16_bf16 v[64:79], v[116:119], v[20:23], v[64:79]
    s_nop 11
    v_max3_f32 v6, v6, v64, v65
    v_max3_f32 v6, v6, v66, v67
    v_max3_f32 v6, v6, v68, v69
    v_max3_f32 v6, v6, v70, v71
    v_max3_f32 v6, v6, v72, v73
    v_max3_f32 v6, v6, v74, v75
    v_max3_f32 v6, v6, v76, v77
    v_max3_f32 v6, v6, v78, v79
    s_add_u32 s50, s50, 86016
    s_cmp_lt_u32 s50, 5505024
    s_cbranch_scc1 Lfb1
    v_mov_b32 v5, v6
    s_nop 1
    v_permlane32_swap_b32 v6, v5
    v_max_f32 v6, v6, v5
    v_sub_f32 v48, 0, v6
    v_mov_b32 v32, 0
    v_sub_f32 v49, 0, v6
    v_mov_b32 v33, 0
    v_sub_f32 v50, 0, v6
    v_mov_b32 v34, 0
    v_sub_f32 v51, 0, v6
    v_mov_b32 v35, 0
    v_sub_f32 v52, 0, v6
    v_mov_b32 v36, 0
    v_sub_f32 v53, 0, v6
    v_mov_b32 v37, 0
    v_sub_f32 v54, 0, v6
    v_mov_b32 v38, 0
    v_sub_f32 v55, 0, v6
    v_mov_b32 v39, 0
    v_sub_f32 v56, 0, v6
    v_mov_b32 v40, 0
    v_sub_f32 v57, 0, v6
    v_mov_b32 v41, 0
    v_sub_f32 v58, 0, v6
    v_mov_b32 v42, 0
    v_sub_f32 v59, 0, v6
    v_mov_b32 v43, 0
    v_sub_f32 v60, 0, v6
    v_mov_b32 v44, 0
    v_sub_f32 v61, 0, v6
    v_mov_b32 v45, 0
    v_sub_f32 v62, 0, v6
    v_mov_b32 v46, 0
    v_sub_f32 v63, 0, v6
    v_mov_b32 v47, 0
    v_mov_b32 v4, 0x3f803f80
    v_cmp_eq_u32 vcc, 28, v2
    s_nop 1
    v_cndmask_b32 v4, 0, v4, vcc
    v_mov_b32 v120, v4
    v_mov_b32 v121, v4
    v_mov_b32 v122, v4
    v_mov_b32 v123, v4
    v_mov_b32 v124, v4
    v_mov_b32 v125, v4
    v_mov_b32 v126, v4
    v_mov_b32 v127, v4
    s_mov_b32 s50, 0
Lfb2:
    buffer_load_dwordx4 v[112:115], v8, s[28:31], s50 offen offset:0 sc1
    buffer_load_dwordx4 v[116:119], v8, s[28:31], s50 offen offset:1024 sc1
    s_not_b64 exec, s[44:45]
    buffer_load_dwordx4 v[120:123], v9, s[28:31], s50 offen offset:2048 sc1
    buffer_load_dwordx4 v[124:127], v10, s[28:31], s50 offen offset:3072 sc1
    s_mov_b64 exec, -1
    s_waitcnt vmcnt(0)
    v_mfma_f32_32x32x16_bf16 v[64:79], v[112:115], v[16:19], v[48:63]
    v_mfma_f32_32x32x16_bf16 v[64:79], v[116:119], v[20:23], v[64:79]
    s_nop 11
    v_exp_f32 v64, v64
    v_exp_f32 v65, v65
    v_exp_f32 v66, v66
    v_exp_f32 v67, v67
    v_exp_f32 v68, v68
    v_exp_f32 v69, v69
    v_exp_f32 v70, v70
    v_exp_f32 v71, v71
    v_exp_f32 v72, v72
    v_exp_f32 v73, v73
    v_exp_f32 v74, v74
    v_exp_f32 v75, v75
    v_exp_f32 v76, v76
    v_exp_f32 v77, v77
    v_exp_f32 v78, v78
    v_exp_f32 v79, v79
    v_cvt_pk_bf16_f32 v96, v64, v65
    v_cvt_pk_bf16_f32 v97, v66, v67
    v_cvt_pk_bf16_f32 v98, v68, v69
    v_cvt_pk_bf16_f32 v99, v70, v71
    v_cvt_pk_bf16_f32 v100, v72, v73
    v_cvt_pk_bf16_f32 v101, v74, v75
    v_cvt_pk_bf16_f32 v102, v76, v77
    v_cvt_pk_bf16_f32 v103, v78, v79
    v_mfma_f32_32x32x16_bf16 v[32:47], v[120:123], v[96:99], v[32:47]
    s_nop 0
    v_mfma_f32_32x32x16_bf16 v[32:47], v[124:127], v[100:103], v[32:47]
    s_add_u32 s50, s50, 86016
    s_cmp_lt_u32 s50, 5505024
    s_cbranch_scc1 Lfb2
    s_mov_b32 s53, 1
    s_branch Lofin
Lrr_157:
    ds_read_b32 v183, v182
    ds_read_b128 v[8:11], v180 offset:0
    ds_read_b128 v[12:15], v180 offset:14336
    ds_read_b128 v[16:19], v180 offset:28672
    ds_read_b128 v[20:23], v180 offset:43008
    ds_read_b128 v[24:27], v181 offset:0
    ds_read_b128 v[28:31], v181 offset:14336
    ds_read_b128 v[32:35], v181 offset:28672
    ds_read_b128 v[36:39], v181 offset:43008
    s_waitcnt lgkmcnt(0)
    v_cmp_gt_u32 vcc, 8, v183
    s_nop 4
    s_cbranch_vccnz Lrr_157
    s_branch Lrk_158
Lhr_131:
    s_mov_b32 s48, 0
Lhr_131x:
    s_lshl_b32 s47, s86, 11
    s_add_u32 s47, s47, s94
    buffer_load_dwordx4 v[112:115], v1, s[28:31], s47 offen offset:0 sc1
    buffer_load_dwordx4 v[116:119], v1, s[28:31], s47 offen offset:1024 sc1
    s_lshl_b32 s47, s87, 11
    s_add_u32 s47, s47, s94
    buffer_load_dwordx4 v[120:123], v1, s[28:31], s47 offen offset:0 sc1
    buffer_load_dwordx4 v[124:127], v1, s[28:31], s47 offen offset:1024 sc1
    s_lshl_b32 s47, s88, 11
    s_add_u32 s47, s47, s94
    buffer_load_dwordx4 v[128:131], v1, s[28:31], s47 offen offset:0 sc1
    buffer_load_dwordx4 v[132:135], v1, s[28:31], s47 offen offset:1024 sc1
    s_waitcnt vmcnt(0)
    v_max_u32 v4, v112, v116
    v_cmp_eq_u32 vcc, -1, v4
    s_nop 4
    s_cbranch_vccz Lhk_132
    s_add_u32 s48, s48, 1
    s_cmp_lt_u32 s48, 262144
    s_cbranch_scc1 Lhr_131x
    s_branch Lhk_132
Lhr_133:
    s_mov_b32 s48, 0
Lhr_133x:
    s_lshl_b32 s47, s87, 11
    s_add_u32 s47, s47, s94
    buffer_load_dwordx4 v[120:123], v1, s[28:31], s47 offen offset:0 sc1
    buffer_load_dwordx4 v[124:127], v1, s[28:31], s47 offen offset:1024 sc1
    s_lshl_b32 s47, s88, 11
    s_add_u32 s47, s47, s94
    buffer_load_dwordx4 v[128:131], v1, s[28:31], s47 offen offset:0 sc1
    buffer_load_dwordx4 v[132:135], v1, s[28:31], s47 offen offset:1024 sc1
    s_lshl_b32 s47, s89, 11
    s_add_u32 s47, s47, s94
    buffer_load_dwordx4 v[136:139], v1, s[28:31], s47 offen offset:0 sc1
    buffer_load_dwordx4 v[140:143], v1, s[28:31], s47 offen offset:1024 sc1
    s_waitcnt vmcnt(0)
    v_max_u32 v4, v120, v124
    v_cmp_eq_u32 vcc, -1, v4
    s_nop 4
    s_cbranch_vccz Lhk_134
    s_add_u32 s48, s48, 1
    s_cmp_lt_u32 s48, 262144
    s_cbranch_scc1 Lhr_133x
    s_branch Lhk_134
Lhr_135:
    s_mov_b32 s48, 0
Lhr_135x:
    s_lshl_b32 s47, s88, 11
    s_add_u32 s47, s47, s94
    buffer_load_dwordx4 v[128:131], v1, s[28:31], s47 offen offset:0 sc1
    buffer_load_dwordx4 v[132:135], v1, s[28:31], s47 offen offset:1024 sc1
    s_lshl_b32 s47, s89, 11
    s_add_u32 s47, s47, s94
    buffer_load_dwordx4 v[136:139], v1, s[28:31], s47 offen offset:0 sc1
    buffer_load_dwordx4 v[140:143], v1, s[28:31], s47 offen offset:1024 sc1
    s_lshl_b32 s47, s90, 11
    s_add_u32 s47, s47, s94
    buffer_load_dwordx4 v[144:147], v1, s[28:31], s47 offen offset:0 sc1
    buffer_load_dwordx4 v[148:151], v1, s[28:31], s47 offen offset:1024 sc1
    s_waitcnt vmcnt(0)
    v_max_u32 v4, v128, v132
    v_cmp_eq_u32 vcc, -1, v4
    s_nop 4
    s_cbranch_vccz Lhk_136
    s_add_u32 s48, s48, 1
    s_cmp_lt_u32 s48, 262144
    s_cbranch_scc1 Lhr_135x
    s_branch Lhk_136
Lhr_137:
    s_mov_b32 s48, 0
Lhr_137x:
    s_lshl_b32 s47, s89, 11
    s_add_u32 s47, s47, s94
    buffer_load_dwordx4 v[136:139], v1, s[28:31], s47 offen offset:0 sc1
    buffer_load_dwordx4 v[140:143], v1, s[28:31], s47 offen offset:1024 sc1
    s_lshl_b32 s47, s90, 11
    s_add_u32 s47, s47, s94
    buffer_load_dwordx4 v[144:147], v1, s[28:31], s47 offen offset:0 sc1
    buffer_load_dwordx4 v[148:151], v1, s[28:31], s47 offen offset:1024 sc1
    s_lshl_b32 s47, s91, 11
    s_add_u32 s47, s47, s94
    buffer_load_dwordx4 v[152:155], v1, s[28:31], s47 offen offset:0 sc1
    buffer_load_dwordx4 v[156:159], v1, s[28:31], s47 offen offset:1024 sc1
    s_waitcnt vmcnt(0)
    v_max_u32 v4, v136, v140
    v_cmp_eq_u32 vcc, -1, v4
    s_nop 4
    s_cbranch_vccz Lhk_138
    s_add_u32 s48, s48, 1
    s_cmp_lt_u32 s48, 262144
    s_cbranch_scc1 Lhr_137x
    s_branch Lhk_138
Lhr_139:
    s_mov_b32 s48, 0
Lhr_139x:
    s_lshl_b32 s47, s90, 11
    s_add_u32 s47, s47, s94
    buffer_load_dwordx4 v[144:147], v1, s[28:31], s47 offen offset:0 sc1
    buffer_load_dwordx4 v[148:151], v1, s[28:31], s47 offen offset:1024 sc1
    s_lshl_b32 s47, s91, 11
    s_add_u32 s47, s47, s94
    buffer_load_dwordx4 v[152:155], v1, s[28:31], s47 offen offset:0 sc1
    buffer_load_dwordx4 v[156:159], v1, s[28:31], s47 offen offset:1024 sc1
    s_lshl_b32 s47, s92, 11
    s_add_u32 s47, s47, s94
    buffer_load_dwordx4 v[160:163], v1, s[28:31], s47 offen offset:0 sc1
    buffer_load_dwordx4 v[164:167], v1, s[28:31], s47 offen offset:1024 sc1
    s_waitcnt vmcnt(0)
    v_max_u32 v4, v144, v148
    v_cmp_eq_u32 vcc, -1, v4
    s_nop 4
    s_cbranch_vccz Lhk_140
    s_add_u32 s48, s48, 1
    s_cmp_lt_u32 s48, 262144
    s_cbranch_scc1 Lhr_139x
    s_branch Lhk_140
Lhr_141:
    s_mov_b32 s48, 0
Lhr_141x:
    s_lshl_b32 s47, s91, 11
    s_add_u32 s47, s47, s94
    buffer_load_dwordx4 v[152:155], v1, s[28:31], s47 offen offset:0 sc1
    buffer_load_dwordx4 v[156:159], v1, s[28:31], s47 offen offset:1024 sc1
    s_lshl_b32 s47, s92, 11
    s_add_u32 s47, s47, s94
    buffer_load_dwordx4 v[160:163], v1, s[28:31], s47 offen offset:0 sc1
    buffer_load_dwordx4 v[164:167], v1, s[28:31], s47 offen offset:1024 sc1
    s_lshl_b32 s47, s86, 11
    s_add_u32 s47, s47, s95
    buffer_load_dwordx4 v[168:171], v1, s[28:31], s47 offen offset:0 sc1
    buffer_load_dwordx4 v[172:175], v1, s[28:31], s47 offen offset:1024 sc1
    s_waitcnt vmcnt(0)
    v_max_u32 v4, v152, v156
    v_cmp_eq_u32 vcc, -1, v4
    s_nop 4
    s_cbranch_vccz Lhk_142
    s_add_u32 s48, s48, 1
    s_cmp_lt_u32 s48, 262144
    s_cbranch_scc1 Lhr_141x
    s_branch Lhk_142
Lhr_143:
    s_mov_b32 s48, 0
Lhr_143x:
    s_lshl_b32 s47, s92, 11
    s_add_u32 s47, s47, s94
    buffer_load_dwordx4 v[160:163], v1, s[28:31], s47 offen offset:0 sc1
    buffer_load_dwordx4 v[164:167], v1, s[28:31], s47 offen offset:1024 sc1
    s_lshl_b32 s47, s86, 11
    s_add_u32 s47, s47, s95
    buffer_load_dwordx4 v[168:171], v1, s[28:31], s47 offen offset:0 sc1
    buffer_load_dwordx4 v[172:175], v1, s[28:31], s47 offen offset:1024 sc1
    s_lshl_b32 s47, s87, 11
    s_add_u32 s47, s47, s95
    buffer_load_dwordx4 v[112:115], v1, s[28:31], s47 offen offset:0 sc1
    buffer_load_dwordx4 v[116:119], v1, s[28:31], s47 offen offset:1024 sc1
    s_waitcnt vmcnt(0)
    v_max_u32 v4, v160, v164
    v_cmp_eq_u32 vcc, -1, v4
    s_nop 4
    s_cbranch_vccz Lhk_144
    s_add_u32 s48, s48, 1
    s_cmp_lt_u32 s48, 262144
    s_cbranch_scc1 Lhr_143x
    s_branch Lhk_144
Lhr_145:
    s_mov_b32 s48, 0
Lhr_145x:
    s_lshl_b32 s47, s86, 11
    s_add_u32 s47, s47, s95
    buffer_load_dwordx4 v[168:171], v1, s[28:31], s47 offen offset:0 sc1
    buffer_load_dwordx4 v[172:175], v1, s[28:31], s47 offen offset:1024 sc1
    s_lshl_b32 s47, s87, 11
    s_add_u32 s47, s47, s95
    buffer_load_dwordx4 v[112:115], v1, s[28:31], s47 offen offset:0 sc1
    buffer_load_dwordx4 v[116:119], v1, s[28:31], s47 offen offset:1024 sc1
    s_lshl_b32 s47, s88, 11
    s_add_u32 s47, s47, s95
    buffer_load_dwordx4 v[120:123], v1, s[28:31], s47 offen offset:0 sc1
    buffer_load_dwordx4 v[124:127], v1, s[28:31], s47 offen offset:1024 sc1
    s_waitcnt vmcnt(0)
    v_max_u32 v4, v168, v172
    v_cmp_eq_u32 vcc, -1, v4
    s_nop 4
    s_cbranch_vccz Lhk_146
    s_add_u32 s48, s48, 1
    s_cmp_lt_u32 s48, 262144
    s_cbranch_scc1 Lhr_145x
    s_branch Lhk_146
Lhr_147:
    s_mov_b32 s48, 0
Lhr_147x:
    s_lshl_b32 s47, s87, 11
    s_add_u32 s47, s47, s95
    buffer_load_dwordx4 v[112:115], v1, s[28:31], s47 offen offset:0 sc1
    buffer_load_dwordx4 v[116:119], v1, s[28:31], s47 offen offset:1024 sc1
    s_lshl_b32 s47, s88, 11
    s_add_u32 s47, s47, s95
    buffer_load_dwordx4 v[120:123], v1, s[28:31], s47 offen offset:0 sc1
    buffer_load_dwordx4 v[124:127], v1, s[28:31], s47 offen offset:1024 sc1
    s_lshl_b32 s47, s89, 11
    s_add_u32 s47, s47, s95
    buffer_load_dwordx4 v[128:131], v1, s[28:31], s47 offen offset:0 sc1
    buffer_load_dwordx4 v[132:135], v1, s[28:31], s47 offen offset:1024 sc1
    s_waitcnt vmcnt(0)
    v_max_u32 v4, v112, v116
    v_cmp_eq_u32 vcc, -1, v4
    s_nop 4
    s_cbranch_vccz Lhk_148
    s_add_u32 s48, s48, 1
    s_cmp_lt_u32 s48, 262144
    s_cbranch_scc1 Lhr_147x
    s_branch Lhk_148
Lhr_149:
    s_mov_b32 s48, 0
Lhr_149x:
    s_lshl_b32 s47, s88, 11
    s_add_u32 s47, s47, s95
    buffer_load_dwordx4 v[120:123], v1, s[28:31], s47 offen offset:0 sc1
    buffer_load_dwordx4 v[124:127], v1, s[28:31], s47 offen offset:1024 sc1
    s_lshl_b32 s47, s89, 11
    s_add_u32 s47, s47, s95
    buffer_load_dwordx4 v[128:131], v1, s[28:31], s47 offen offset:0 sc1
    buffer_load_dwordx4 v[132:135], v1, s[28:31], s47 offen offset:1024 sc1
    s_lshl_b32 s47, s90, 11
    s_add_u32 s47, s47, s95
    buffer_load_dwordx4 v[136:139], v1, s[28:31], s47 offen offset:0 sc1
    buffer_load_dwordx4 v[140:143], v1, s[28:31], s47 offen offset:1024 sc1
    s_waitcnt vmcnt(0)
    v_max_u32 v4, v120, v124
    v_cmp_eq_u32 vcc, -1, v4
    s_nop 4
    s_cbranch_vccz Lhk_150
    s_add_u32 s48, s48, 1
    s_cmp_lt_u32 s48, 262144
    s_cbranch_scc1 Lhr_149x
    s_branch Lhk_150
Lhr_151:
    s_mov_b32 s48, 0
Lhr_151x:
    s_lshl_b32 s47, s89, 11
    s_add_u32 s47, s47, s95
    buffer_load_dwordx4 v[128:131], v1, s[28:31], s47 offen offset:0 sc1
    buffer_load_dwordx4 v[132:135], v1, s[28:31], s47 offen offset:1024 sc1
    s_lshl_b32 s47, s90, 11
    s_add_u32 s47, s47, s95
    buffer_load_dwordx4 v[136:139], v1, s[28:31], s47 offen offset:0 sc1
    buffer_load_dwordx4 v[140:143], v1, s[28:31], s47 offen offset:1024 sc1
    s_lshl_b32 s47, s91, 11
    s_add_u32 s47, s47, s95
    buffer_load_dwordx4 v[144:147], v1, s[28:31], s47 offen offset:0 sc1
    buffer_load_dwordx4 v[148:151], v1, s[28:31], s47 offen offset:1024 sc1
    s_waitcnt vmcnt(0)
    v_max_u32 v4, v128, v132
    v_cmp_eq_u32 vcc, -1, v4
    s_nop 4
    s_cbranch_vccz Lhk_152
    s_add_u32 s48, s48, 1
    s_cmp_lt_u32 s48, 262144
    s_cbranch_scc1 Lhr_151x
    s_branch Lhk_152
Lhr_153:
    s_mov_b32 s48, 0
Lhr_153x:
    s_lshl_b32 s47, s90, 11
    s_add_u32 s47, s47, s95
    buffer_load_dwordx4 v[136:139], v1, s[28:31], s47 offen offset:0 sc1
    buffer_load_dwordx4 v[140:143], v1, s[28:31], s47 offen offset:1024 sc1
    s_lshl_b32 s47, s91, 11
    s_add_u32 s47, s47, s95
    buffer_load_dwordx4 v[144:147], v1, s[28:31], s47 offen offset:0 sc1
    buffer_load_dwordx4 v[148:151], v1, s[28:31], s47 offen offset:1024 sc1
    s_lshl_b32 s47, s92, 11
    s_add_u32 s47, s47, s95
    buffer_load_dwordx4 v[152:155], v1, s[28:31], s47 offen offset:0 sc1
    buffer_load_dwordx4 v[156:159], v1, s[28:31], s47 offen offset:1024 sc1
    s_waitcnt vmcnt(0)
    v_max_u32 v4, v136, v140
    v_cmp_eq_u32 vcc, -1, v4
    s_nop 4
    s_cbranch_vccz Lhk_154
    s_add_u32 s48, s48, 1
    s_cmp_lt_u32 s48, 262144
    s_cbranch_scc1 Lhr_153x
    s_branch Lhk_154
Lhr_155:
    s_mov_b32 s48, 0
Lhr_155x:
    s_lshl_b32 s47, s91, 11
    s_add_u32 s47, s47, s95
    buffer_load_dwordx4 v[144:147], v1, s[28:31], s47 offen offset:0 sc1
    buffer_load_dwordx4 v[148:151], v1, s[28:31], s47 offen offset:1024 sc1
    s_lshl_b32 s47, s92, 11
    s_add_u32 s47, s47, s95
    buffer_load_dwordx4 v[152:155], v1, s[28:31], s47 offen offset:0 sc1
    buffer_load_dwordx4 v[156:159], v1, s[28:31], s47 offen offset:1024 sc1
    s_waitcnt vmcnt(0)
    v_max_u32 v4, v144, v148
    v_cmp_eq_u32 vcc, -1, v4
    s_nop 4
    s_cbranch_vccz Lhk_156
    s_add_u32 s48, s48, 1
    s_cmp_lt_u32 s48, 262144
    s_cbranch_scc1 Lhr_155x
    s_branch Lhk_156
Lhr_159:
    s_mov_b32 s48, 0
Lhr_159x:
    s_lshl_b32 s47, s92, 11
    s_add_u32 s47, s47, s95
    buffer_load_dwordx4 v[152:155], v1, s[28:31], s47 offen offset:0 sc1
    buffer_load_dwordx4 v[156:159], v1, s[28:31], s47 offen offset:1024 sc1
    s_waitcnt vmcnt(0)
    v_max_u32 v4, v152, v156
    v_cmp_eq_u32 vcc, -1, v4
    s_nop 4
    s_cbranch_vccz Lhk_160
    s_add_u32 s48, s48, 1
    s_cmp_lt_u32 s48, 262144
    s_cbranch_scc1 Lhr_159x
    s_branch Lhk_160
Lcode_end:
    s_endpgm
.section .rodata,"a"
.p2align 6
.amdhsa_kernel sequential_preLN__softmax_full_mha__dense_activation_relu__prompt_kernel
  .amdhsa_next_free_vgpr 256
  .amdhsa_next_free_sgpr 102
  .amdhsa_accum_offset 256
  .amdhsa_group_segment_fixed_size 0
  .amdhsa_kernarg_size 72
  .amdhsa_user_sgpr_count 2
  .amdhsa_user_sgpr_kernarg_segment_ptr 1
  .amdhsa_system_sgpr_workgroup_id_x 1
.end_amdhsa_kernel
```
